```python
import torch

def _softmax(x, axis=-1):
    return torch.softmax(x, dim=axis)
def _gelu(x):
    return torch.nn.functional.gelu(x, approximate="tanh")
def _silu(x):
    return torch.nn.functional.silu(x)
def _sigmoid(x):
    return torch.sigmoid(x)
def _layernorm(x, axis=-1, eps=1e-5):
    m = x.mean(dim=axis, keepdim=True)
    v = x.var(dim=axis, keepdim=True, unbiased=False)
    return (x - m) / torch.sqrt(v + eps)
def _scatter_add(tgt, idx, src, axis=0):
    return tgt.clone().index_add_(axis, idx, src)
def _segment_sum(src, seg, n):
    out = torch.zeros((n,) + src.shape[1:], dtype=src.dtype)
    return out.index_add_(0, seg, src)
def _pad(x, pw):
    flat = tuple(v for pair in reversed(pw) for v in pair)
    return torch.nn.functional.pad(x, flat)

kernel_name = 'standalone__mha_softmax__near_ridge'

def setup_inputs():

    _w = (lambda a: (lambda t: t.to(torch.bfloat16) if t.is_floating_point() else t)(torch.as_tensor(a)))
    B, H, Sq, Sk, D = 8, 16, 496, 1024, 256
    return {
        "q": _w((lambda *s: torch.randn(*s, dtype=torch.bfloat16) * 0.8)(B, H, Sq, D)),
        "k": _w((lambda *s: torch.randn(*s, dtype=torch.bfloat16) * 0.8)(B, H, Sk, D)),
        "v": _w((lambda *s: torch.randn(*s, dtype=torch.bfloat16) * 0.05)(B, H, Sk, D)),
    }

def reference(q, k, v):
    scale = q.shape[-1] ** -0.5
    scores = torch.einsum("bhqd,bhkd->bhqk", q, k) * scale
    p = _softmax(scores, axis=-1)
    return torch.einsum("bhqk,bhkd->bhqd", p, v)
```

```asm
; @launch grid=(256,1,1) block=(256,1,1) lds=152128
.amdgcn_target "amdgcn-amd-amdhsa--gfx950"
.text
.globl standalone__mha_softmax__near_ridge_kernel
.p2align 8
.type standalone__mha_softmax__near_ridge_kernel,@function
standalone__mha_softmax__near_ridge_kernel:
    s_cmp_ge_u32 s2, 256
    s_cbranch_scc1 L_end
    s_load_dwordx8 s[40:47], s[0:1], 0
    v_lshrrev_b32 v16, 6, v0
    v_and_b32 v17, 63, v0
    v_readfirstlane_b32 s29, v16
    s_getpc_b64 s[100:101]
    s_bfe_u32 s33, s2, 0x40003
    s_min_u32 s33, s33, 10
    s_lshl_b32 s33, s33, 12
    v_lshl_add_u32 v18, v0, 4, s33
    global_load_dwordx4 v[252:255], v18, s[100:101]
    v_lshrrev_b32 v18, 5, v17
    v_and_b32 v19, 31, v17
    v_lshlrev_b32 v19, 4, v19
    s_lshr_b32 s33, s2, 4
    s_lshl_b32 s33, s33, 3
    s_and_b32 s34, s2, 7
    s_add_u32 s33, s33, s34
    s_lshr_b32 s34, s2, 3
    s_and_b32 s34, s34, 1
    s_mul_i32 s35, s33, 253952
    s_lshl_b32 s36, s33, 19
    s_mul_i32 s30, s29, 4224
    s_lshl_b32 s34, s34, 2
    s_add_u32 s34, s34, s29
    s_lshl_b32 s96, s34, 15
    s_cmp_eq_u32 s34, 7
    s_cselect_b32 s26, 0x7149f2ca, 0
    v_lshlrev_b32 v20, 11, v16
    v_lshl_add_u32 v20, v18, 13, v20
    v_add_u32 v5, v20, v19
    v_lshrrev_b32 v20, 3, v17
    v_and_b32 v21, 7, v17
    v_xor_b32 v22, v21, v20
    v_lshlrev_b32 v22, 4, v22
    v_lshl_add_u32 v6, v20, 9, v22
    s_mul_i32 s39, s29, 16896
    s_add_u32 s39, s39, 33792
    s_add_u32 s88, s96, 0
    s_add_u32 s89, s96, 4096
    s_add_u32 s90, s96, 8192
    s_add_u32 s91, s96, 12288
    s_add_u32 s92, s96, 16384
    s_add_u32 s93, s96, 20480
    s_add_u32 s94, s96, 24576
    s_add_u32 s95, s96, 28672
    s_mov_b32 s31, 16384
    s_mov_b32 s32, 32768
    s_mov_b32 s37, 49152
    s_mov_b32 s23, 65536
    s_mov_b32 s25, 81920
    s_mov_b32 s22, 81920
    s_mov_b32 s24, 98304
    s_waitcnt lgkmcnt(0)
    s_add_u32 s8, s42, s36
    s_addc_u32 s9, s43, 0
    s_and_b32 s9, s9, 0xffff
    s_mov_b32 s10, 524288
    s_mov_b32 s11, 0x00020000
    s_add_u32 s4, s40, s35
    s_addc_u32 s5, s41, 0
    s_and_b32 s5, s5, 0xffff
    s_mov_b32 s6, 253952
    s_mov_b32 s7, 0x00020000
    s_add_u32 m0, s30, 135168
    s_nop 0
    buffer_load_dwordx4 v5, s[8:11], 0 offen offset:0 nt lds
    s_add_u32 m0, s30, 135712
    s_nop 0
    buffer_load_dwordx4 v5, s[8:11], 0 offen offset:512 nt lds
    s_add_u32 m0, s30, 136256
    s_nop 0
    buffer_load_dwordx4 v5, s[8:11], 0 offen offset:1024 nt lds
    s_add_u32 m0, s30, 136800
    s_nop 0
    buffer_load_dwordx4 v5, s[8:11], 0 offen offset:1536 nt lds
    s_add_u32 m0, s30, 0
    s_nop 0
    buffer_load_dwordx4 v5, s[8:11], s31 offen offset:0 nt lds
    s_add_u32 m0, s30, 544
    s_nop 0
    buffer_load_dwordx4 v5, s[8:11], s31 offen offset:512 nt lds
    s_add_u32 m0, s30, 1088
    s_nop 0
    buffer_load_dwordx4 v5, s[8:11], s31 offen offset:1024 nt lds
    s_add_u32 m0, s30, 1632
    s_nop 0
    buffer_load_dwordx4 v5, s[8:11], s31 offen offset:1536 nt lds
    s_add_u32 m0, s39, 512
    s_nop 0
    buffer_load_dwordx4 v6, s[4:7], s88 offen offset:0 nt lds
    s_add_u32 m0, s39, 1536
    s_nop 0
    buffer_load_dwordx4 v6, s[4:7], s89 offen offset:0 nt lds
    s_add_u32 s12, s44, s36
    s_addc_u32 s13, s45, 0
    s_and_b32 s13, s13, 0xffff
    s_mov_b32 s14, 524288
    s_mov_b32 s15, 0x00020000
    s_add_u32 s16, s46, s35
    s_addc_u32 s17, s47, 0
    s_and_b32 s17, s17, 0xffff
    s_mov_b32 s18, 253952
    s_mov_b32 s19, 0x00020000
    v_and_b32 v20, 15, v17
    v_lshrrev_b32 v21, 4, v17
    v_mul_u32_u24 v22, 1056, v20
    v_lshl_add_u32 v1, v21, 4, v22
    v_add_u32 v4, 135168, v1
    v_lshrrev_b32 v22, 2, v17
    v_mul_u32_u24 v22, 1056, v22
    v_and_b32 v23, 3, v17
    v_lshl_add_u32 v22, v23, 3, v22
    v_add_u32 v3, 67584, v22
    v_and_b32 v22, 7, v17
    v_xor_b32 v22, v22, v21
    v_lshlrev_b32 v22, 4, v22
    v_lshl_add_u32 v22, v20, 7, v22
    v_xor_b32 v23, 64, v22
    v_add_u32 v7, s39, v22
    v_add_u32 v2, s39, v23
    s_mov_b32 s20, 0x3db8aa3b
    s_mov_b32 s28, 0
    v_mov_b32 v12, 0
    v_mov_b32 v13, 0
    v_mov_b32 v14, 0
    v_mov_b32 v15, 0
    s_nop 1
    v_mfma_f32_32x32x16_bf16 a[0:15], v[12:15], v[12:15], 0
    v_mfma_f32_32x32x16_bf16 a[16:31], v[12:15], v[12:15], 0
    v_mfma_f32_32x32x16_bf16 a[32:47], v[12:15], v[12:15], 0
    v_mfma_f32_32x32x16_bf16 a[48:63], v[12:15], v[12:15], 0
    v_mfma_f32_32x32x16_bf16 a[64:79], v[12:15], v[12:15], 0
    v_mfma_f32_32x32x16_bf16 a[80:95], v[12:15], v[12:15], 0
    v_mfma_f32_32x32x16_bf16 a[96:111], v[12:15], v[12:15], 0
    v_mfma_f32_32x32x16_bf16 a[112:127], v[12:15], v[12:15], 0
    v_mfma_f32_32x32x16_bf16 a[128:143], v[12:15], v[12:15], 0
    v_mfma_f32_32x32x16_bf16 a[144:159], v[12:15], v[12:15], 0
    v_mfma_f32_32x32x16_bf16 a[160:175], v[12:15], v[12:15], 0
    v_mfma_f32_32x32x16_bf16 a[176:191], v[12:15], v[12:15], 0
    v_mfma_f32_32x32x16_bf16 a[192:207], v[12:15], v[12:15], 0
    v_mfma_f32_32x32x16_bf16 a[208:223], v[12:15], v[12:15], 0
    v_mfma_f32_32x32x16_bf16 a[224:239], v[12:15], v[12:15], 0
    v_mfma_f32_32x32x16_bf16 a[240:255], v[12:15], v[12:15], 0
    s_getreg_b32 s33, hwreg(HW_REG_XCC_ID)
    s_and_b32 s33, s33, 1
    s_cbranch_scc1 L_odd
    s_add_u32 m0, s39, 2432
    s_nop 0
    buffer_load_dwordx4 v6, s[4:7], s88 offen offset:128 nt lds
    s_add_u32 m0, s39, 3456
    s_nop 0
    buffer_load_dwordx4 v6, s[4:7], s89 offen offset:128 nt lds
    s_waitcnt vmcnt(2)
    s_barrier
    ds_read_b128 v[128:131], v7 offset:512
    ds_read_b128 v[132:135], v2 offset:512
    ds_read_b128 v[32:35], v4 offset:0
    ds_read_b128 v[36:39], v4 offset:64
    ds_read_b128 v[40:43], v4 offset:512
    ds_read_b128 v[44:47], v4 offset:576
    ds_read_b128 v[48:51], v1 offset:0
    ds_read_b128 v[52:55], v1 offset:64
    ds_read_b128 v[56:59], v1 offset:512
    ds_read_b128 v[60:63], v1 offset:576
    s_add_u32 m0, s39, 4352
    s_nop 0
    buffer_load_dwordx4 v6, s[4:7], s88 offen offset:256 nt lds
    s_add_u32 m0, s39, 5376
    s_nop 0
    buffer_load_dwordx4 v6, s[4:7], s89 offen offset:256 nt lds
    s_waitcnt lgkmcnt(0)
    v_mfma_f32_16x16x32_bf16 v[64:67], v[32:35], v[128:131], 0
    v_mfma_f32_16x16x32_bf16 v[64:67], v[36:39], v[132:135], v[64:67]
    ds_read_b128 v[32:35], v4 offset:128
    v_mfma_f32_16x16x32_bf16 v[96:99], v[40:43], v[128:131], 0
    ds_read_b128 v[36:39], v4 offset:192
    v_mfma_f32_16x16x32_bf16 v[96:99], v[44:47], v[132:135], v[96:99]
    ds_read_b128 v[40:43], v4 offset:640
    v_mfma_f32_16x16x32_bf16 v[80:83], v[48:51], v[128:131], 0
    ds_read_b128 v[44:47], v4 offset:704
    v_mfma_f32_16x16x32_bf16 v[80:83], v[52:55], v[132:135], v[80:83]
    ds_read_b128 v[48:51], v1 offset:128
    v_mfma_f32_16x16x32_bf16 v[112:115], v[56:59], v[128:131], 0
    ds_read_b128 v[52:55], v1 offset:192
    v_mfma_f32_16x16x32_bf16 v[112:115], v[60:63], v[132:135], v[112:115]
    ds_read_b128 v[56:59], v1 offset:640
    s_nop 1
    ds_read_b128 v[60:63], v1 offset:704
    s_waitcnt vmcnt(2)
    ds_read_b128 v[136:139], v7 offset:2560
    ds_read_b128 v[140:143], v2 offset:2560
    s_add_u32 m0, s39, 6272
    s_nop 0
    buffer_load_dwordx4 v6, s[4:7], s88 offen offset:384 nt lds
    s_add_u32 m0, s39, 7296
    s_nop 0
    buffer_load_dwordx4 v6, s[4:7], s89 offen offset:384 nt lds
    v_lshlrev_b32 v8, 16, v128
    v_and_b32 v9, 0xffff0000, v128
    v_lshlrev_b32 v10, 16, v129
    v_and_b32 v11, 0xffff0000, v129
    v_mul_f32 v8, s20, v8
    v_mul_f32 v9, s20, v9
    v_mul_f32 v10, s20, v10
    v_mul_f32 v11, s20, v11
    v_cvt_pk_bf16_f32 v128, v8, v9
    v_cvt_pk_bf16_f32 v129, v10, v11
    v_lshlrev_b32 v8, 16, v130
    v_and_b32 v9, 0xffff0000, v130
    v_lshlrev_b32 v10, 16, v131
    v_and_b32 v11, 0xffff0000, v131
    v_mul_f32 v8, s20, v8
    v_mul_f32 v9, s20, v9
    v_mul_f32 v10, s20, v10
    v_mul_f32 v11, s20, v11
    v_cvt_pk_bf16_f32 v130, v8, v9
    v_cvt_pk_bf16_f32 v131, v10, v11
    v_lshlrev_b32 v8, 16, v132
    v_and_b32 v9, 0xffff0000, v132
    v_lshlrev_b32 v10, 16, v133
    v_and_b32 v11, 0xffff0000, v133
    v_mul_f32 v8, s20, v8
    v_mul_f32 v9, s20, v9
    v_mul_f32 v10, s20, v10
    v_mul_f32 v11, s20, v11
    v_cvt_pk_bf16_f32 v132, v8, v9
    v_cvt_pk_bf16_f32 v133, v10, v11
    v_lshlrev_b32 v8, 16, v134
    v_and_b32 v9, 0xffff0000, v134
    s_waitcnt lgkmcnt(0)
    v_mfma_f32_16x16x32_bf16 v[64:67], v[32:35], v[136:139], v[64:67]
    v_lshlrev_b32 v10, 16, v135
    v_mfma_f32_16x16x32_bf16 v[64:67], v[36:39], v[140:143], v[64:67]
    ds_read_b128 v[32:35], v4 offset:256
    v_and_b32 v11, 0xffff0000, v135
    v_mfma_f32_16x16x32_bf16 v[96:99], v[40:43], v[136:139], v[96:99]
    ds_read_b128 v[36:39], v4 offset:320
    v_mul_f32 v8, s20, v8
    v_mfma_f32_16x16x32_bf16 v[96:99], v[44:47], v[140:143], v[96:99]
    ds_read_b128 v[40:43], v4 offset:768
    v_mul_f32 v9, s20, v9
    v_mfma_f32_16x16x32_bf16 v[80:83], v[48:51], v[136:139], v[80:83]
    ds_read_b128 v[44:47], v4 offset:832
    v_mul_f32 v10, s20, v10
    v_mfma_f32_16x16x32_bf16 v[80:83], v[52:55], v[140:143], v[80:83]
    ds_read_b128 v[48:51], v1 offset:256
    v_mul_f32 v11, s20, v11
    v_mfma_f32_16x16x32_bf16 v[112:115], v[56:59], v[136:139], v[112:115]
    ds_read_b128 v[52:55], v1 offset:320
    v_cvt_pk_bf16_f32 v134, v8, v9
    v_mfma_f32_16x16x32_bf16 v[112:115], v[60:63], v[140:143], v[112:115]
    ds_read_b128 v[56:59], v1 offset:768
    v_cvt_pk_bf16_f32 v135, v10, v11
    s_nop 1
    ds_read_b128 v[60:63], v1 offset:832
    s_waitcnt vmcnt(2)
    ds_read_b128 v[144:147], v7 offset:4608
    ds_read_b128 v[148:151], v2 offset:4608
    s_add_u32 m0, s39, 8704
    s_nop 0
    buffer_load_dwordx4 v6, s[4:7], s90 offen offset:0 nt lds
    s_add_u32 m0, s39, 9728
    s_nop 0
    buffer_load_dwordx4 v6, s[4:7], s91 offen offset:0 nt lds
    v_lshlrev_b32 v8, 16, v136
    v_and_b32 v9, 0xffff0000, v136
    v_lshlrev_b32 v10, 16, v137
    v_and_b32 v11, 0xffff0000, v137
    v_mul_f32 v8, s20, v8
    v_mul_f32 v9, s20, v9
    v_mul_f32 v10, s20, v10
    v_mul_f32 v11, s20, v11
    v_cvt_pk_bf16_f32 v136, v8, v9
    v_cvt_pk_bf16_f32 v137, v10, v11
    v_lshlrev_b32 v8, 16, v138
    v_and_b32 v9, 0xffff0000, v138
    v_lshlrev_b32 v10, 16, v139
    v_and_b32 v11, 0xffff0000, v139
    v_mul_f32 v8, s20, v8
    v_mul_f32 v9, s20, v9
    v_mul_f32 v10, s20, v10
    v_mul_f32 v11, s20, v11
    v_cvt_pk_bf16_f32 v138, v8, v9
    v_cvt_pk_bf16_f32 v139, v10, v11
    v_lshlrev_b32 v8, 16, v140
    v_and_b32 v9, 0xffff0000, v140
    v_lshlrev_b32 v10, 16, v141
    v_and_b32 v11, 0xffff0000, v141
    v_mul_f32 v8, s20, v8
    v_mul_f32 v9, s20, v9
    v_mul_f32 v10, s20, v10
    v_mul_f32 v11, s20, v11
    v_cvt_pk_bf16_f32 v140, v8, v9
    v_cvt_pk_bf16_f32 v141, v10, v11
    v_lshlrev_b32 v8, 16, v142
    v_and_b32 v9, 0xffff0000, v142
    s_waitcnt lgkmcnt(0)
    v_mfma_f32_16x16x32_bf16 v[64:67], v[32:35], v[144:147], v[64:67]
    v_lshlrev_b32 v10, 16, v143
    v_mfma_f32_16x16x32_bf16 v[64:67], v[36:39], v[148:151], v[64:67]
    ds_read_b128 v[32:35], v4 offset:384
    v_and_b32 v11, 0xffff0000, v143
    v_mfma_f32_16x16x32_bf16 v[96:99], v[40:43], v[144:147], v[96:99]
    ds_read_b128 v[36:39], v4 offset:448
    v_mul_f32 v8, s20, v8
    v_mfma_f32_16x16x32_bf16 v[96:99], v[44:47], v[148:151], v[96:99]
    ds_read_b128 v[40:43], v4 offset:896
    v_mul_f32 v9, s20, v9
    v_mfma_f32_16x16x32_bf16 v[80:83], v[48:51], v[144:147], v[80:83]
    ds_read_b128 v[44:47], v4 offset:960
    v_mul_f32 v10, s20, v10
    v_mfma_f32_16x16x32_bf16 v[80:83], v[52:55], v[148:151], v[80:83]
    ds_read_b128 v[48:51], v1 offset:384
    v_mul_f32 v11, s20, v11
    v_mfma_f32_16x16x32_bf16 v[112:115], v[56:59], v[144:147], v[112:115]
    ds_read_b128 v[52:55], v1 offset:448
    v_cvt_pk_bf16_f32 v142, v8, v9
    v_mfma_f32_16x16x32_bf16 v[112:115], v[60:63], v[148:151], v[112:115]
    ds_read_b128 v[56:59], v1 offset:896
    v_cvt_pk_bf16_f32 v143, v10, v11
    s_nop 1
    ds_read_b128 v[60:63], v1 offset:960
    s_waitcnt vmcnt(2)
    ds_read_b128 v[152:155], v7 offset:6656
    ds_read_b128 v[156:159], v2 offset:6656
    s_add_u32 m0, s39, 10624
    s_nop 0
    buffer_load_dwordx4 v6, s[4:7], s90 offen offset:128 nt lds
    s_add_u32 m0, s39, 11648
    s_nop 0
    buffer_load_dwordx4 v6, s[4:7], s91 offen offset:128 nt lds
    v_lshlrev_b32 v8, 16, v144
    v_and_b32 v9, 0xffff0000, v144
    v_lshlrev_b32 v10, 16, v145
    v_and_b32 v11, 0xffff0000, v145
    v_mul_f32 v8, s20, v8
    v_mul_f32 v9, s20, v9
    v_mul_f32 v10, s20, v10
    v_mul_f32 v11, s20, v11
    v_cvt_pk_bf16_f32 v144, v8, v9
    v_cvt_pk_bf16_f32 v145, v10, v11
    v_lshlrev_b32 v8, 16, v146
    v_and_b32 v9, 0xffff0000, v146
    v_lshlrev_b32 v10, 16, v147
    v_and_b32 v11, 0xffff0000, v147
    v_mul_f32 v8, s20, v8
    v_mul_f32 v9, s20, v9
    v_mul_f32 v10, s20, v10
    v_mul_f32 v11, s20, v11
    v_cvt_pk_bf16_f32 v146, v8, v9
    v_cvt_pk_bf16_f32 v147, v10, v11
    v_lshlrev_b32 v8, 16, v148
    v_and_b32 v9, 0xffff0000, v148
    v_lshlrev_b32 v10, 16, v149
    v_and_b32 v11, 0xffff0000, v149
    v_mul_f32 v8, s20, v8
    v_mul_f32 v9, s20, v9
    v_mul_f32 v10, s20, v10
    v_mul_f32 v11, s20, v11
    v_cvt_pk_bf16_f32 v148, v8, v9
    v_cvt_pk_bf16_f32 v149, v10, v11
    v_lshlrev_b32 v8, 16, v150
    v_and_b32 v9, 0xffff0000, v150
    s_waitcnt lgkmcnt(0)
    v_mfma_f32_16x16x32_bf16 v[64:67], v[32:35], v[152:155], v[64:67]
    v_lshlrev_b32 v10, 16, v151
    v_mfma_f32_16x16x32_bf16 v[64:67], v[36:39], v[156:159], v[64:67]
    ds_read_b128 v[32:35], v4 offset:0
    v_and_b32 v11, 0xffff0000, v151
    v_mfma_f32_16x16x32_bf16 v[96:99], v[40:43], v[152:155], v[96:99]
    ds_read_b128 v[36:39], v4 offset:64
    v_mul_f32 v8, s20, v8
    v_mfma_f32_16x16x32_bf16 v[96:99], v[44:47], v[156:159], v[96:99]
    ds_read_b128 v[40:43], v4 offset:512
    v_mul_f32 v9, s20, v9
    v_mfma_f32_16x16x32_bf16 v[80:83], v[48:51], v[152:155], v[80:83]
    ds_read_b128 v[44:47], v4 offset:576
    v_mul_f32 v10, s20, v10
    v_mfma_f32_16x16x32_bf16 v[80:83], v[52:55], v[156:159], v[80:83]
    ds_read_b128 v[48:51], v1 offset:0
    v_mul_f32 v11, s20, v11
    v_mfma_f32_16x16x32_bf16 v[112:115], v[56:59], v[152:155], v[112:115]
    ds_read_b128 v[52:55], v1 offset:64
    v_cvt_pk_bf16_f32 v150, v8, v9
    v_mfma_f32_16x16x32_bf16 v[112:115], v[60:63], v[156:159], v[112:115]
    ds_read_b128 v[56:59], v1 offset:512
    v_cvt_pk_bf16_f32 v151, v10, v11
    s_nop 1
    ds_read_b128 v[60:63], v1 offset:576
    s_waitcnt vmcnt(2)
    ds_read_b128 v[160:163], v7 offset:8704
    ds_read_b128 v[164:167], v2 offset:8704
    s_add_u32 m0, s39, 12544
    s_nop 0
    buffer_load_dwordx4 v6, s[4:7], s90 offen offset:256 nt lds
    s_add_u32 m0, s39, 13568
    s_nop 0
    buffer_load_dwordx4 v6, s[4:7], s91 offen offset:256 nt lds
    v_lshlrev_b32 v8, 16, v152
    v_and_b32 v9, 0xffff0000, v152
    v_lshlrev_b32 v10, 16, v153
    v_and_b32 v11, 0xffff0000, v153
    v_mul_f32 v8, s20, v8
    v_mul_f32 v9, s20, v9
    v_mul_f32 v10, s20, v10
    v_mul_f32 v11, s20, v11
    v_cvt_pk_bf16_f32 v152, v8, v9
    v_cvt_pk_bf16_f32 v153, v10, v11
    v_lshlrev_b32 v8, 16, v154
    v_and_b32 v9, 0xffff0000, v154
    v_lshlrev_b32 v10, 16, v155
    v_and_b32 v11, 0xffff0000, v155
    v_mul_f32 v8, s20, v8
    v_mul_f32 v9, s20, v9
    v_mul_f32 v10, s20, v10
    v_mul_f32 v11, s20, v11
    v_cvt_pk_bf16_f32 v154, v8, v9
    v_cvt_pk_bf16_f32 v155, v10, v11
    v_lshlrev_b32 v8, 16, v156
    v_and_b32 v9, 0xffff0000, v156
    v_lshlrev_b32 v10, 16, v157
    v_and_b32 v11, 0xffff0000, v157
    v_mul_f32 v8, s20, v8
    v_mul_f32 v9, s20, v9
    v_mul_f32 v10, s20, v10
    v_mul_f32 v11, s20, v11
    v_cvt_pk_bf16_f32 v156, v8, v9
    v_cvt_pk_bf16_f32 v157, v10, v11
    v_lshlrev_b32 v8, 16, v158
    v_and_b32 v9, 0xffff0000, v158
    v_lshlrev_b32 v10, 16, v159
    v_and_b32 v11, 0xffff0000, v159
    v_mul_f32 v8, s20, v8
    v_mul_f32 v9, s20, v9
    v_mul_f32 v10, s20, v10
    v_mul_f32 v11, s20, v11
    v_cvt_pk_bf16_f32 v158, v8, v9
    v_cvt_pk_bf16_f32 v159, v10, v11
    v_max3_f32 v8, v64, v65, v66
    v_max3_f32 v8, v8, v67, v96
    v_max3_f32 v8, v8, v97, v98
    v_max3_f32 v8, v8, v99, v80
    v_max3_f32 v8, v8, v81, v82
    v_max3_f32 v8, v8, v83, v112
    v_max3_f32 v8, v8, v113, v114
    v_max_f32 v8, v8, v115
    v_mov_b32 v9, v8
    s_nop 1
    v_permlane16_swap_b32 v8, v9
    v_max_f32 v8, v8, v9
    v_mov_b32 v9, v8
    s_nop 1
    v_permlane32_swap_b32 v8, v9
    v_max_f32 v8, v8, v9
    v_mul_f32 v16, -v8, s20
    v_fma_f32 v64, v64, s20, v16
    v_fma_f32 v65, v65, s20, v16
    v_fma_f32 v66, v66, s20, v16
    v_fma_f32 v67, v67, s20, v16
    v_fma_f32 v96, v96, s20, v16
    v_fma_f32 v97, v97, s20, v16
    v_fma_f32 v98, v98, s20, v16
    v_fma_f32 v99, v99, s20, v16
    v_fma_f32 v80, v80, s20, v16
    v_fma_f32 v81, v81, s20, v16
    v_fma_f32 v82, v82, s20, v16
    s_waitcnt lgkmcnt(0)
    v_mfma_f32_16x16x32_bf16 v[68:71], v[32:35], v[160:163], 0
    v_fma_f32 v83, v83, s20, v16
    v_mfma_f32_16x16x32_bf16 v[68:71], v[36:39], v[164:167], v[68:71]
    ds_read_b128 v[32:35], v4 offset:128
    v_fma_f32 v112, v112, s20, v16
    v_mfma_f32_16x16x32_bf16 v[100:103], v[40:43], v[160:163], 0
    ds_read_b128 v[36:39], v4 offset:192
    v_fma_f32 v113, v113, s20, v16
    v_mfma_f32_16x16x32_bf16 v[100:103], v[44:47], v[164:167], v[100:103]
    ds_read_b128 v[40:43], v4 offset:640
    v_fma_f32 v114, v114, s20, v16
    v_mfma_f32_16x16x32_bf16 v[84:87], v[48:51], v[160:163], 0
    ds_read_b128 v[44:47], v4 offset:704
    v_fma_f32 v115, v115, s20, v16
    v_mfma_f32_16x16x32_bf16 v[84:87], v[52:55], v[164:167], v[84:87]
    ds_read_b128 v[48:51], v1 offset:128
    v_mov_b32 v17, v16
    v_mfma_f32_16x16x32_bf16 v[116:119], v[56:59], v[160:163], 0
    ds_read_b128 v[52:55], v1 offset:192
    v_mov_b32 v18, v16
    v_mfma_f32_16x16x32_bf16 v[116:119], v[60:63], v[164:167], v[116:119]
    ds_read_b128 v[56:59], v1 offset:640
    v_mov_b32 v19, v16
    s_nop 1
    ds_read_b128 v[60:63], v1 offset:704
    s_waitcnt vmcnt(2)
    ds_read_b128 v[168:171], v7 offset:10752
    ds_read_b128 v[172:175], v2 offset:10752
    s_add_u32 m0, s39, 14464
    s_nop 0
    buffer_load_dwordx4 v6, s[4:7], s90 offen offset:384 nt lds
    s_add_u32 m0, s39, 15488
    s_nop 0
    buffer_load_dwordx4 v6, s[4:7], s91 offen offset:384 nt lds
    v_lshlrev_b32 v8, 16, v160
    v_and_b32 v9, 0xffff0000, v160
    v_lshlrev_b32 v10, 16, v161
    v_and_b32 v11, 0xffff0000, v161
    v_mul_f32 v8, s20, v8
    v_mul_f32 v9, s20, v9
    v_mul_f32 v10, s20, v10
    v_mul_f32 v11, s20, v11
    v_cvt_pk_bf16_f32 v160, v8, v9
    v_cvt_pk_bf16_f32 v161, v10, v11
    v_lshlrev_b32 v8, 16, v162
    v_and_b32 v9, 0xffff0000, v162
    v_lshlrev_b32 v10, 16, v163
    v_and_b32 v11, 0xffff0000, v163
    v_mul_f32 v8, s20, v8
    v_mul_f32 v9, s20, v9
    v_mul_f32 v10, s20, v10
    v_mul_f32 v11, s20, v11
    v_cvt_pk_bf16_f32 v162, v8, v9
    v_cvt_pk_bf16_f32 v163, v10, v11
    v_lshlrev_b32 v8, 16, v164
    v_and_b32 v9, 0xffff0000, v164
    v_lshlrev_b32 v10, 16, v165
    v_and_b32 v11, 0xffff0000, v165
    v_mul_f32 v8, s20, v8
    v_mul_f32 v9, s20, v9
    v_mul_f32 v10, s20, v10
    v_mul_f32 v11, s20, v11
    v_cvt_pk_bf16_f32 v164, v8, v9
    v_cvt_pk_bf16_f32 v165, v10, v11
    v_lshlrev_b32 v8, 16, v166
    v_and_b32 v9, 0xffff0000, v166
    v_lshlrev_b32 v10, 16, v167
    v_and_b32 v11, 0xffff0000, v167
    v_mul_f32 v8, s20, v8
    v_mul_f32 v9, s20, v9
    v_mul_f32 v10, s20, v10
    v_mul_f32 v11, s20, v11
    v_cvt_pk_bf16_f32 v166, v8, v9
    v_cvt_pk_bf16_f32 v167, v10, v11
    v_exp_f32 v64, v64
    v_exp_f32 v65, v65
    v_exp_f32 v66, v66
    v_exp_f32 v67, v67
    v_exp_f32 v96, v96
    v_exp_f32 v97, v97
    v_exp_f32 v98, v98
    v_exp_f32 v99, v99
    s_nop 0
    v_add_f32 v12, v12, v64
    v_add_f32 v12, v12, v65
    v_cvt_pk_bf16_f32 v64, v64, v65
    v_add_f32 v12, v12, v66
    s_waitcnt lgkmcnt(0)
    v_mfma_f32_16x16x32_bf16 v[68:71], v[32:35], v[168:171], v[68:71]
    v_add_f32 v12, v12, v67
    v_mfma_f32_16x16x32_bf16 v[68:71], v[36:39], v[172:175], v[68:71]
    ds_read_b128 v[32:35], v4 offset:256
    v_cvt_pk_bf16_f32 v65, v66, v67
    v_mfma_f32_16x16x32_bf16 v[100:103], v[40:43], v[168:171], v[100:103]
    ds_read_b128 v[36:39], v4 offset:320
    v_add_f32 v12, v12, v96
    v_mfma_f32_16x16x32_bf16 v[100:103], v[44:47], v[172:175], v[100:103]
    ds_read_b128 v[40:43], v4 offset:768
    v_cvt_pk_bf16_f32 v66, v96, v97
    v_mfma_f32_16x16x32_bf16 v[84:87], v[48:51], v[168:171], v[84:87]
    ds_read_b128 v[44:47], v4 offset:832
    v_add_f32 v12, v12, v97
    v_mfma_f32_16x16x32_bf16 v[84:87], v[52:55], v[172:175], v[84:87]
    ds_read_b128 v[48:51], v1 offset:256
    v_add_f32 v12, v12, v98
    v_mfma_f32_16x16x32_bf16 v[116:119], v[56:59], v[168:171], v[116:119]
    ds_read_b128 v[52:55], v1 offset:320
    v_cvt_pk_bf16_f32 v67, v98, v99
    v_mfma_f32_16x16x32_bf16 v[116:119], v[60:63], v[172:175], v[116:119]
    ds_read_b128 v[56:59], v1 offset:768
    v_add_f32 v12, v12, v99
    s_nop 1
    ds_read_b128 v[60:63], v1 offset:832
    s_waitcnt vmcnt(2)
    ds_read_b128 v[176:179], v7 offset:12800
    ds_read_b128 v[180:183], v2 offset:12800
    s_add_u32 m0, s39, 512
    s_nop 0
    buffer_load_dwordx4 v6, s[4:7], s92 offen offset:0 nt lds
    s_add_u32 m0, s39, 1536
    s_nop 0
    buffer_load_dwordx4 v6, s[4:7], s93 offen offset:0 nt lds
    v_lshlrev_b32 v8, 16, v168
    v_and_b32 v9, 0xffff0000, v168
    v_lshlrev_b32 v10, 16, v169
    v_and_b32 v11, 0xffff0000, v169
    v_mul_f32 v8, s20, v8
    v_mul_f32 v9, s20, v9
    v_mul_f32 v10, s20, v10
    v_mul_f32 v11, s20, v11
    v_cvt_pk_bf16_f32 v168, v8, v9
    v_cvt_pk_bf16_f32 v169, v10, v11
    v_lshlrev_b32 v8, 16, v170
    v_and_b32 v9, 0xffff0000, v170
    v_lshlrev_b32 v10, 16, v171
    v_and_b32 v11, 0xffff0000, v171
    v_mul_f32 v8, s20, v8
    v_mul_f32 v9, s20, v9
    v_mul_f32 v10, s20, v10
    v_mul_f32 v11, s20, v11
    v_cvt_pk_bf16_f32 v170, v8, v9
    v_cvt_pk_bf16_f32 v171, v10, v11
    v_lshlrev_b32 v8, 16, v172
    v_and_b32 v9, 0xffff0000, v172
    v_lshlrev_b32 v10, 16, v173
    v_and_b32 v11, 0xffff0000, v173
    v_mul_f32 v8, s20, v8
    v_mul_f32 v9, s20, v9
    v_mul_f32 v10, s20, v10
    v_mul_f32 v11, s20, v11
    v_cvt_pk_bf16_f32 v172, v8, v9
    v_cvt_pk_bf16_f32 v173, v10, v11
    v_lshlrev_b32 v8, 16, v174
    v_and_b32 v9, 0xffff0000, v174
    v_lshlrev_b32 v10, 16, v175
    v_and_b32 v11, 0xffff0000, v175
    v_mul_f32 v8, s20, v8
    v_mul_f32 v9, s20, v9
    v_mul_f32 v10, s20, v10
    v_mul_f32 v11, s20, v11
    v_cvt_pk_bf16_f32 v174, v8, v9
    v_cvt_pk_bf16_f32 v175, v10, v11
    v_exp_f32 v80, v80
    v_exp_f32 v81, v81
    v_exp_f32 v82, v82
    v_exp_f32 v83, v83
    v_exp_f32 v112, v112
    v_exp_f32 v113, v113
    v_exp_f32 v114, v114
    v_exp_f32 v115, v115
    s_nop 0
    v_add_f32 v12, v12, v80
    v_add_f32 v12, v12, v81
    v_cvt_pk_bf16_f32 v80, v80, v81
    v_add_f32 v12, v12, v82
    s_waitcnt lgkmcnt(0)
    v_mfma_f32_16x16x32_bf16 v[68:71], v[32:35], v[176:179], v[68:71]
    v_add_f32 v12, v12, v83
    v_mfma_f32_16x16x32_bf16 v[68:71], v[36:39], v[180:183], v[68:71]
    ds_read_b128 v[32:35], v4 offset:384
    v_cvt_pk_bf16_f32 v81, v82, v83
    v_mfma_f32_16x16x32_bf16 v[100:103], v[40:43], v[176:179], v[100:103]
    ds_read_b128 v[36:39], v4 offset:448
    v_add_f32 v12, v12, v112
    v_mfma_f32_16x16x32_bf16 v[100:103], v[44:47], v[180:183], v[100:103]
    ds_read_b128 v[40:43], v4 offset:896
    v_cvt_pk_bf16_f32 v82, v112, v113
    v_mfma_f32_16x16x32_bf16 v[84:87], v[48:51], v[176:179], v[84:87]
    ds_read_b128 v[44:47], v4 offset:960
    v_add_f32 v12, v12, v113
    v_mfma_f32_16x16x32_bf16 v[84:87], v[52:55], v[180:183], v[84:87]
    ds_read_b128 v[48:51], v1 offset:384
    v_add_f32 v12, v12, v114
    v_mfma_f32_16x16x32_bf16 v[116:119], v[56:59], v[176:179], v[116:119]
    ds_read_b128 v[52:55], v1 offset:448
    v_cvt_pk_bf16_f32 v83, v114, v115
    v_mfma_f32_16x16x32_bf16 v[116:119], v[60:63], v[180:183], v[116:119]
    ds_read_b128 v[56:59], v1 offset:896
    v_add_f32 v12, v12, v115
    s_nop 1
    ds_read_b128 v[60:63], v1 offset:960
    s_waitcnt vmcnt(2)
    ds_read_b128 v[184:187], v7 offset:14848
    ds_read_b128 v[188:191], v2 offset:14848
    s_add_u32 m0, s39, 2432
    s_nop 0
    buffer_load_dwordx4 v6, s[4:7], s92 offen offset:128 nt lds
    s_add_u32 m0, s39, 3456
    s_nop 0
    buffer_load_dwordx4 v6, s[4:7], s93 offen offset:128 nt lds
    v_lshlrev_b32 v8, 16, v176
    v_and_b32 v9, 0xffff0000, v176
    v_lshlrev_b32 v10, 16, v177
    v_and_b32 v11, 0xffff0000, v177
    v_mul_f32 v8, s20, v8
    v_mul_f32 v9, s20, v9
    v_mul_f32 v10, s20, v10
    v_mul_f32 v11, s20, v11
    v_cvt_pk_bf16_f32 v176, v8, v9
    v_cvt_pk_bf16_f32 v177, v10, v11
    v_lshlrev_b32 v8, 16, v178
    v_and_b32 v9, 0xffff0000, v178
    v_lshlrev_b32 v10, 16, v179
    v_and_b32 v11, 0xffff0000, v179
    v_mul_f32 v8, s20, v8
    v_mul_f32 v9, s20, v9
    v_mul_f32 v10, s20, v10
    v_mul_f32 v11, s20, v11
    v_cvt_pk_bf16_f32 v178, v8, v9
    v_cvt_pk_bf16_f32 v179, v10, v11
    v_lshlrev_b32 v8, 16, v180
    v_and_b32 v9, 0xffff0000, v180
    v_lshlrev_b32 v10, 16, v181
    v_and_b32 v11, 0xffff0000, v181
    v_mul_f32 v8, s20, v8
    v_mul_f32 v9, s20, v9
    v_mul_f32 v10, s20, v10
    v_mul_f32 v11, s20, v11
    v_cvt_pk_bf16_f32 v180, v8, v9
    v_cvt_pk_bf16_f32 v181, v10, v11
    v_lshlrev_b32 v8, 16, v182
    v_and_b32 v9, 0xffff0000, v182
    s_waitcnt lgkmcnt(0)
    v_mfma_f32_16x16x32_bf16 v[68:71], v[32:35], v[184:187], v[68:71]
    v_lshlrev_b32 v10, 16, v183
    v_mfma_f32_16x16x32_bf16 v[68:71], v[36:39], v[188:191], v[68:71]
    ds_read_b128 v[32:35], v4 offset:0
    v_and_b32 v11, 0xffff0000, v183
    v_mfma_f32_16x16x32_bf16 v[100:103], v[40:43], v[184:187], v[100:103]
    ds_read_b128 v[36:39], v4 offset:64
    v_mul_f32 v8, s20, v8
    v_mfma_f32_16x16x32_bf16 v[100:103], v[44:47], v[188:191], v[100:103]
    ds_read_b128 v[40:43], v4 offset:512
    v_mul_f32 v9, s20, v9
    v_mfma_f32_16x16x32_bf16 v[84:87], v[48:51], v[184:187], v[84:87]
    ds_read_b128 v[44:47], v4 offset:576
    v_mul_f32 v10, s20, v10
    v_mfma_f32_16x16x32_bf16 v[84:87], v[52:55], v[188:191], v[84:87]
    ds_read_b128 v[48:51], v1 offset:0
    v_mul_f32 v11, s20, v11
    v_mfma_f32_16x16x32_bf16 v[116:119], v[56:59], v[184:187], v[116:119]
    ds_read_b128 v[52:55], v1 offset:64
    v_cvt_pk_bf16_f32 v182, v8, v9
    v_mfma_f32_16x16x32_bf16 v[116:119], v[60:63], v[188:191], v[116:119]
    ds_read_b128 v[56:59], v1 offset:512
    v_cvt_pk_bf16_f32 v183, v10, v11
    s_nop 1
    ds_read_b128 v[60:63], v1 offset:576
    s_waitcnt vmcnt(2)
    ds_read_b128 v[192:195], v7 offset:512
    ds_read_b128 v[196:199], v2 offset:512
    s_add_u32 m0, s39, 4352
    s_nop 0
    buffer_load_dwordx4 v6, s[4:7], s92 offen offset:256 nt lds
    s_add_u32 m0, s39, 5376
    s_nop 0
    buffer_load_dwordx4 v6, s[4:7], s93 offen offset:256 nt lds
    v_lshlrev_b32 v8, 16, v184
    v_and_b32 v9, 0xffff0000, v184
    v_lshlrev_b32 v10, 16, v185
    v_and_b32 v11, 0xffff0000, v185
    v_mul_f32 v8, s20, v8
    v_mul_f32 v9, s20, v9
    v_mul_f32 v10, s20, v10
    v_mul_f32 v11, s20, v11
    v_cvt_pk_bf16_f32 v184, v8, v9
    v_cvt_pk_bf16_f32 v185, v10, v11
    v_lshlrev_b32 v8, 16, v186
    v_and_b32 v9, 0xffff0000, v186
    v_lshlrev_b32 v10, 16, v187
    v_and_b32 v11, 0xffff0000, v187
    v_mul_f32 v8, s20, v8
    v_mul_f32 v9, s20, v9
    v_mul_f32 v10, s20, v10
    v_mul_f32 v11, s20, v11
    v_cvt_pk_bf16_f32 v186, v8, v9
    v_cvt_pk_bf16_f32 v187, v10, v11
    v_lshlrev_b32 v8, 16, v188
    v_and_b32 v9, 0xffff0000, v188
    v_lshlrev_b32 v10, 16, v189
    v_and_b32 v11, 0xffff0000, v189
    v_mul_f32 v8, s20, v8
    v_mul_f32 v9, s20, v9
    v_mul_f32 v10, s20, v10
    v_mul_f32 v11, s20, v11
    v_cvt_pk_bf16_f32 v188, v8, v9
    v_cvt_pk_bf16_f32 v189, v10, v11
    v_lshlrev_b32 v8, 16, v190
    v_and_b32 v9, 0xffff0000, v190
    v_lshlrev_b32 v10, 16, v191
    v_and_b32 v11, 0xffff0000, v191
    v_mul_f32 v8, s20, v8
    v_mul_f32 v9, s20, v9
    v_mul_f32 v10, s20, v10
    v_mul_f32 v11, s20, v11
    v_cvt_pk_bf16_f32 v190, v8, v9
    v_cvt_pk_bf16_f32 v191, v10, v11
    v_max3_f32 v8, v68, v69, v70
    v_max3_f32 v8, v8, v71, v100
    v_max3_f32 v8, v8, v101, v102
    v_max3_f32 v8, v8, v103, v84
    v_max3_f32 v8, v8, v85, v86
    v_max3_f32 v8, v8, v87, v116
    v_max3_f32 v8, v8, v117, v118
    v_max_f32 v8, v8, v119
    v_mov_b32 v9, v8
    s_nop 1
    v_permlane16_swap_b32 v8, v9
    v_max_f32 v8, v8, v9
    v_mov_b32 v9, v8
    s_nop 1
    v_permlane32_swap_b32 v8, v9
    v_max_f32 v8, v8, v9
    v_mul_f32 v20, -v8, s20
    v_fma_f32 v68, v68, s20, v20
    v_fma_f32 v69, v69, s20, v20
    v_fma_f32 v70, v70, s20, v20
    v_fma_f32 v71, v71, s20, v20
    v_fma_f32 v100, v100, s20, v20
    v_fma_f32 v101, v101, s20, v20
    v_fma_f32 v102, v102, s20, v20
    v_fma_f32 v103, v103, s20, v20
    v_fma_f32 v84, v84, s20, v20
    v_fma_f32 v85, v85, s20, v20
    v_fma_f32 v86, v86, s20, v20
    s_waitcnt lgkmcnt(0)
    v_mfma_f32_16x16x32_bf16 v[72:75], v[32:35], v[192:195], 0
    v_fma_f32 v87, v87, s20, v20
    v_mfma_f32_16x16x32_bf16 v[72:75], v[36:39], v[196:199], v[72:75]
    ds_read_b128 v[32:35], v4 offset:128
    v_fma_f32 v116, v116, s20, v20
    v_mfma_f32_16x16x32_bf16 v[104:107], v[40:43], v[192:195], 0
    ds_read_b128 v[36:39], v4 offset:192
    v_fma_f32 v117, v117, s20, v20
    v_mfma_f32_16x16x32_bf16 v[104:107], v[44:47], v[196:199], v[104:107]
    ds_read_b128 v[40:43], v4 offset:640
    v_fma_f32 v118, v118, s20, v20
    v_mfma_f32_16x16x32_bf16 v[88:91], v[48:51], v[192:195], 0
    ds_read_b128 v[44:47], v4 offset:704
    v_fma_f32 v119, v119, s20, v20
    v_mfma_f32_16x16x32_bf16 v[88:91], v[52:55], v[196:199], v[88:91]
    ds_read_b128 v[48:51], v1 offset:128
    v_mov_b32 v21, v20
    v_mfma_f32_16x16x32_bf16 v[120:123], v[56:59], v[192:195], 0
    ds_read_b128 v[52:55], v1 offset:192
    v_mov_b32 v22, v20
    v_mfma_f32_16x16x32_bf16 v[120:123], v[60:63], v[196:199], v[120:123]
    ds_read_b128 v[56:59], v1 offset:640
    v_mov_b32 v23, v20
    s_nop 1
    ds_read_b128 v[60:63], v1 offset:704
    s_waitcnt vmcnt(2)
    ds_read_b128 v[200:203], v7 offset:2560
    ds_read_b128 v[204:207], v2 offset:2560
    s_add_u32 m0, s39, 6272
    s_nop 0
    buffer_load_dwordx4 v6, s[4:7], s92 offen offset:384 nt lds
    s_add_u32 m0, s39, 7296
    s_nop 0
    buffer_load_dwordx4 v6, s[4:7], s93 offen offset:384 nt lds
    s_add_u32 m0, s39, 8704
    s_nop 0
    buffer_load_dwordx4 v6, s[4:7], s94 offen offset:0 nt lds
    s_add_u32 m0, s39, 9728
    s_nop 0
    buffer_load_dwordx4 v6, s[4:7], s95 offen offset:0 nt lds
    v_lshlrev_b32 v8, 16, v192
    v_and_b32 v9, 0xffff0000, v192
    v_lshlrev_b32 v10, 16, v193
    v_and_b32 v11, 0xffff0000, v193
    v_mul_f32 v8, s20, v8
    v_mul_f32 v9, s20, v9
    v_mul_f32 v10, s20, v10
    v_mul_f32 v11, s20, v11
    v_cvt_pk_bf16_f32 v192, v8, v9
    v_cvt_pk_bf16_f32 v193, v10, v11
    v_lshlrev_b32 v8, 16, v194
    v_and_b32 v9, 0xffff0000, v194
    v_lshlrev_b32 v10, 16, v195
    v_and_b32 v11, 0xffff0000, v195
    v_mul_f32 v8, s20, v8
    v_mul_f32 v9, s20, v9
    v_mul_f32 v10, s20, v10
    v_mul_f32 v11, s20, v11
    v_cvt_pk_bf16_f32 v194, v8, v9
    v_cvt_pk_bf16_f32 v195, v10, v11
    v_lshlrev_b32 v8, 16, v196
    v_and_b32 v9, 0xffff0000, v196
    v_lshlrev_b32 v10, 16, v197
    v_and_b32 v11, 0xffff0000, v197
    v_mul_f32 v8, s20, v8
    v_mul_f32 v9, s20, v9
    v_mul_f32 v10, s20, v10
    v_mul_f32 v11, s20, v11
    v_cvt_pk_bf16_f32 v196, v8, v9
    v_cvt_pk_bf16_f32 v197, v10, v11
    v_lshlrev_b32 v8, 16, v198
    v_and_b32 v9, 0xffff0000, v198
    v_lshlrev_b32 v10, 16, v199
    v_and_b32 v11, 0xffff0000, v199
    v_mul_f32 v8, s20, v8
    v_mul_f32 v9, s20, v9
    v_mul_f32 v10, s20, v10
    v_mul_f32 v11, s20, v11
    v_cvt_pk_bf16_f32 v198, v8, v9
    v_cvt_pk_bf16_f32 v199, v10, v11
    v_exp_f32 v68, v68
    v_exp_f32 v69, v69
    v_exp_f32 v70, v70
    v_exp_f32 v71, v71
    v_exp_f32 v100, v100
    v_exp_f32 v101, v101
    v_exp_f32 v102, v102
    v_exp_f32 v103, v103
    s_nop 0
    v_add_f32 v13, v13, v68
    v_add_f32 v13, v13, v69
    v_cvt_pk_bf16_f32 v68, v68, v69
    v_add_f32 v13, v13, v70
    s_waitcnt lgkmcnt(0)
    v_mfma_f32_16x16x32_bf16 v[72:75], v[32:35], v[200:203], v[72:75]
    v_add_f32 v13, v13, v71
    v_mfma_f32_16x16x32_bf16 v[72:75], v[36:39], v[204:207], v[72:75]
    ds_read_b128 v[32:35], v4 offset:256
    v_cvt_pk_bf16_f32 v69, v70, v71
    v_mfma_f32_16x16x32_bf16 v[104:107], v[40:43], v[200:203], v[104:107]
    ds_read_b128 v[36:39], v4 offset:320
    v_add_f32 v13, v13, v100
    v_mfma_f32_16x16x32_bf16 v[104:107], v[44:47], v[204:207], v[104:107]
    ds_read_b128 v[40:43], v4 offset:768
    v_cvt_pk_bf16_f32 v70, v100, v101
    v_mfma_f32_16x16x32_bf16 v[88:91], v[48:51], v[200:203], v[88:91]
    ds_read_b128 v[44:47], v4 offset:832
    v_add_f32 v13, v13, v101
    v_mfma_f32_16x16x32_bf16 v[88:91], v[52:55], v[204:207], v[88:91]
    ds_read_b128 v[48:51], v1 offset:256
    v_add_f32 v13, v13, v102
    v_mfma_f32_16x16x32_bf16 v[120:123], v[56:59], v[200:203], v[120:123]
    ds_read_b128 v[52:55], v1 offset:320
    v_cvt_pk_bf16_f32 v71, v102, v103
    v_mfma_f32_16x16x32_bf16 v[120:123], v[60:63], v[204:207], v[120:123]
    ds_read_b128 v[56:59], v1 offset:768
    v_add_f32 v13, v13, v103
    s_nop 1
    ds_read_b128 v[60:63], v1 offset:832
    s_waitcnt vmcnt(4)
    ds_read_b128 v[208:211], v7 offset:4608
    ds_read_b128 v[212:215], v2 offset:4608
    s_add_u32 m0, s39, 10624
    s_nop 0
    buffer_load_dwordx4 v6, s[4:7], s94 offen offset:128 nt lds
    s_add_u32 m0, s39, 11648
    s_nop 0
    buffer_load_dwordx4 v6, s[4:7], s95 offen offset:128 nt lds
    s_add_u32 m0, s39, 12544
    s_nop 0
    buffer_load_dwordx4 v6, s[4:7], s94 offen offset:256 nt lds
    s_add_u32 m0, s39, 13568
    s_nop 0
    buffer_load_dwordx4 v6, s[4:7], s95 offen offset:256 nt lds
    v_lshlrev_b32 v8, 16, v200
    v_and_b32 v9, 0xffff0000, v200
    v_lshlrev_b32 v10, 16, v201
    v_and_b32 v11, 0xffff0000, v201
    v_mul_f32 v8, s20, v8
    v_mul_f32 v9, s20, v9
    v_mul_f32 v10, s20, v10
    v_mul_f32 v11, s20, v11
    v_cvt_pk_bf16_f32 v200, v8, v9
    v_cvt_pk_bf16_f32 v201, v10, v11
    v_lshlrev_b32 v8, 16, v202
    v_and_b32 v9, 0xffff0000, v202
    v_lshlrev_b32 v10, 16, v203
    v_and_b32 v11, 0xffff0000, v203
    v_mul_f32 v8, s20, v8
    v_mul_f32 v9, s20, v9
    v_mul_f32 v10, s20, v10
    v_mul_f32 v11, s20, v11
    v_cvt_pk_bf16_f32 v202, v8, v9
    v_cvt_pk_bf16_f32 v203, v10, v11
    v_lshlrev_b32 v8, 16, v204
    v_and_b32 v9, 0xffff0000, v204
    v_lshlrev_b32 v10, 16, v205
    v_and_b32 v11, 0xffff0000, v205
    v_mul_f32 v8, s20, v8
    v_mul_f32 v9, s20, v9
    v_mul_f32 v10, s20, v10
    v_mul_f32 v11, s20, v11
    v_cvt_pk_bf16_f32 v204, v8, v9
    v_cvt_pk_bf16_f32 v205, v10, v11
    v_lshlrev_b32 v8, 16, v206
    v_and_b32 v9, 0xffff0000, v206
    v_lshlrev_b32 v10, 16, v207
    v_and_b32 v11, 0xffff0000, v207
    v_mul_f32 v8, s20, v8
    v_mul_f32 v9, s20, v9
    v_mul_f32 v10, s20, v10
    v_mul_f32 v11, s20, v11
    v_cvt_pk_bf16_f32 v206, v8, v9
    v_cvt_pk_bf16_f32 v207, v10, v11
    v_exp_f32 v84, v84
    v_exp_f32 v85, v85
    v_exp_f32 v86, v86
    v_exp_f32 v87, v87
    v_exp_f32 v116, v116
    v_exp_f32 v117, v117
    v_exp_f32 v118, v118
    v_exp_f32 v119, v119
    s_nop 0
    v_add_f32 v13, v13, v84
    v_add_f32 v13, v13, v85
    v_cvt_pk_bf16_f32 v84, v84, v85
    v_add_f32 v13, v13, v86
    s_waitcnt lgkmcnt(0)
    v_mfma_f32_16x16x32_bf16 v[72:75], v[32:35], v[208:211], v[72:75]
    v_add_f32 v13, v13, v87
    v_mfma_f32_16x16x32_bf16 v[72:75], v[36:39], v[212:215], v[72:75]
    ds_read_b128 v[32:35], v4 offset:384
    v_cvt_pk_bf16_f32 v85, v86, v87
    v_mfma_f32_16x16x32_bf16 v[104:107], v[40:43], v[208:211], v[104:107]
    ds_read_b128 v[36:39], v4 offset:448
    v_add_f32 v13, v13, v116
    v_mfma_f32_16x16x32_bf16 v[104:107], v[44:47], v[212:215], v[104:107]
    ds_read_b128 v[40:43], v4 offset:896
    v_cvt_pk_bf16_f32 v86, v116, v117
    v_mfma_f32_16x16x32_bf16 v[88:91], v[48:51], v[208:211], v[88:91]
    ds_read_b128 v[44:47], v4 offset:960
    v_add_f32 v13, v13, v117
    v_mfma_f32_16x16x32_bf16 v[88:91], v[52:55], v[212:215], v[88:91]
    ds_read_b128 v[48:51], v1 offset:384
    v_add_f32 v13, v13, v118
    v_mfma_f32_16x16x32_bf16 v[120:123], v[56:59], v[208:211], v[120:123]
    ds_read_b128 v[52:55], v1 offset:448
    v_cvt_pk_bf16_f32 v87, v118, v119
    v_mfma_f32_16x16x32_bf16 v[120:123], v[60:63], v[212:215], v[120:123]
    ds_read_b128 v[56:59], v1 offset:896
    v_add_f32 v13, v13, v119
    s_nop 1
    ds_read_b128 v[60:63], v1 offset:960
    s_waitcnt vmcnt(6)
    ds_read_b128 v[216:219], v7 offset:6656
    ds_read_b128 v[220:223], v2 offset:6656
    s_add_u32 m0, s39, 14464
    s_nop 0
    buffer_load_dwordx4 v6, s[4:7], s94 offen offset:384 nt lds
    s_add_u32 m0, s39, 15488
    s_nop 0
    buffer_load_dwordx4 v6, s[4:7], s95 offen offset:384 nt lds
    s_add_u32 m0, s30, 16896
    s_nop 0
    buffer_load_dwordx4 v5, s[8:11], s32 offen offset:0 nt lds
    s_add_u32 m0, s30, 17440
    s_nop 0
    buffer_load_dwordx4 v5, s[8:11], s32 offen offset:512 nt lds
    v_lshlrev_b32 v8, 16, v208
    v_and_b32 v9, 0xffff0000, v208
    v_lshlrev_b32 v10, 16, v209
    v_and_b32 v11, 0xffff0000, v209
    v_mul_f32 v8, s20, v8
    v_mul_f32 v9, s20, v9
    v_mul_f32 v10, s20, v10
    v_mul_f32 v11, s20, v11
    v_cvt_pk_bf16_f32 v208, v8, v9
    v_cvt_pk_bf16_f32 v209, v10, v11
    v_lshlrev_b32 v8, 16, v210
    v_and_b32 v9, 0xffff0000, v210
    v_lshlrev_b32 v10, 16, v211
    v_and_b32 v11, 0xffff0000, v211
    v_mul_f32 v8, s20, v8
    v_mul_f32 v9, s20, v9
    v_mul_f32 v10, s20, v10
    v_mul_f32 v11, s20, v11
    v_cvt_pk_bf16_f32 v210, v8, v9
    v_cvt_pk_bf16_f32 v211, v10, v11
    v_lshlrev_b32 v8, 16, v212
    v_and_b32 v9, 0xffff0000, v212
    v_lshlrev_b32 v10, 16, v213
    v_and_b32 v11, 0xffff0000, v213
    v_mul_f32 v8, s20, v8
    v_mul_f32 v9, s20, v9
    v_mul_f32 v10, s20, v10
    v_mul_f32 v11, s20, v11
    v_cvt_pk_bf16_f32 v212, v8, v9
    v_cvt_pk_bf16_f32 v213, v10, v11
    v_lshlrev_b32 v8, 16, v214
    v_and_b32 v9, 0xffff0000, v214
    s_waitcnt lgkmcnt(0)
    v_mfma_f32_16x16x32_bf16 v[72:75], v[32:35], v[216:219], v[72:75]
    v_lshlrev_b32 v10, 16, v215
    v_mfma_f32_16x16x32_bf16 v[72:75], v[36:39], v[220:223], v[72:75]
    ds_read_b128 v[32:35], v4 offset:0
    v_and_b32 v11, 0xffff0000, v215
    v_mfma_f32_16x16x32_bf16 v[104:107], v[40:43], v[216:219], v[104:107]
    ds_read_b128 v[36:39], v4 offset:64
    v_mul_f32 v8, s20, v8
    v_mfma_f32_16x16x32_bf16 v[104:107], v[44:47], v[220:223], v[104:107]
    ds_read_b128 v[40:43], v4 offset:512
    v_mul_f32 v9, s20, v9
    v_mfma_f32_16x16x32_bf16 v[88:91], v[48:51], v[216:219], v[88:91]
    ds_read_b128 v[44:47], v4 offset:576
    v_mul_f32 v10, s20, v10
    v_mfma_f32_16x16x32_bf16 v[88:91], v[52:55], v[220:223], v[88:91]
    ds_read_b128 v[48:51], v1 offset:0
    v_mul_f32 v11, s20, v11
    v_mfma_f32_16x16x32_bf16 v[120:123], v[56:59], v[216:219], v[120:123]
    ds_read_b128 v[52:55], v1 offset:64
    v_cvt_pk_bf16_f32 v214, v8, v9
    v_mfma_f32_16x16x32_bf16 v[120:123], v[60:63], v[220:223], v[120:123]
    ds_read_b128 v[56:59], v1 offset:512
    v_cvt_pk_bf16_f32 v215, v10, v11
    s_nop 1
    ds_read_b128 v[60:63], v1 offset:576
    s_waitcnt vmcnt(8)
    ds_read_b128 v[224:227], v7 offset:8704
    ds_read_b128 v[228:231], v2 offset:8704
    s_add_u32 m0, s30, 17984
    s_nop 0
    buffer_load_dwordx4 v5, s[8:11], s32 offen offset:1024 nt lds
    s_add_u32 m0, s30, 18528
    s_nop 0
    buffer_load_dwordx4 v5, s[8:11], s32 offen offset:1536 nt lds
    v_lshlrev_b32 v8, 16, v216
    v_and_b32 v9, 0xffff0000, v216
    v_lshlrev_b32 v10, 16, v217
    v_and_b32 v11, 0xffff0000, v217
    v_mul_f32 v8, s20, v8
    v_mul_f32 v9, s20, v9
    v_mul_f32 v10, s20, v10
    v_mul_f32 v11, s20, v11
    v_cvt_pk_bf16_f32 v216, v8, v9
    v_cvt_pk_bf16_f32 v217, v10, v11
    v_lshlrev_b32 v8, 16, v218
    v_and_b32 v9, 0xffff0000, v218
    v_lshlrev_b32 v10, 16, v219
    v_and_b32 v11, 0xffff0000, v219
    v_mul_f32 v8, s20, v8
    v_mul_f32 v9, s20, v9
    v_mul_f32 v10, s20, v10
    v_mul_f32 v11, s20, v11
    v_cvt_pk_bf16_f32 v218, v8, v9
    v_cvt_pk_bf16_f32 v219, v10, v11
    v_lshlrev_b32 v8, 16, v220
    v_and_b32 v9, 0xffff0000, v220
    v_lshlrev_b32 v10, 16, v221
    v_and_b32 v11, 0xffff0000, v221
    v_mul_f32 v8, s20, v8
    v_mul_f32 v9, s20, v9
    v_mul_f32 v10, s20, v10
    v_mul_f32 v11, s20, v11
    v_cvt_pk_bf16_f32 v220, v8, v9
    v_cvt_pk_bf16_f32 v221, v10, v11
    v_lshlrev_b32 v8, 16, v222
    v_and_b32 v9, 0xffff0000, v222
    v_lshlrev_b32 v10, 16, v223
    v_and_b32 v11, 0xffff0000, v223
    v_mul_f32 v8, s20, v8
    v_mul_f32 v9, s20, v9
    v_mul_f32 v10, s20, v10
    v_mul_f32 v11, s20, v11
    v_cvt_pk_bf16_f32 v222, v8, v9
    v_cvt_pk_bf16_f32 v223, v10, v11
    v_max3_f32 v8, v72, v73, v74
    v_max3_f32 v8, v8, v75, v104
    v_max3_f32 v8, v8, v105, v106
    v_max3_f32 v8, v8, v107, v88
    v_max3_f32 v8, v8, v89, v90
    v_max3_f32 v8, v8, v91, v120
    v_max3_f32 v8, v8, v121, v122
    v_max_f32 v8, v8, v123
    v_mov_b32 v9, v8
    s_nop 1
    v_permlane16_swap_b32 v8, v9
    v_max_f32 v8, v8, v9
    v_mov_b32 v9, v8
    s_nop 1
    v_permlane32_swap_b32 v8, v9
    v_max_f32 v8, v8, v9
    v_mul_f32 v24, -v8, s20
    v_fma_f32 v72, v72, s20, v24
    v_fma_f32 v73, v73, s20, v24
    v_fma_f32 v74, v74, s20, v24
    v_fma_f32 v75, v75, s20, v24
    v_fma_f32 v104, v104, s20, v24
    v_fma_f32 v105, v105, s20, v24
    v_fma_f32 v106, v106, s20, v24
    v_fma_f32 v107, v107, s20, v24
    v_fma_f32 v88, v88, s20, v24
    v_fma_f32 v89, v89, s20, v24
    v_fma_f32 v90, v90, s20, v24
    s_waitcnt lgkmcnt(0)
    v_mfma_f32_16x16x32_bf16 v[76:79], v[32:35], v[224:227], 0
    v_fma_f32 v91, v91, s20, v24
    v_mfma_f32_16x16x32_bf16 v[76:79], v[36:39], v[228:231], v[76:79]
    ds_read_b128 v[32:35], v4 offset:128
    v_fma_f32 v120, v120, s20, v24
    v_mfma_f32_16x16x32_bf16 v[108:111], v[40:43], v[224:227], 0
    ds_read_b128 v[36:39], v4 offset:192
    v_fma_f32 v121, v121, s20, v24
    v_mfma_f32_16x16x32_bf16 v[108:111], v[44:47], v[228:231], v[108:111]
    ds_read_b128 v[40:43], v4 offset:640
    v_fma_f32 v122, v122, s20, v24
    v_mfma_f32_16x16x32_bf16 v[92:95], v[48:51], v[224:227], 0
    ds_read_b128 v[44:47], v4 offset:704
    v_fma_f32 v123, v123, s20, v24
    v_mfma_f32_16x16x32_bf16 v[92:95], v[52:55], v[228:231], v[92:95]
    ds_read_b128 v[48:51], v1 offset:128
    v_mov_b32 v25, v24
    v_mfma_f32_16x16x32_bf16 v[124:127], v[56:59], v[224:227], 0
    ds_read_b128 v[52:55], v1 offset:192
    v_mov_b32 v26, v24
    v_mfma_f32_16x16x32_bf16 v[124:127], v[60:63], v[228:231], v[124:127]
    ds_read_b128 v[56:59], v1 offset:640
    v_mov_b32 v27, v24
    s_nop 1
    ds_read_b128 v[60:63], v1 offset:704
    s_waitcnt vmcnt(8)
    ds_read_b128 v[232:235], v7 offset:10752
    ds_read_b128 v[236:239], v2 offset:10752
    s_add_u32 m0, s30, 101376
    s_nop 0
    buffer_load_dwordx4 v5, s[12:15], 0 offen offset:0 nt lds
    s_add_u32 m0, s30, 101920
    s_nop 0
    buffer_load_dwordx4 v5, s[12:15], 0 offen offset:512 nt lds
    v_lshlrev_b32 v8, 16, v224
    v_and_b32 v9, 0xffff0000, v224
    v_lshlrev_b32 v10, 16, v225
    v_and_b32 v11, 0xffff0000, v225
    v_mul_f32 v8, s20, v8
    v_mul_f32 v9, s20, v9
    v_mul_f32 v10, s20, v10
    v_mul_f32 v11, s20, v11
    v_cvt_pk_bf16_f32 v224, v8, v9
    v_cvt_pk_bf16_f32 v225, v10, v11
    v_lshlrev_b32 v8, 16, v226
    v_and_b32 v9, 0xffff0000, v226
    v_lshlrev_b32 v10, 16, v227
    v_and_b32 v11, 0xffff0000, v227
    v_mul_f32 v8, s20, v8
    v_mul_f32 v9, s20, v9
    v_mul_f32 v10, s20, v10
    v_mul_f32 v11, s20, v11
    v_cvt_pk_bf16_f32 v226, v8, v9
    v_cvt_pk_bf16_f32 v227, v10, v11
    v_lshlrev_b32 v8, 16, v228
    v_and_b32 v9, 0xffff0000, v228
    v_lshlrev_b32 v10, 16, v229
    v_and_b32 v11, 0xffff0000, v229
    v_mul_f32 v8, s20, v8
    v_mul_f32 v9, s20, v9
    v_mul_f32 v10, s20, v10
    v_mul_f32 v11, s20, v11
    v_cvt_pk_bf16_f32 v228, v8, v9
    v_cvt_pk_bf16_f32 v229, v10, v11
    v_lshlrev_b32 v8, 16, v230
    v_and_b32 v9, 0xffff0000, v230
    v_lshlrev_b32 v10, 16, v231
    v_and_b32 v11, 0xffff0000, v231
    v_mul_f32 v8, s20, v8
    v_mul_f32 v9, s20, v9
    v_mul_f32 v10, s20, v10
    v_mul_f32 v11, s20, v11
    v_cvt_pk_bf16_f32 v230, v8, v9
    v_cvt_pk_bf16_f32 v231, v10, v11
    v_exp_f32 v72, v72
    v_exp_f32 v73, v73
    v_exp_f32 v74, v74
    v_exp_f32 v75, v75
    v_exp_f32 v104, v104
    v_exp_f32 v105, v105
    v_exp_f32 v106, v106
    v_exp_f32 v107, v107
    s_nop 0
    v_add_f32 v14, v14, v72
    v_add_f32 v14, v14, v73
    v_cvt_pk_bf16_f32 v72, v72, v73
    v_add_f32 v14, v14, v74
    s_waitcnt lgkmcnt(0)
    v_mfma_f32_16x16x32_bf16 v[76:79], v[32:35], v[232:235], v[76:79]
    v_add_f32 v14, v14, v75
    v_mfma_f32_16x16x32_bf16 v[76:79], v[36:39], v[236:239], v[76:79]
    ds_read_b128 v[32:35], v4 offset:256
    v_cvt_pk_bf16_f32 v73, v74, v75
    v_mfma_f32_16x16x32_bf16 v[108:111], v[40:43], v[232:235], v[108:111]
    ds_read_b128 v[36:39], v4 offset:320
    v_add_f32 v14, v14, v104
    v_mfma_f32_16x16x32_bf16 v[108:111], v[44:47], v[236:239], v[108:111]
    ds_read_b128 v[40:43], v4 offset:768
    v_cvt_pk_bf16_f32 v74, v104, v105
    v_mfma_f32_16x16x32_bf16 v[92:95], v[48:51], v[232:235], v[92:95]
    ds_read_b128 v[44:47], v4 offset:832
    v_add_f32 v14, v14, v105
    v_mfma_f32_16x16x32_bf16 v[92:95], v[52:55], v[236:239], v[92:95]
    ds_read_b128 v[48:51], v1 offset:256
    v_add_f32 v14, v14, v106
    v_mfma_f32_16x16x32_bf16 v[124:127], v[56:59], v[232:235], v[124:127]
    ds_read_b128 v[52:55], v1 offset:320
    v_cvt_pk_bf16_f32 v75, v106, v107
    v_mfma_f32_16x16x32_bf16 v[124:127], v[60:63], v[236:239], v[124:127]
    ds_read_b128 v[56:59], v1 offset:768
    v_add_f32 v14, v14, v107
    s_nop 1
    ds_read_b128 v[60:63], v1 offset:832
    s_waitcnt vmcnt(8)
    ds_read_b128 v[240:243], v7 offset:12800
    ds_read_b128 v[244:247], v2 offset:12800
    s_add_u32 m0, s30, 102464
    s_nop 0
    buffer_load_dwordx4 v5, s[12:15], 0 offen offset:1024 nt lds
    s_add_u32 m0, s30, 103008
    s_nop 0
    buffer_load_dwordx4 v5, s[12:15], 0 offen offset:1536 nt lds
    v_lshlrev_b32 v8, 16, v232
    v_and_b32 v9, 0xffff0000, v232
    v_lshlrev_b32 v10, 16, v233
    v_and_b32 v11, 0xffff0000, v233
    v_mul_f32 v8, s20, v8
    v_mul_f32 v9, s20, v9
    v_mul_f32 v10, s20, v10
    v_mul_f32 v11, s20, v11
    v_cvt_pk_bf16_f32 v232, v8, v9
    v_cvt_pk_bf16_f32 v233, v10, v11
    v_lshlrev_b32 v8, 16, v234
    v_and_b32 v9, 0xffff0000, v234
    v_lshlrev_b32 v10, 16, v235
    v_and_b32 v11, 0xffff0000, v235
    v_mul_f32 v8, s20, v8
    v_mul_f32 v9, s20, v9
    v_mul_f32 v10, s20, v10
    v_mul_f32 v11, s20, v11
    v_cvt_pk_bf16_f32 v234, v8, v9
    v_cvt_pk_bf16_f32 v235, v10, v11
    v_lshlrev_b32 v8, 16, v236
    v_and_b32 v9, 0xffff0000, v236
    v_lshlrev_b32 v10, 16, v237
    v_and_b32 v11, 0xffff0000, v237
    v_mul_f32 v8, s20, v8
    v_mul_f32 v9, s20, v9
    v_mul_f32 v10, s20, v10
    v_mul_f32 v11, s20, v11
    v_cvt_pk_bf16_f32 v236, v8, v9
    v_cvt_pk_bf16_f32 v237, v10, v11
    v_lshlrev_b32 v8, 16, v238
    v_and_b32 v9, 0xffff0000, v238
    v_lshlrev_b32 v10, 16, v239
    v_and_b32 v11, 0xffff0000, v239
    v_mul_f32 v8, s20, v8
    v_mul_f32 v9, s20, v9
    v_mul_f32 v10, s20, v10
    v_mul_f32 v11, s20, v11
    v_cvt_pk_bf16_f32 v238, v8, v9
    v_cvt_pk_bf16_f32 v239, v10, v11
    v_exp_f32 v88, v88
    v_exp_f32 v89, v89
    v_exp_f32 v90, v90
    v_exp_f32 v91, v91
    v_exp_f32 v120, v120
    v_exp_f32 v121, v121
    v_exp_f32 v122, v122
    v_exp_f32 v123, v123
    s_nop 0
    v_add_f32 v14, v14, v88
    v_add_f32 v14, v14, v89
    v_cvt_pk_bf16_f32 v88, v88, v89
    v_add_f32 v14, v14, v90
    s_waitcnt lgkmcnt(0)
    v_mfma_f32_16x16x32_bf16 v[76:79], v[32:35], v[240:243], v[76:79]
    v_add_f32 v14, v14, v91
    v_mfma_f32_16x16x32_bf16 v[76:79], v[36:39], v[244:247], v[76:79]
    ds_read_b128 v[32:35], v4 offset:384
    v_cvt_pk_bf16_f32 v89, v90, v91
    v_mfma_f32_16x16x32_bf16 v[108:111], v[40:43], v[240:243], v[108:111]
    ds_read_b128 v[36:39], v4 offset:448
    v_add_f32 v14, v14, v120
    v_mfma_f32_16x16x32_bf16 v[108:111], v[44:47], v[244:247], v[108:111]
    ds_read_b128 v[40:43], v4 offset:896
    v_cvt_pk_bf16_f32 v90, v120, v121
    v_mfma_f32_16x16x32_bf16 v[92:95], v[48:51], v[240:243], v[92:95]
    ds_read_b128 v[44:47], v4 offset:960
    v_add_f32 v14, v14, v121
    v_mfma_f32_16x16x32_bf16 v[92:95], v[52:55], v[244:247], v[92:95]
    ds_read_b128 v[48:51], v1 offset:384
    v_add_f32 v14, v14, v122
    v_mfma_f32_16x16x32_bf16 v[124:127], v[56:59], v[240:243], v[124:127]
    ds_read_b128 v[52:55], v1 offset:448
    v_cvt_pk_bf16_f32 v91, v122, v123
    v_mfma_f32_16x16x32_bf16 v[124:127], v[60:63], v[244:247], v[124:127]
    ds_read_b128 v[56:59], v1 offset:896
    v_add_f32 v14, v14, v123
    s_nop 1
    ds_read_b128 v[60:63], v1 offset:960
    s_waitcnt vmcnt(8)
    ds_read_b128 v[248:251], v7 offset:14848
    ds_read_b128 v[252:255], v2 offset:14848
    s_add_u32 m0, s30, 118272
    s_nop 0
    buffer_load_dwordx4 v5, s[12:15], s31 offen offset:0 nt lds
    s_add_u32 m0, s30, 118816
    s_nop 0
    buffer_load_dwordx4 v5, s[12:15], s31 offen offset:512 nt lds
    v_lshlrev_b32 v8, 16, v240
    v_and_b32 v9, 0xffff0000, v240
    v_lshlrev_b32 v10, 16, v241
    v_and_b32 v11, 0xffff0000, v241
    v_mul_f32 v8, s20, v8
    v_mul_f32 v9, s20, v9
    v_mul_f32 v10, s20, v10
    v_mul_f32 v11, s20, v11
    v_cvt_pk_bf16_f32 v240, v8, v9
    v_cvt_pk_bf16_f32 v241, v10, v11
    v_lshlrev_b32 v8, 16, v242
    v_and_b32 v9, 0xffff0000, v242
    v_lshlrev_b32 v10, 16, v243
    v_and_b32 v11, 0xffff0000, v243
    v_mul_f32 v8, s20, v8
    v_mul_f32 v9, s20, v9
    v_mul_f32 v10, s20, v10
    v_mul_f32 v11, s20, v11
    v_cvt_pk_bf16_f32 v242, v8, v9
    v_cvt_pk_bf16_f32 v243, v10, v11
    v_lshlrev_b32 v8, 16, v244
    v_and_b32 v9, 0xffff0000, v244
    v_lshlrev_b32 v10, 16, v245
    v_and_b32 v11, 0xffff0000, v245
    s_waitcnt lgkmcnt(0)
    v_mfma_f32_16x16x32_bf16 v[76:79], v[32:35], v[248:251], v[76:79]
    v_mul_f32 v8, s20, v8
    v_mul_f32 v9, s20, v9
    v_mfma_f32_16x16x32_bf16 v[76:79], v[36:39], v[252:255], v[76:79]
    v_mul_f32 v10, s20, v10
    v_mul_f32 v11, s20, v11
    v_mfma_f32_16x16x32_bf16 v[108:111], v[40:43], v[248:251], v[108:111]
    v_cvt_pk_bf16_f32 v244, v8, v9
    v_cvt_pk_bf16_f32 v245, v10, v11
    v_mfma_f32_16x16x32_bf16 v[108:111], v[44:47], v[252:255], v[108:111]
    v_lshlrev_b32 v8, 16, v246
    v_and_b32 v9, 0xffff0000, v246
    v_mfma_f32_16x16x32_bf16 v[92:95], v[48:51], v[248:251], v[92:95]
    v_lshlrev_b32 v10, 16, v247
    v_and_b32 v11, 0xffff0000, v247
    v_mfma_f32_16x16x32_bf16 v[92:95], v[52:55], v[252:255], v[92:95]
    v_mul_f32 v8, s20, v8
    v_mul_f32 v9, s20, v9
    v_mfma_f32_16x16x32_bf16 v[124:127], v[56:59], v[248:251], v[124:127]
    v_mul_f32 v10, s20, v10
    v_mul_f32 v11, s20, v11
    v_mfma_f32_16x16x32_bf16 v[124:127], v[60:63], v[252:255], v[124:127]
    v_cvt_pk_bf16_f32 v246, v8, v9
    v_cvt_pk_bf16_f32 v247, v10, v11
    s_add_u32 m0, s30, 119360
    s_nop 0
    buffer_load_dwordx4 v5, s[12:15], s31 offen offset:1024 nt lds
    s_add_u32 m0, s30, 119904
    s_nop 0
    buffer_load_dwordx4 v5, s[12:15], s31 offen offset:1536 nt lds
    v_lshlrev_b32 v8, 16, v248
    v_and_b32 v9, 0xffff0000, v248
    v_lshlrev_b32 v10, 16, v249
    v_and_b32 v11, 0xffff0000, v249
    v_mul_f32 v8, s20, v8
    v_mul_f32 v9, s20, v9
    v_mul_f32 v10, s20, v10
    v_mul_f32 v11, s20, v11
    v_cvt_pk_bf16_f32 v248, v8, v9
    v_cvt_pk_bf16_f32 v249, v10, v11
    v_lshlrev_b32 v8, 16, v250
    v_and_b32 v9, 0xffff0000, v250
    v_lshlrev_b32 v10, 16, v251
    v_and_b32 v11, 0xffff0000, v251
    v_mul_f32 v8, s20, v8
    v_mul_f32 v9, s20, v9
    v_mul_f32 v10, s20, v10
    v_mul_f32 v11, s20, v11
    v_cvt_pk_bf16_f32 v250, v8, v9
    v_cvt_pk_bf16_f32 v251, v10, v11
    v_lshlrev_b32 v8, 16, v252
    v_and_b32 v9, 0xffff0000, v252
    v_lshlrev_b32 v10, 16, v253
    v_and_b32 v11, 0xffff0000, v253
    v_mul_f32 v8, s20, v8
    v_mul_f32 v9, s20, v9
    v_mul_f32 v10, s20, v10
    v_mul_f32 v11, s20, v11
    v_cvt_pk_bf16_f32 v252, v8, v9
    v_cvt_pk_bf16_f32 v253, v10, v11
    v_lshlrev_b32 v8, 16, v254
    v_and_b32 v9, 0xffff0000, v254
    v_lshlrev_b32 v10, 16, v255
    v_and_b32 v11, 0xffff0000, v255
    v_mul_f32 v8, s20, v8
    v_mul_f32 v9, s20, v9
    v_mul_f32 v10, s20, v10
    v_mul_f32 v11, s20, v11
    v_cvt_pk_bf16_f32 v254, v8, v9
    v_cvt_pk_bf16_f32 v255, v10, v11
    v_max3_f32 v8, v76, v77, v78
    v_max3_f32 v8, v8, v79, v108
    v_max3_f32 v8, v8, v109, v110
    v_max3_f32 v8, v8, v111, v92
    v_max3_f32 v8, v8, v93, v94
    v_max3_f32 v8, v8, v95, v124
    v_max3_f32 v8, v8, v125, v126
    v_max_f32 v8, v8, v127
    v_mov_b32 v9, v8
    s_nop 1
    v_permlane16_swap_b32 v8, v9
    v_max_f32 v8, v8, v9
    v_mov_b32 v9, v8
    s_nop 1
    v_permlane32_swap_b32 v8, v9
    v_max_f32 v8, v8, v9
    v_mov_b32 v9, s26
    v_fma_f32 v28, -v8, s20, -v9
    v_fma_f32 v76, v76, s20, v28
    v_fma_f32 v77, v77, s20, v28
    v_fma_f32 v78, v78, s20, v28
    v_fma_f32 v79, v79, s20, v28
    v_fma_f32 v108, v108, s20, v28
    v_fma_f32 v109, v109, s20, v28
    v_fma_f32 v110, v110, s20, v28
    v_fma_f32 v111, v111, s20, v28
    v_fma_f32 v92, v92, s20, v28
    v_fma_f32 v93, v93, s20, v28
    v_fma_f32 v94, v94, s20, v28
    v_fma_f32 v95, v95, s20, v28
    v_fma_f32 v124, v124, s20, v28
    v_fma_f32 v125, v125, s20, v28
    v_fma_f32 v126, v126, s20, v28
    v_fma_f32 v127, v127, s20, v28
    v_mov_b32 v29, v28
    v_mov_b32 v30, v28
    v_mov_b32 v31, v28
    v_exp_f32 v76, v76
    v_exp_f32 v77, v77
    v_exp_f32 v78, v78
    v_exp_f32 v79, v79
    v_exp_f32 v108, v108
    v_exp_f32 v109, v109
    v_exp_f32 v110, v110
    v_exp_f32 v111, v111
    s_nop 0
    v_add_f32 v15, v15, v76
    v_add_f32 v15, v15, v77
    v_cvt_pk_bf16_f32 v76, v76, v77
    v_add_f32 v15, v15, v78
    v_add_f32 v15, v15, v79
    v_cvt_pk_bf16_f32 v77, v78, v79
    v_add_f32 v15, v15, v108
    v_cvt_pk_bf16_f32 v78, v108, v109
    v_add_f32 v15, v15, v109
    v_add_f32 v15, v15, v110
    v_cvt_pk_bf16_f32 v79, v110, v111
    v_add_f32 v15, v15, v111
    v_and_b32 v9, 63, v0
    v_and_b32 v10, 15, v9
    v_lshrrev_b32 v11, 4, v9
    v_mul_u32_u24 v10, 144, v10
    v_lshl_add_u32 v10, v11, 3, v10
    s_and_b32 s33, s29, 1
    s_mul_i32 s33, s33, 8448
    s_cmp_ge_u32 s29, 2
    s_cselect_b32 s34, 84480, 0
    s_add_u32 s33, s33, s34
    s_add_u32 s33, s33, 50688
    v_add_u32 v6, s33, v10
    v_lshrrev_b32 v10, 3, v9
    v_and_b32 v11, 7, v9
    v_lshlrev_b32 v11, 4, v11
    v_mul_u32_u24 v2, 144, v10
    v_add3_u32 v7, s33, v2, v11
    v_lshl_add_u32 v8, v10, 9, v11
    s_bfe_u32 s34, s2, 0x10003
    v_and_b32 v11, 0xfe, v0
    v_or_b32 v11, s34, v11
    v_lshlrev_b32 v11, 7, v11
    v_lshl_add_u32 v9, v9, 4, s33
    v_subrev_u32 v10, 67584, v3
    s_waitcnt vmcnt(8)
    s_barrier
    ds_read_b128 v[32:35], v1 offset:16896
    ds_read_b128 v[36:39], v1 offset:16960
    ds_read_b128 v[40:43], v1 offset:17024
    ds_read_b128 v[44:47], v1 offset:17088
    ds_read_b128 v[48:51], v1 offset:17152
    ds_read_b128 v[52:55], v1 offset:17216
    s_waitcnt lgkmcnt(4)
    s_branch L_head
L_odd:
    s_add_u32 m0, s39, 2432
    s_nop 0
    buffer_load_dwordx4 v6, s[4:7], s88 offen offset:128 nt lds
    s_add_u32 m0, s39, 3456
    s_nop 0
    buffer_load_dwordx4 v6, s[4:7], s89 offen offset:128 nt lds
    s_add_u32 m0, s39, 4352
    s_nop 0
    buffer_load_dwordx4 v6, s[4:7], s88 offen offset:256 nt lds
    s_add_u32 m0, s39, 5376
    s_nop 0
    buffer_load_dwordx4 v6, s[4:7], s89 offen offset:256 nt lds
    s_add_u32 m0, s39, 6272
    s_nop 0
    buffer_load_dwordx4 v6, s[4:7], s88 offen offset:384 nt lds
    s_add_u32 m0, s39, 7296
    s_nop 0
    buffer_load_dwordx4 v6, s[4:7], s89 offen offset:384 nt lds
    s_add_u32 m0, s39, 8704
    s_nop 0
    buffer_load_dwordx4 v6, s[4:7], s90 offen offset:0 nt lds
    s_add_u32 m0, s39, 9728
    s_nop 0
    buffer_load_dwordx4 v6, s[4:7], s91 offen offset:0 nt lds
    s_waitcnt vmcnt(8)
    s_barrier
    ds_read_b128 v[128:131], v7 offset:512
    ds_read_b128 v[132:135], v2 offset:512
    ds_read_b128 v[32:35], v4 offset:0
    ds_read_b128 v[36:39], v4 offset:64
    ds_read_b128 v[40:43], v4 offset:512
    ds_read_b128 v[44:47], v4 offset:576
    ds_read_b128 v[48:51], v1 offset:0
    ds_read_b128 v[52:55], v1 offset:64
    ds_read_b128 v[56:59], v1 offset:512
    ds_read_b128 v[60:63], v1 offset:576
    s_add_u32 m0, s39, 10624
    s_nop 0
    buffer_load_dwordx4 v6, s[4:7], s90 offen offset:128 nt lds
    s_add_u32 m0, s39, 11648
    s_nop 0
    buffer_load_dwordx4 v6, s[4:7], s91 offen offset:128 nt lds
    s_waitcnt lgkmcnt(0)
    v_mfma_f32_16x16x32_bf16 v[64:67], v[32:35], v[128:131], 0
    v_mfma_f32_16x16x32_bf16 v[64:67], v[36:39], v[132:135], v[64:67]
    ds_read_b128 v[32:35], v4 offset:128
    v_mfma_f32_16x16x32_bf16 v[96:99], v[40:43], v[128:131], 0
    ds_read_b128 v[36:39], v4 offset:192
    v_mfma_f32_16x16x32_bf16 v[96:99], v[44:47], v[132:135], v[96:99]
    ds_read_b128 v[40:43], v4 offset:640
    v_mfma_f32_16x16x32_bf16 v[80:83], v[48:51], v[128:131], 0
    ds_read_b128 v[44:47], v4 offset:704
    v_mfma_f32_16x16x32_bf16 v[80:83], v[52:55], v[132:135], v[80:83]
    ds_read_b128 v[48:51], v1 offset:128
    v_mfma_f32_16x16x32_bf16 v[112:115], v[56:59], v[128:131], 0
    ds_read_b128 v[52:55], v1 offset:192
    v_mfma_f32_16x16x32_bf16 v[112:115], v[60:63], v[132:135], v[112:115]
    ds_read_b128 v[56:59], v1 offset:640
    s_nop 1
    ds_read_b128 v[60:63], v1 offset:704
    s_waitcnt vmcnt(8)
    ds_read_b128 v[136:139], v7 offset:2560
    ds_read_b128 v[140:143], v2 offset:2560
    s_add_u32 m0, s39, 12544
    s_nop 0
    buffer_load_dwordx4 v6, s[4:7], s90 offen offset:256 nt lds
    s_add_u32 m0, s39, 13568
    s_nop 0
    buffer_load_dwordx4 v6, s[4:7], s91 offen offset:256 nt lds
    v_lshlrev_b32 v8, 16, v128
    v_and_b32 v9, 0xffff0000, v128
    v_lshlrev_b32 v10, 16, v129
    v_and_b32 v11, 0xffff0000, v129
    v_mul_f32 v8, s20, v8
    v_mul_f32 v9, s20, v9
    v_mul_f32 v10, s20, v10
    v_mul_f32 v11, s20, v11
    v_cvt_pk_bf16_f32 v128, v8, v9
    v_cvt_pk_bf16_f32 v129, v10, v11
    v_lshlrev_b32 v8, 16, v130
    v_and_b32 v9, 0xffff0000, v130
    v_lshlrev_b32 v10, 16, v131
    v_and_b32 v11, 0xffff0000, v131
    v_mul_f32 v8, s20, v8
    v_mul_f32 v9, s20, v9
    v_mul_f32 v10, s20, v10
    v_mul_f32 v11, s20, v11
    v_cvt_pk_bf16_f32 v130, v8, v9
    v_cvt_pk_bf16_f32 v131, v10, v11
    v_lshlrev_b32 v8, 16, v132
    v_and_b32 v9, 0xffff0000, v132
    v_lshlrev_b32 v10, 16, v133
    v_and_b32 v11, 0xffff0000, v133
    v_mul_f32 v8, s20, v8
    v_mul_f32 v9, s20, v9
    v_mul_f32 v10, s20, v10
    v_mul_f32 v11, s20, v11
    v_cvt_pk_bf16_f32 v132, v8, v9
    v_cvt_pk_bf16_f32 v133, v10, v11
    v_lshlrev_b32 v8, 16, v134
    v_and_b32 v9, 0xffff0000, v134
    s_waitcnt lgkmcnt(0)
    v_mfma_f32_16x16x32_bf16 v[64:67], v[32:35], v[136:139], v[64:67]
    v_lshlrev_b32 v10, 16, v135
    v_mfma_f32_16x16x32_bf16 v[64:67], v[36:39], v[140:143], v[64:67]
    ds_read_b128 v[32:35], v4 offset:256
    v_and_b32 v11, 0xffff0000, v135
    v_mfma_f32_16x16x32_bf16 v[96:99], v[40:43], v[136:139], v[96:99]
    ds_read_b128 v[36:39], v4 offset:320
    v_mul_f32 v8, s20, v8
    v_mfma_f32_16x16x32_bf16 v[96:99], v[44:47], v[140:143], v[96:99]
    ds_read_b128 v[40:43], v4 offset:768
    v_mul_f32 v9, s20, v9
    v_mfma_f32_16x16x32_bf16 v[80:83], v[48:51], v[136:139], v[80:83]
    ds_read_b128 v[44:47], v4 offset:832
    v_mul_f32 v10, s20, v10
    v_mfma_f32_16x16x32_bf16 v[80:83], v[52:55], v[140:143], v[80:83]
    ds_read_b128 v[48:51], v1 offset:256
    v_mul_f32 v11, s20, v11
    v_mfma_f32_16x16x32_bf16 v[112:115], v[56:59], v[136:139], v[112:115]
    ds_read_b128 v[52:55], v1 offset:320
    v_cvt_pk_bf16_f32 v134, v8, v9
    v_mfma_f32_16x16x32_bf16 v[112:115], v[60:63], v[140:143], v[112:115]
    ds_read_b128 v[56:59], v1 offset:768
    v_cvt_pk_bf16_f32 v135, v10, v11
    s_nop 1
    ds_read_b128 v[60:63], v1 offset:832
    s_waitcnt vmcnt(8)
    ds_read_b128 v[144:147], v7 offset:4608
    ds_read_b128 v[148:151], v2 offset:4608
    s_add_u32 m0, s39, 14464
    s_nop 0
    buffer_load_dwordx4 v6, s[4:7], s90 offen offset:384 nt lds
    s_add_u32 m0, s39, 15488
    s_nop 0
    buffer_load_dwordx4 v6, s[4:7], s91 offen offset:384 nt lds
    v_lshlrev_b32 v8, 16, v136
    v_and_b32 v9, 0xffff0000, v136
    v_lshlrev_b32 v10, 16, v137
    v_and_b32 v11, 0xffff0000, v137
    v_mul_f32 v8, s20, v8
    v_mul_f32 v9, s20, v9
    v_mul_f32 v10, s20, v10
    v_mul_f32 v11, s20, v11
    v_cvt_pk_bf16_f32 v136, v8, v9
    v_cvt_pk_bf16_f32 v137, v10, v11
    v_lshlrev_b32 v8, 16, v138
    v_and_b32 v9, 0xffff0000, v138
    v_lshlrev_b32 v10, 16, v139
    v_and_b32 v11, 0xffff0000, v139
    v_mul_f32 v8, s20, v8
    v_mul_f32 v9, s20, v9
    v_mul_f32 v10, s20, v10
    v_mul_f32 v11, s20, v11
    v_cvt_pk_bf16_f32 v138, v8, v9
    v_cvt_pk_bf16_f32 v139, v10, v11
    v_lshlrev_b32 v8, 16, v140
    v_and_b32 v9, 0xffff0000, v140
    v_lshlrev_b32 v10, 16, v141
    v_and_b32 v11, 0xffff0000, v141
    v_mul_f32 v8, s20, v8
    v_mul_f32 v9, s20, v9
    v_mul_f32 v10, s20, v10
    v_mul_f32 v11, s20, v11
    v_cvt_pk_bf16_f32 v140, v8, v9
    v_cvt_pk_bf16_f32 v141, v10, v11
    v_lshlrev_b32 v8, 16, v142
    v_and_b32 v9, 0xffff0000, v142
    s_waitcnt lgkmcnt(0)
    v_mfma_f32_16x16x32_bf16 v[64:67], v[32:35], v[144:147], v[64:67]
    v_lshlrev_b32 v10, 16, v143
    v_mfma_f32_16x16x32_bf16 v[64:67], v[36:39], v[148:151], v[64:67]
    ds_read_b128 v[32:35], v4 offset:384
    v_and_b32 v11, 0xffff0000, v143
    v_mfma_f32_16x16x32_bf16 v[96:99], v[40:43], v[144:147], v[96:99]
    ds_read_b128 v[36:39], v4 offset:448
    v_mul_f32 v8, s20, v8
    v_mfma_f32_16x16x32_bf16 v[96:99], v[44:47], v[148:151], v[96:99]
    ds_read_b128 v[40:43], v4 offset:896
    v_mul_f32 v9, s20, v9
    v_mfma_f32_16x16x32_bf16 v[80:83], v[48:51], v[144:147], v[80:83]
    ds_read_b128 v[44:47], v4 offset:960
    v_mul_f32 v10, s20, v10
    v_mfma_f32_16x16x32_bf16 v[80:83], v[52:55], v[148:151], v[80:83]
    ds_read_b128 v[48:51], v1 offset:384
    v_mul_f32 v11, s20, v11
    v_mfma_f32_16x16x32_bf16 v[112:115], v[56:59], v[144:147], v[112:115]
    ds_read_b128 v[52:55], v1 offset:448
    v_cvt_pk_bf16_f32 v142, v8, v9
    v_mfma_f32_16x16x32_bf16 v[112:115], v[60:63], v[148:151], v[112:115]
    ds_read_b128 v[56:59], v1 offset:896
    v_cvt_pk_bf16_f32 v143, v10, v11
    s_nop 1
    ds_read_b128 v[60:63], v1 offset:960
    s_waitcnt vmcnt(8)
    ds_read_b128 v[152:155], v7 offset:6656
    ds_read_b128 v[156:159], v2 offset:6656
    s_add_u32 m0, s39, 512
    s_nop 0
    buffer_load_dwordx4 v6, s[4:7], s92 offen offset:0 nt lds
    s_add_u32 m0, s39, 1536
    s_nop 0
    buffer_load_dwordx4 v6, s[4:7], s93 offen offset:0 nt lds
    v_lshlrev_b32 v8, 16, v144
    v_and_b32 v9, 0xffff0000, v144
    v_lshlrev_b32 v10, 16, v145
    v_and_b32 v11, 0xffff0000, v145
    v_mul_f32 v8, s20, v8
    v_mul_f32 v9, s20, v9
    v_mul_f32 v10, s20, v10
    v_mul_f32 v11, s20, v11
    v_cvt_pk_bf16_f32 v144, v8, v9
    v_cvt_pk_bf16_f32 v145, v10, v11
    v_lshlrev_b32 v8, 16, v146
    v_and_b32 v9, 0xffff0000, v146
    v_lshlrev_b32 v10, 16, v147
    v_and_b32 v11, 0xffff0000, v147
    v_mul_f32 v8, s20, v8
    v_mul_f32 v9, s20, v9
    v_mul_f32 v10, s20, v10
    v_mul_f32 v11, s20, v11
    v_cvt_pk_bf16_f32 v146, v8, v9
    v_cvt_pk_bf16_f32 v147, v10, v11
    v_lshlrev_b32 v8, 16, v148
    v_and_b32 v9, 0xffff0000, v148
    v_lshlrev_b32 v10, 16, v149
    v_and_b32 v11, 0xffff0000, v149
    v_mul_f32 v8, s20, v8
    v_mul_f32 v9, s20, v9
    v_mul_f32 v10, s20, v10
    v_mul_f32 v11, s20, v11
    v_cvt_pk_bf16_f32 v148, v8, v9
    v_cvt_pk_bf16_f32 v149, v10, v11
    v_lshlrev_b32 v8, 16, v150
    v_and_b32 v9, 0xffff0000, v150
    s_waitcnt lgkmcnt(0)
    v_mfma_f32_16x16x32_bf16 v[64:67], v[32:35], v[152:155], v[64:67]
    v_lshlrev_b32 v10, 16, v151
    v_mfma_f32_16x16x32_bf16 v[64:67], v[36:39], v[156:159], v[64:67]
    ds_read_b128 v[32:35], v4 offset:0
    v_and_b32 v11, 0xffff0000, v151
    v_mfma_f32_16x16x32_bf16 v[96:99], v[40:43], v[152:155], v[96:99]
    ds_read_b128 v[36:39], v4 offset:64
    v_mul_f32 v8, s20, v8
    v_mfma_f32_16x16x32_bf16 v[96:99], v[44:47], v[156:159], v[96:99]
    ds_read_b128 v[40:43], v4 offset:512
    v_mul_f32 v9, s20, v9
    v_mfma_f32_16x16x32_bf16 v[80:83], v[48:51], v[152:155], v[80:83]
    ds_read_b128 v[44:47], v4 offset:576
    v_mul_f32 v10, s20, v10
    v_mfma_f32_16x16x32_bf16 v[80:83], v[52:55], v[156:159], v[80:83]
    ds_read_b128 v[48:51], v1 offset:0
    v_mul_f32 v11, s20, v11
    v_mfma_f32_16x16x32_bf16 v[112:115], v[56:59], v[152:155], v[112:115]
    ds_read_b128 v[52:55], v1 offset:64
    v_cvt_pk_bf16_f32 v150, v8, v9
    v_mfma_f32_16x16x32_bf16 v[112:115], v[60:63], v[156:159], v[112:115]
    ds_read_b128 v[56:59], v1 offset:512
    v_cvt_pk_bf16_f32 v151, v10, v11
    s_nop 1
    ds_read_b128 v[60:63], v1 offset:576
    s_waitcnt vmcnt(8)
    ds_read_b128 v[160:163], v7 offset:8704
    ds_read_b128 v[164:167], v2 offset:8704
    s_add_u32 m0, s39, 2432
    s_nop 0
    buffer_load_dwordx4 v6, s[4:7], s92 offen offset:128 nt lds
    s_add_u32 m0, s39, 3456
    s_nop 0
    buffer_load_dwordx4 v6, s[4:7], s93 offen offset:128 nt lds
    v_lshlrev_b32 v8, 16, v152
    v_and_b32 v9, 0xffff0000, v152
    v_lshlrev_b32 v10, 16, v153
    v_and_b32 v11, 0xffff0000, v153
    v_mul_f32 v8, s20, v8
    v_mul_f32 v9, s20, v9
    v_mul_f32 v10, s20, v10
    v_mul_f32 v11, s20, v11
    v_cvt_pk_bf16_f32 v152, v8, v9
    v_cvt_pk_bf16_f32 v153, v10, v11
    v_lshlrev_b32 v8, 16, v154
    v_and_b32 v9, 0xffff0000, v154
    v_lshlrev_b32 v10, 16, v155
    v_and_b32 v11, 0xffff0000, v155
    v_mul_f32 v8, s20, v8
    v_mul_f32 v9, s20, v9
    v_mul_f32 v10, s20, v10
    v_mul_f32 v11, s20, v11
    v_cvt_pk_bf16_f32 v154, v8, v9
    v_cvt_pk_bf16_f32 v155, v10, v11
    v_lshlrev_b32 v8, 16, v156
    v_and_b32 v9, 0xffff0000, v156
    v_lshlrev_b32 v10, 16, v157
    v_and_b32 v11, 0xffff0000, v157
    v_mul_f32 v8, s20, v8
    v_mul_f32 v9, s20, v9
    v_mul_f32 v10, s20, v10
    v_mul_f32 v11, s20, v11
    v_cvt_pk_bf16_f32 v156, v8, v9
    v_cvt_pk_bf16_f32 v157, v10, v11
    v_lshlrev_b32 v8, 16, v158
    v_and_b32 v9, 0xffff0000, v158
    v_lshlrev_b32 v10, 16, v159
    v_and_b32 v11, 0xffff0000, v159
    v_mul_f32 v8, s20, v8
    v_mul_f32 v9, s20, v9
    v_mul_f32 v10, s20, v10
    v_mul_f32 v11, s20, v11
    v_cvt_pk_bf16_f32 v158, v8, v9
    v_cvt_pk_bf16_f32 v159, v10, v11
    v_max3_f32 v8, v64, v65, v66
    v_max3_f32 v8, v8, v67, v96
    v_max3_f32 v8, v8, v97, v98
    v_max3_f32 v8, v8, v99, v80
    v_max3_f32 v8, v8, v81, v82
    v_max3_f32 v8, v8, v83, v112
    v_max3_f32 v8, v8, v113, v114
    v_max_f32 v8, v8, v115
    v_mov_b32 v9, v8
    s_nop 1
    v_permlane16_swap_b32 v8, v9
    v_max_f32 v8, v8, v9
    v_mov_b32 v9, v8
    s_nop 1
    v_permlane32_swap_b32 v8, v9
    v_max_f32 v8, v8, v9
    v_mul_f32 v16, -v8, s20
    v_fma_f32 v64, v64, s20, v16
    v_fma_f32 v65, v65, s20, v16
    v_fma_f32 v66, v66, s20, v16
    v_fma_f32 v67, v67, s20, v16
    v_fma_f32 v96, v96, s20, v16
    v_fma_f32 v97, v97, s20, v16
    v_fma_f32 v98, v98, s20, v16
    v_fma_f32 v99, v99, s20, v16
    v_fma_f32 v80, v80, s20, v16
    v_fma_f32 v81, v81, s20, v16
    v_fma_f32 v82, v82, s20, v16
    s_waitcnt lgkmcnt(0)
    v_mfma_f32_16x16x32_bf16 v[68:71], v[32:35], v[160:163], 0
    v_fma_f32 v83, v83, s20, v16
    v_mfma_f32_16x16x32_bf16 v[68:71], v[36:39], v[164:167], v[68:71]
    ds_read_b128 v[32:35], v4 offset:128
    v_fma_f32 v112, v112, s20, v16
    v_mfma_f32_16x16x32_bf16 v[100:103], v[40:43], v[160:163], 0
    ds_read_b128 v[36:39], v4 offset:192
    v_fma_f32 v113, v113, s20, v16
    v_mfma_f32_16x16x32_bf16 v[100:103], v[44:47], v[164:167], v[100:103]
    ds_read_b128 v[40:43], v4 offset:640
    v_fma_f32 v114, v114, s20, v16
    v_mfma_f32_16x16x32_bf16 v[84:87], v[48:51], v[160:163], 0
    ds_read_b128 v[44:47], v4 offset:704
    v_fma_f32 v115, v115, s20, v16
    v_mfma_f32_16x16x32_bf16 v[84:87], v[52:55], v[164:167], v[84:87]
    ds_read_b128 v[48:51], v1 offset:128
    v_mov_b32 v17, v16
    v_mfma_f32_16x16x32_bf16 v[116:119], v[56:59], v[160:163], 0
    ds_read_b128 v[52:55], v1 offset:192
    v_mov_b32 v18, v16
    v_mfma_f32_16x16x32_bf16 v[116:119], v[60:63], v[164:167], v[116:119]
    ds_read_b128 v[56:59], v1 offset:640
    v_mov_b32 v19, v16
    s_nop 1
    ds_read_b128 v[60:63], v1 offset:704
    s_waitcnt vmcnt(8)
    ds_read_b128 v[168:171], v7 offset:10752
    ds_read_b128 v[172:175], v2 offset:10752
    s_add_u32 m0, s39, 4352
    s_nop 0
    buffer_load_dwordx4 v6, s[4:7], s92 offen offset:256 nt lds
    s_add_u32 m0, s39, 5376
    s_nop 0
    buffer_load_dwordx4 v6, s[4:7], s93 offen offset:256 nt lds
    v_lshlrev_b32 v8, 16, v160
    v_and_b32 v9, 0xffff0000, v160
    v_lshlrev_b32 v10, 16, v161
    v_and_b32 v11, 0xffff0000, v161
    v_mul_f32 v8, s20, v8
    v_mul_f32 v9, s20, v9
    v_mul_f32 v10, s20, v10
    v_mul_f32 v11, s20, v11
    v_cvt_pk_bf16_f32 v160, v8, v9
    v_cvt_pk_bf16_f32 v161, v10, v11
    v_lshlrev_b32 v8, 16, v162
    v_and_b32 v9, 0xffff0000, v162
    v_lshlrev_b32 v10, 16, v163
    v_and_b32 v11, 0xffff0000, v163
    v_mul_f32 v8, s20, v8
    v_mul_f32 v9, s20, v9
    v_mul_f32 v10, s20, v10
    v_mul_f32 v11, s20, v11
    v_cvt_pk_bf16_f32 v162, v8, v9
    v_cvt_pk_bf16_f32 v163, v10, v11
    v_lshlrev_b32 v8, 16, v164
    v_and_b32 v9, 0xffff0000, v164
    v_lshlrev_b32 v10, 16, v165
    v_and_b32 v11, 0xffff0000, v165
    v_mul_f32 v8, s20, v8
    v_mul_f32 v9, s20, v9
    v_mul_f32 v10, s20, v10
    v_mul_f32 v11, s20, v11
    v_cvt_pk_bf16_f32 v164, v8, v9
    v_cvt_pk_bf16_f32 v165, v10, v11
    v_lshlrev_b32 v8, 16, v166
    v_and_b32 v9, 0xffff0000, v166
    v_lshlrev_b32 v10, 16, v167
    v_and_b32 v11, 0xffff0000, v167
    v_mul_f32 v8, s20, v8
    v_mul_f32 v9, s20, v9
    v_mul_f32 v10, s20, v10
    v_mul_f32 v11, s20, v11
    v_cvt_pk_bf16_f32 v166, v8, v9
    v_cvt_pk_bf16_f32 v167, v10, v11
    v_exp_f32 v64, v64
    v_exp_f32 v65, v65
    v_exp_f32 v66, v66
    v_exp_f32 v67, v67
    v_exp_f32 v96, v96
    v_exp_f32 v97, v97
    v_exp_f32 v98, v98
    v_exp_f32 v99, v99
    s_nop 0
    v_add_f32 v12, v12, v64
    v_add_f32 v12, v12, v65
    v_cvt_pk_bf16_f32 v64, v64, v65
    v_add_f32 v12, v12, v66
    s_waitcnt lgkmcnt(0)
    v_mfma_f32_16x16x32_bf16 v[68:71], v[32:35], v[168:171], v[68:71]
    v_add_f32 v12, v12, v67
    v_mfma_f32_16x16x32_bf16 v[68:71], v[36:39], v[172:175], v[68:71]
    ds_read_b128 v[32:35], v4 offset:256
    v_cvt_pk_bf16_f32 v65, v66, v67
    v_mfma_f32_16x16x32_bf16 v[100:103], v[40:43], v[168:171], v[100:103]
    ds_read_b128 v[36:39], v4 offset:320
    v_add_f32 v12, v12, v96
    v_mfma_f32_16x16x32_bf16 v[100:103], v[44:47], v[172:175], v[100:103]
    ds_read_b128 v[40:43], v4 offset:768
    v_cvt_pk_bf16_f32 v66, v96, v97
    v_mfma_f32_16x16x32_bf16 v[84:87], v[48:51], v[168:171], v[84:87]
    ds_read_b128 v[44:47], v4 offset:832
    v_add_f32 v12, v12, v97
    v_mfma_f32_16x16x32_bf16 v[84:87], v[52:55], v[172:175], v[84:87]
    ds_read_b128 v[48:51], v1 offset:256
    v_add_f32 v12, v12, v98
    v_mfma_f32_16x16x32_bf16 v[116:119], v[56:59], v[168:171], v[116:119]
    ds_read_b128 v[52:55], v1 offset:320
    v_cvt_pk_bf16_f32 v67, v98, v99
    v_mfma_f32_16x16x32_bf16 v[116:119], v[60:63], v[172:175], v[116:119]
    ds_read_b128 v[56:59], v1 offset:768
    v_add_f32 v12, v12, v99
    s_nop 1
    ds_read_b128 v[60:63], v1 offset:832
    s_waitcnt vmcnt(8)
    ds_read_b128 v[176:179], v7 offset:12800
    ds_read_b128 v[180:183], v2 offset:12800
    s_add_u32 m0, s39, 6272
    s_nop 0
    buffer_load_dwordx4 v6, s[4:7], s92 offen offset:384 nt lds
    s_add_u32 m0, s39, 7296
    s_nop 0
    buffer_load_dwordx4 v6, s[4:7], s93 offen offset:384 nt lds
    v_lshlrev_b32 v8, 16, v168
    v_and_b32 v9, 0xffff0000, v168
    v_lshlrev_b32 v10, 16, v169
    v_and_b32 v11, 0xffff0000, v169
    v_mul_f32 v8, s20, v8
    v_mul_f32 v9, s20, v9
    v_mul_f32 v10, s20, v10
    v_mul_f32 v11, s20, v11
    v_cvt_pk_bf16_f32 v168, v8, v9
    v_cvt_pk_bf16_f32 v169, v10, v11
    v_lshlrev_b32 v8, 16, v170
    v_and_b32 v9, 0xffff0000, v170
    v_lshlrev_b32 v10, 16, v171
    v_and_b32 v11, 0xffff0000, v171
    v_mul_f32 v8, s20, v8
    v_mul_f32 v9, s20, v9
    v_mul_f32 v10, s20, v10
    v_mul_f32 v11, s20, v11
    v_cvt_pk_bf16_f32 v170, v8, v9
    v_cvt_pk_bf16_f32 v171, v10, v11
    v_lshlrev_b32 v8, 16, v172
    v_and_b32 v9, 0xffff0000, v172
    v_lshlrev_b32 v10, 16, v173
    v_and_b32 v11, 0xffff0000, v173
    v_mul_f32 v8, s20, v8
    v_mul_f32 v9, s20, v9
    v_mul_f32 v10, s20, v10
    v_mul_f32 v11, s20, v11
    v_cvt_pk_bf16_f32 v172, v8, v9
    v_cvt_pk_bf16_f32 v173, v10, v11
    v_lshlrev_b32 v8, 16, v174
    v_and_b32 v9, 0xffff0000, v174
    v_lshlrev_b32 v10, 16, v175
    v_and_b32 v11, 0xffff0000, v175
    v_mul_f32 v8, s20, v8
    v_mul_f32 v9, s20, v9
    v_mul_f32 v10, s20, v10
    v_mul_f32 v11, s20, v11
    v_cvt_pk_bf16_f32 v174, v8, v9
    v_cvt_pk_bf16_f32 v175, v10, v11
    v_exp_f32 v80, v80
    v_exp_f32 v81, v81
    v_exp_f32 v82, v82
    v_exp_f32 v83, v83
    v_exp_f32 v112, v112
    v_exp_f32 v113, v113
    v_exp_f32 v114, v114
    v_exp_f32 v115, v115
    s_nop 0
    v_add_f32 v12, v12, v80
    v_add_f32 v12, v12, v81
    v_cvt_pk_bf16_f32 v80, v80, v81
    v_add_f32 v12, v12, v82
    s_waitcnt lgkmcnt(0)
    v_mfma_f32_16x16x32_bf16 v[68:71], v[32:35], v[176:179], v[68:71]
    v_add_f32 v12, v12, v83
    v_mfma_f32_16x16x32_bf16 v[68:71], v[36:39], v[180:183], v[68:71]
    ds_read_b128 v[32:35], v4 offset:384
    v_cvt_pk_bf16_f32 v81, v82, v83
    v_mfma_f32_16x16x32_bf16 v[100:103], v[40:43], v[176:179], v[100:103]
    ds_read_b128 v[36:39], v4 offset:448
    v_add_f32 v12, v12, v112
    v_mfma_f32_16x16x32_bf16 v[100:103], v[44:47], v[180:183], v[100:103]
    ds_read_b128 v[40:43], v4 offset:896
    v_cvt_pk_bf16_f32 v82, v112, v113
    v_mfma_f32_16x16x32_bf16 v[84:87], v[48:51], v[176:179], v[84:87]
    ds_read_b128 v[44:47], v4 offset:960
    v_add_f32 v12, v12, v113
    v_mfma_f32_16x16x32_bf16 v[84:87], v[52:55], v[180:183], v[84:87]
    ds_read_b128 v[48:51], v1 offset:384
    v_add_f32 v12, v12, v114
    v_mfma_f32_16x16x32_bf16 v[116:119], v[56:59], v[176:179], v[116:119]
    ds_read_b128 v[52:55], v1 offset:448
    v_cvt_pk_bf16_f32 v83, v114, v115
    v_mfma_f32_16x16x32_bf16 v[116:119], v[60:63], v[180:183], v[116:119]
    ds_read_b128 v[56:59], v1 offset:896
    v_add_f32 v12, v12, v115
    s_nop 1
    ds_read_b128 v[60:63], v1 offset:960
    s_waitcnt vmcnt(8)
    ds_read_b128 v[184:187], v7 offset:14848
    ds_read_b128 v[188:191], v2 offset:14848
    s_add_u32 m0, s39, 8704
    s_nop 0
    buffer_load_dwordx4 v6, s[4:7], s94 offen offset:0 nt lds
    s_add_u32 m0, s39, 9728
    s_nop 0
    buffer_load_dwordx4 v6, s[4:7], s95 offen offset:0 nt lds
    v_lshlrev_b32 v8, 16, v176
    v_and_b32 v9, 0xffff0000, v176
    v_lshlrev_b32 v10, 16, v177
    v_and_b32 v11, 0xffff0000, v177
    v_mul_f32 v8, s20, v8
    v_mul_f32 v9, s20, v9
    v_mul_f32 v10, s20, v10
    v_mul_f32 v11, s20, v11
    v_cvt_pk_bf16_f32 v176, v8, v9
    v_cvt_pk_bf16_f32 v177, v10, v11
    v_lshlrev_b32 v8, 16, v178
    v_and_b32 v9, 0xffff0000, v178
    v_lshlrev_b32 v10, 16, v179
    v_and_b32 v11, 0xffff0000, v179
    v_mul_f32 v8, s20, v8
    v_mul_f32 v9, s20, v9
    v_mul_f32 v10, s20, v10
    v_mul_f32 v11, s20, v11
    v_cvt_pk_bf16_f32 v178, v8, v9
    v_cvt_pk_bf16_f32 v179, v10, v11
    v_lshlrev_b32 v8, 16, v180
    v_and_b32 v9, 0xffff0000, v180
    v_lshlrev_b32 v10, 16, v181
    v_and_b32 v11, 0xffff0000, v181
    v_mul_f32 v8, s20, v8
    v_mul_f32 v9, s20, v9
    v_mul_f32 v10, s20, v10
    v_mul_f32 v11, s20, v11
    v_cvt_pk_bf16_f32 v180, v8, v9
    v_cvt_pk_bf16_f32 v181, v10, v11
    v_lshlrev_b32 v8, 16, v182
    v_and_b32 v9, 0xffff0000, v182
    s_waitcnt lgkmcnt(0)
    v_mfma_f32_16x16x32_bf16 v[68:71], v[32:35], v[184:187], v[68:71]
    v_lshlrev_b32 v10, 16, v183
    v_mfma_f32_16x16x32_bf16 v[68:71], v[36:39], v[188:191], v[68:71]
    ds_read_b128 v[32:35], v4 offset:0
    v_and_b32 v11, 0xffff0000, v183
    v_mfma_f32_16x16x32_bf16 v[100:103], v[40:43], v[184:187], v[100:103]
    ds_read_b128 v[36:39], v4 offset:64
    v_mul_f32 v8, s20, v8
    v_mfma_f32_16x16x32_bf16 v[100:103], v[44:47], v[188:191], v[100:103]
    ds_read_b128 v[40:43], v4 offset:512
    v_mul_f32 v9, s20, v9
    v_mfma_f32_16x16x32_bf16 v[84:87], v[48:51], v[184:187], v[84:87]
    ds_read_b128 v[44:47], v4 offset:576
    v_mul_f32 v10, s20, v10
    v_mfma_f32_16x16x32_bf16 v[84:87], v[52:55], v[188:191], v[84:87]
    ds_read_b128 v[48:51], v1 offset:0
    v_mul_f32 v11, s20, v11
    v_mfma_f32_16x16x32_bf16 v[116:119], v[56:59], v[184:187], v[116:119]
    ds_read_b128 v[52:55], v1 offset:64
    v_cvt_pk_bf16_f32 v182, v8, v9
    v_mfma_f32_16x16x32_bf16 v[116:119], v[60:63], v[188:191], v[116:119]
    ds_read_b128 v[56:59], v1 offset:512
    v_cvt_pk_bf16_f32 v183, v10, v11
    s_nop 1
    ds_read_b128 v[60:63], v1 offset:576
    s_waitcnt vmcnt(8)
    ds_read_b128 v[192:195], v7 offset:512
    ds_read_b128 v[196:199], v2 offset:512
    s_add_u32 m0, s39, 10624
    s_nop 0
    buffer_load_dwordx4 v6, s[4:7], s94 offen offset:128 nt lds
    s_add_u32 m0, s39, 11648
    s_nop 0
    buffer_load_dwordx4 v6, s[4:7], s95 offen offset:128 nt lds
    v_lshlrev_b32 v8, 16, v184
    v_and_b32 v9, 0xffff0000, v184
    v_lshlrev_b32 v10, 16, v185
    v_and_b32 v11, 0xffff0000, v185
    v_mul_f32 v8, s20, v8
    v_mul_f32 v9, s20, v9
    v_mul_f32 v10, s20, v10
    v_mul_f32 v11, s20, v11
    v_cvt_pk_bf16_f32 v184, v8, v9
    v_cvt_pk_bf16_f32 v185, v10, v11
    v_lshlrev_b32 v8, 16, v186
    v_and_b32 v9, 0xffff0000, v186
    v_lshlrev_b32 v10, 16, v187
    v_and_b32 v11, 0xffff0000, v187
    v_mul_f32 v8, s20, v8
    v_mul_f32 v9, s20, v9
    v_mul_f32 v10, s20, v10
    v_mul_f32 v11, s20, v11
    v_cvt_pk_bf16_f32 v186, v8, v9
    v_cvt_pk_bf16_f32 v187, v10, v11
    v_lshlrev_b32 v8, 16, v188
    v_and_b32 v9, 0xffff0000, v188
    v_lshlrev_b32 v10, 16, v189
    v_and_b32 v11, 0xffff0000, v189
    v_mul_f32 v8, s20, v8
    v_mul_f32 v9, s20, v9
    v_mul_f32 v10, s20, v10
    v_mul_f32 v11, s20, v11
    v_cvt_pk_bf16_f32 v188, v8, v9
    v_cvt_pk_bf16_f32 v189, v10, v11
    v_lshlrev_b32 v8, 16, v190
    v_and_b32 v9, 0xffff0000, v190
    v_lshlrev_b32 v10, 16, v191
    v_and_b32 v11, 0xffff0000, v191
    v_mul_f32 v8, s20, v8
    v_mul_f32 v9, s20, v9
    v_mul_f32 v10, s20, v10
    v_mul_f32 v11, s20, v11
    v_cvt_pk_bf16_f32 v190, v8, v9
    v_cvt_pk_bf16_f32 v191, v10, v11
    v_max3_f32 v8, v68, v69, v70
    v_max3_f32 v8, v8, v71, v100
    v_max3_f32 v8, v8, v101, v102
    v_max3_f32 v8, v8, v103, v84
    v_max3_f32 v8, v8, v85, v86
    v_max3_f32 v8, v8, v87, v116
    v_max3_f32 v8, v8, v117, v118
    v_max_f32 v8, v8, v119
    v_mov_b32 v9, v8
    s_nop 1
    v_permlane16_swap_b32 v8, v9
    v_max_f32 v8, v8, v9
    v_mov_b32 v9, v8
    s_nop 1
    v_permlane32_swap_b32 v8, v9
    v_max_f32 v8, v8, v9
    v_mul_f32 v20, -v8, s20
    v_fma_f32 v68, v68, s20, v20
    v_fma_f32 v69, v69, s20, v20
    v_fma_f32 v70, v70, s20, v20
    v_fma_f32 v71, v71, s20, v20
    v_fma_f32 v100, v100, s20, v20
    v_fma_f32 v101, v101, s20, v20
    v_fma_f32 v102, v102, s20, v20
    v_fma_f32 v103, v103, s20, v20
    v_fma_f32 v84, v84, s20, v20
    v_fma_f32 v85, v85, s20, v20
    v_fma_f32 v86, v86, s20, v20
    s_waitcnt lgkmcnt(0)
    v_mfma_f32_16x16x32_bf16 v[72:75], v[32:35], v[192:195], 0
    v_fma_f32 v87, v87, s20, v20
    v_mfma_f32_16x16x32_bf16 v[72:75], v[36:39], v[196:199], v[72:75]
    ds_read_b128 v[32:35], v4 offset:128
    v_fma_f32 v116, v116, s20, v20
    v_mfma_f32_16x16x32_bf16 v[104:107], v[40:43], v[192:195], 0
    ds_read_b128 v[36:39], v4 offset:192
    v_fma_f32 v117, v117, s20, v20
    v_mfma_f32_16x16x32_bf16 v[104:107], v[44:47], v[196:199], v[104:107]
    ds_read_b128 v[40:43], v4 offset:640
    v_fma_f32 v118, v118, s20, v20
    v_mfma_f32_16x16x32_bf16 v[88:91], v[48:51], v[192:195], 0
    ds_read_b128 v[44:47], v4 offset:704
    v_fma_f32 v119, v119, s20, v20
    v_mfma_f32_16x16x32_bf16 v[88:91], v[52:55], v[196:199], v[88:91]
    ds_read_b128 v[48:51], v1 offset:128
    v_mov_b32 v21, v20
    v_mfma_f32_16x16x32_bf16 v[120:123], v[56:59], v[192:195], 0
    ds_read_b128 v[52:55], v1 offset:192
    v_mov_b32 v22, v20
    v_mfma_f32_16x16x32_bf16 v[120:123], v[60:63], v[196:199], v[120:123]
    ds_read_b128 v[56:59], v1 offset:640
    v_mov_b32 v23, v20
    s_nop 1
    ds_read_b128 v[60:63], v1 offset:704
    s_waitcnt vmcnt(8)
    ds_read_b128 v[200:203], v7 offset:2560
    ds_read_b128 v[204:207], v2 offset:2560
    s_add_u32 m0, s39, 12544
    s_nop 0
    buffer_load_dwordx4 v6, s[4:7], s94 offen offset:256 nt lds
    s_add_u32 m0, s39, 13568
    s_nop 0
    buffer_load_dwordx4 v6, s[4:7], s95 offen offset:256 nt lds
    v_lshlrev_b32 v8, 16, v192
    v_and_b32 v9, 0xffff0000, v192
    v_lshlrev_b32 v10, 16, v193
    v_and_b32 v11, 0xffff0000, v193
    v_mul_f32 v8, s20, v8
    v_mul_f32 v9, s20, v9
    v_mul_f32 v10, s20, v10
    v_mul_f32 v11, s20, v11
    v_cvt_pk_bf16_f32 v192, v8, v9
    v_cvt_pk_bf16_f32 v193, v10, v11
    v_lshlrev_b32 v8, 16, v194
    v_and_b32 v9, 0xffff0000, v194
    v_lshlrev_b32 v10, 16, v195
    v_and_b32 v11, 0xffff0000, v195
    v_mul_f32 v8, s20, v8
    v_mul_f32 v9, s20, v9
    v_mul_f32 v10, s20, v10
    v_mul_f32 v11, s20, v11
    v_cvt_pk_bf16_f32 v194, v8, v9
    v_cvt_pk_bf16_f32 v195, v10, v11
    v_lshlrev_b32 v8, 16, v196
    v_and_b32 v9, 0xffff0000, v196
    v_lshlrev_b32 v10, 16, v197
    v_and_b32 v11, 0xffff0000, v197
    v_mul_f32 v8, s20, v8
    v_mul_f32 v9, s20, v9
    v_mul_f32 v10, s20, v10
    v_mul_f32 v11, s20, v11
    v_cvt_pk_bf16_f32 v196, v8, v9
    v_cvt_pk_bf16_f32 v197, v10, v11
    v_lshlrev_b32 v8, 16, v198
    v_and_b32 v9, 0xffff0000, v198
    v_lshlrev_b32 v10, 16, v199
    v_and_b32 v11, 0xffff0000, v199
    v_mul_f32 v8, s20, v8
    v_mul_f32 v9, s20, v9
    v_mul_f32 v10, s20, v10
    v_mul_f32 v11, s20, v11
    v_cvt_pk_bf16_f32 v198, v8, v9
    v_cvt_pk_bf16_f32 v199, v10, v11
    v_exp_f32 v68, v68
    v_exp_f32 v69, v69
    v_exp_f32 v70, v70
    v_exp_f32 v71, v71
    v_exp_f32 v100, v100
    v_exp_f32 v101, v101
    v_exp_f32 v102, v102
    v_exp_f32 v103, v103
    s_nop 0
    v_add_f32 v13, v13, v68
    v_add_f32 v13, v13, v69
    v_cvt_pk_bf16_f32 v68, v68, v69
    v_add_f32 v13, v13, v70
    s_waitcnt lgkmcnt(0)
    v_mfma_f32_16x16x32_bf16 v[72:75], v[32:35], v[200:203], v[72:75]
    v_add_f32 v13, v13, v71
    v_mfma_f32_16x16x32_bf16 v[72:75], v[36:39], v[204:207], v[72:75]
    ds_read_b128 v[32:35], v4 offset:256
    v_cvt_pk_bf16_f32 v69, v70, v71
    v_mfma_f32_16x16x32_bf16 v[104:107], v[40:43], v[200:203], v[104:107]
    ds_read_b128 v[36:39], v4 offset:320
    v_add_f32 v13, v13, v100
    v_mfma_f32_16x16x32_bf16 v[104:107], v[44:47], v[204:207], v[104:107]
    ds_read_b128 v[40:43], v4 offset:768
    v_cvt_pk_bf16_f32 v70, v100, v101
    v_mfma_f32_16x16x32_bf16 v[88:91], v[48:51], v[200:203], v[88:91]
    ds_read_b128 v[44:47], v4 offset:832
    v_add_f32 v13, v13, v101
    v_mfma_f32_16x16x32_bf16 v[88:91], v[52:55], v[204:207], v[88:91]
    ds_read_b128 v[48:51], v1 offset:256
    v_add_f32 v13, v13, v102
    v_mfma_f32_16x16x32_bf16 v[120:123], v[56:59], v[200:203], v[120:123]
    ds_read_b128 v[52:55], v1 offset:320
    v_cvt_pk_bf16_f32 v71, v102, v103
    v_mfma_f32_16x16x32_bf16 v[120:123], v[60:63], v[204:207], v[120:123]
    ds_read_b128 v[56:59], v1 offset:768
    v_add_f32 v13, v13, v103
    s_nop 1
    ds_read_b128 v[60:63], v1 offset:832
    s_waitcnt vmcnt(8)
    ds_read_b128 v[208:211], v7 offset:4608
    ds_read_b128 v[212:215], v2 offset:4608
    s_add_u32 m0, s39, 14464
    s_nop 0
    buffer_load_dwordx4 v6, s[4:7], s94 offen offset:384 nt lds
    s_add_u32 m0, s39, 15488
    s_nop 0
    buffer_load_dwordx4 v6, s[4:7], s95 offen offset:384 nt lds
    v_lshlrev_b32 v8, 16, v200
    v_and_b32 v9, 0xffff0000, v200
    v_lshlrev_b32 v10, 16, v201
    v_and_b32 v11, 0xffff0000, v201
    v_mul_f32 v8, s20, v8
    v_mul_f32 v9, s20, v9
    v_mul_f32 v10, s20, v10
    v_mul_f32 v11, s20, v11
    v_cvt_pk_bf16_f32 v200, v8, v9
    v_cvt_pk_bf16_f32 v201, v10, v11
    v_lshlrev_b32 v8, 16, v202
    v_and_b32 v9, 0xffff0000, v202
    v_lshlrev_b32 v10, 16, v203
    v_and_b32 v11, 0xffff0000, v203
    v_mul_f32 v8, s20, v8
    v_mul_f32 v9, s20, v9
    v_mul_f32 v10, s20, v10
    v_mul_f32 v11, s20, v11
    v_cvt_pk_bf16_f32 v202, v8, v9
    v_cvt_pk_bf16_f32 v203, v10, v11
    v_lshlrev_b32 v8, 16, v204
    v_and_b32 v9, 0xffff0000, v204
    v_lshlrev_b32 v10, 16, v205
    v_and_b32 v11, 0xffff0000, v205
    v_mul_f32 v8, s20, v8
    v_mul_f32 v9, s20, v9
    v_mul_f32 v10, s20, v10
    v_mul_f32 v11, s20, v11
    v_cvt_pk_bf16_f32 v204, v8, v9
    v_cvt_pk_bf16_f32 v205, v10, v11
    v_lshlrev_b32 v8, 16, v206
    v_and_b32 v9, 0xffff0000, v206
    v_lshlrev_b32 v10, 16, v207
    v_and_b32 v11, 0xffff0000, v207
    v_mul_f32 v8, s20, v8
    v_mul_f32 v9, s20, v9
    v_mul_f32 v10, s20, v10
    v_mul_f32 v11, s20, v11
    v_cvt_pk_bf16_f32 v206, v8, v9
    v_cvt_pk_bf16_f32 v207, v10, v11
    v_exp_f32 v84, v84
    v_exp_f32 v85, v85
    v_exp_f32 v86, v86
    v_exp_f32 v87, v87
    v_exp_f32 v116, v116
    v_exp_f32 v117, v117
    v_exp_f32 v118, v118
    v_exp_f32 v119, v119
    s_nop 0
    v_add_f32 v13, v13, v84
    v_add_f32 v13, v13, v85
    v_cvt_pk_bf16_f32 v84, v84, v85
    v_add_f32 v13, v13, v86
    s_waitcnt lgkmcnt(0)
    v_mfma_f32_16x16x32_bf16 v[72:75], v[32:35], v[208:211], v[72:75]
    v_add_f32 v13, v13, v87
    v_mfma_f32_16x16x32_bf16 v[72:75], v[36:39], v[212:215], v[72:75]
    ds_read_b128 v[32:35], v4 offset:384
    v_cvt_pk_bf16_f32 v85, v86, v87
    v_mfma_f32_16x16x32_bf16 v[104:107], v[40:43], v[208:211], v[104:107]
    ds_read_b128 v[36:39], v4 offset:448
    v_add_f32 v13, v13, v116
    v_mfma_f32_16x16x32_bf16 v[104:107], v[44:47], v[212:215], v[104:107]
    ds_read_b128 v[40:43], v4 offset:896
    v_cvt_pk_bf16_f32 v86, v116, v117
    v_mfma_f32_16x16x32_bf16 v[88:91], v[48:51], v[208:211], v[88:91]
    ds_read_b128 v[44:47], v4 offset:960
    v_add_f32 v13, v13, v117
    v_mfma_f32_16x16x32_bf16 v[88:91], v[52:55], v[212:215], v[88:91]
    ds_read_b128 v[48:51], v1 offset:384
    v_add_f32 v13, v13, v118
    v_mfma_f32_16x16x32_bf16 v[120:123], v[56:59], v[208:211], v[120:123]
    ds_read_b128 v[52:55], v1 offset:448
    v_cvt_pk_bf16_f32 v87, v118, v119
    v_mfma_f32_16x16x32_bf16 v[120:123], v[60:63], v[212:215], v[120:123]
    ds_read_b128 v[56:59], v1 offset:896
    v_add_f32 v13, v13, v119
    s_nop 1
    ds_read_b128 v[60:63], v1 offset:960
    s_waitcnt vmcnt(8)
    ds_read_b128 v[216:219], v7 offset:6656
    ds_read_b128 v[220:223], v2 offset:6656
    s_add_u32 m0, s30, 16896
    s_nop 0
    buffer_load_dwordx4 v5, s[8:11], s32 offen offset:0 nt lds
    s_add_u32 m0, s30, 17440
    s_nop 0
    buffer_load_dwordx4 v5, s[8:11], s32 offen offset:512 nt lds
    v_lshlrev_b32 v8, 16, v208
    v_and_b32 v9, 0xffff0000, v208
    v_lshlrev_b32 v10, 16, v209
    v_and_b32 v11, 0xffff0000, v209
    v_mul_f32 v8, s20, v8
    v_mul_f32 v9, s20, v9
    v_mul_f32 v10, s20, v10
    v_mul_f32 v11, s20, v11
    v_cvt_pk_bf16_f32 v208, v8, v9
    v_cvt_pk_bf16_f32 v209, v10, v11
    v_lshlrev_b32 v8, 16, v210
    v_and_b32 v9, 0xffff0000, v210
    v_lshlrev_b32 v10, 16, v211
    v_and_b32 v11, 0xffff0000, v211
    v_mul_f32 v8, s20, v8
    v_mul_f32 v9, s20, v9
    v_mul_f32 v10, s20, v10
    v_mul_f32 v11, s20, v11
    v_cvt_pk_bf16_f32 v210, v8, v9
    v_cvt_pk_bf16_f32 v211, v10, v11
    v_lshlrev_b32 v8, 16, v212
    v_and_b32 v9, 0xffff0000, v212
    v_lshlrev_b32 v10, 16, v213
    v_and_b32 v11, 0xffff0000, v213
    v_mul_f32 v8, s20, v8
    v_mul_f32 v9, s20, v9
    v_mul_f32 v10, s20, v10
    v_mul_f32 v11, s20, v11
    v_cvt_pk_bf16_f32 v212, v8, v9
    v_cvt_pk_bf16_f32 v213, v10, v11
    v_lshlrev_b32 v8, 16, v214
    v_and_b32 v9, 0xffff0000, v214
    s_waitcnt lgkmcnt(0)
    v_mfma_f32_16x16x32_bf16 v[72:75], v[32:35], v[216:219], v[72:75]
    v_lshlrev_b32 v10, 16, v215
    v_mfma_f32_16x16x32_bf16 v[72:75], v[36:39], v[220:223], v[72:75]
    ds_read_b128 v[32:35], v4 offset:0
    v_and_b32 v11, 0xffff0000, v215
    v_mfma_f32_16x16x32_bf16 v[104:107], v[40:43], v[216:219], v[104:107]
    ds_read_b128 v[36:39], v4 offset:64
    v_mul_f32 v8, s20, v8
    v_mfma_f32_16x16x32_bf16 v[104:107], v[44:47], v[220:223], v[104:107]
    ds_read_b128 v[40:43], v4 offset:512
    v_mul_f32 v9, s20, v9
    v_mfma_f32_16x16x32_bf16 v[88:91], v[48:51], v[216:219], v[88:91]
    ds_read_b128 v[44:47], v4 offset:576
    v_mul_f32 v10, s20, v10
    v_mfma_f32_16x16x32_bf16 v[88:91], v[52:55], v[220:223], v[88:91]
    ds_read_b128 v[48:51], v1 offset:0
    v_mul_f32 v11, s20, v11
    v_mfma_f32_16x16x32_bf16 v[120:123], v[56:59], v[216:219], v[120:123]
    ds_read_b128 v[52:55], v1 offset:64
    v_cvt_pk_bf16_f32 v214, v8, v9
    v_mfma_f32_16x16x32_bf16 v[120:123], v[60:63], v[220:223], v[120:123]
    ds_read_b128 v[56:59], v1 offset:512
    v_cvt_pk_bf16_f32 v215, v10, v11
    s_nop 1
    ds_read_b128 v[60:63], v1 offset:576
    s_waitcnt vmcnt(8)
    ds_read_b128 v[224:227], v7 offset:8704
    ds_read_b128 v[228:231], v2 offset:8704
    s_add_u32 m0, s30, 17984
    s_nop 0
    buffer_load_dwordx4 v5, s[8:11], s32 offen offset:1024 nt lds
    s_add_u32 m0, s30, 18528
    s_nop 0
    buffer_load_dwordx4 v5, s[8:11], s32 offen offset:1536 nt lds
    v_lshlrev_b32 v8, 16, v216
    v_and_b32 v9, 0xffff0000, v216
    v_lshlrev_b32 v10, 16, v217
    v_and_b32 v11, 0xffff0000, v217
    v_mul_f32 v8, s20, v8
    v_mul_f32 v9, s20, v9
    v_mul_f32 v10, s20, v10
    v_mul_f32 v11, s20, v11
    v_cvt_pk_bf16_f32 v216, v8, v9
    v_cvt_pk_bf16_f32 v217, v10, v11
    v_lshlrev_b32 v8, 16, v218
    v_and_b32 v9, 0xffff0000, v218
    v_lshlrev_b32 v10, 16, v219
    v_and_b32 v11, 0xffff0000, v219
    v_mul_f32 v8, s20, v8
    v_mul_f32 v9, s20, v9
    v_mul_f32 v10, s20, v10
    v_mul_f32 v11, s20, v11
    v_cvt_pk_bf16_f32 v218, v8, v9
    v_cvt_pk_bf16_f32 v219, v10, v11
    v_lshlrev_b32 v8, 16, v220
    v_and_b32 v9, 0xffff0000, v220
    v_lshlrev_b32 v10, 16, v221
    v_and_b32 v11, 0xffff0000, v221
    v_mul_f32 v8, s20, v8
    v_mul_f32 v9, s20, v9
    v_mul_f32 v10, s20, v10
    v_mul_f32 v11, s20, v11
    v_cvt_pk_bf16_f32 v220, v8, v9
    v_cvt_pk_bf16_f32 v221, v10, v11
    v_lshlrev_b32 v8, 16, v222
    v_and_b32 v9, 0xffff0000, v222
    v_lshlrev_b32 v10, 16, v223
    v_and_b32 v11, 0xffff0000, v223
    v_mul_f32 v8, s20, v8
    v_mul_f32 v9, s20, v9
    v_mul_f32 v10, s20, v10
    v_mul_f32 v11, s20, v11
    v_cvt_pk_bf16_f32 v222, v8, v9
    v_cvt_pk_bf16_f32 v223, v10, v11
    v_max3_f32 v8, v72, v73, v74
    v_max3_f32 v8, v8, v75, v104
    v_max3_f32 v8, v8, v105, v106
    v_max3_f32 v8, v8, v107, v88
    v_max3_f32 v8, v8, v89, v90
    v_max3_f32 v8, v8, v91, v120
    v_max3_f32 v8, v8, v121, v122
    v_max_f32 v8, v8, v123
    v_mov_b32 v9, v8
    s_nop 1
    v_permlane16_swap_b32 v8, v9
    v_max_f32 v8, v8, v9
    v_mov_b32 v9, v8
    s_nop 1
    v_permlane32_swap_b32 v8, v9
    v_max_f32 v8, v8, v9
    v_mul_f32 v24, -v8, s20
    v_fma_f32 v72, v72, s20, v24
    v_fma_f32 v73, v73, s20, v24
    v_fma_f32 v74, v74, s20, v24
    v_fma_f32 v75, v75, s20, v24
    v_fma_f32 v104, v104, s20, v24
    v_fma_f32 v105, v105, s20, v24
    v_fma_f32 v106, v106, s20, v24
    v_fma_f32 v107, v107, s20, v24
    v_fma_f32 v88, v88, s20, v24
    v_fma_f32 v89, v89, s20, v24
    v_fma_f32 v90, v90, s20, v24
    s_waitcnt lgkmcnt(0)
    v_mfma_f32_16x16x32_bf16 v[76:79], v[32:35], v[224:227], 0
    v_fma_f32 v91, v91, s20, v24
    v_mfma_f32_16x16x32_bf16 v[76:79], v[36:39], v[228:231], v[76:79]
    ds_read_b128 v[32:35], v4 offset:128
    v_fma_f32 v120, v120, s20, v24
    v_mfma_f32_16x16x32_bf16 v[108:111], v[40:43], v[224:227], 0
    ds_read_b128 v[36:39], v4 offset:192
    v_fma_f32 v121, v121, s20, v24
    v_mfma_f32_16x16x32_bf16 v[108:111], v[44:47], v[228:231], v[108:111]
    ds_read_b128 v[40:43], v4 offset:640
    v_fma_f32 v122, v122, s20, v24
    v_mfma_f32_16x16x32_bf16 v[92:95], v[48:51], v[224:227], 0
    ds_read_b128 v[44:47], v4 offset:704
    v_fma_f32 v123, v123, s20, v24
    v_mfma_f32_16x16x32_bf16 v[92:95], v[52:55], v[228:231], v[92:95]
    ds_read_b128 v[48:51], v1 offset:128
    v_mov_b32 v25, v24
    v_mfma_f32_16x16x32_bf16 v[124:127], v[56:59], v[224:227], 0
    ds_read_b128 v[52:55], v1 offset:192
    v_mov_b32 v26, v24
    v_mfma_f32_16x16x32_bf16 v[124:127], v[60:63], v[228:231], v[124:127]
    ds_read_b128 v[56:59], v1 offset:640
    v_mov_b32 v27, v24
    s_nop 1
    ds_read_b128 v[60:63], v1 offset:704
    s_waitcnt vmcnt(8)
    ds_read_b128 v[232:235], v7 offset:10752
    ds_read_b128 v[236:239], v2 offset:10752
    s_add_u32 m0, s30, 101376
    s_nop 0
    buffer_load_dwordx4 v5, s[12:15], 0 offen offset:0 nt lds
    s_add_u32 m0, s30, 101920
    s_nop 0
    buffer_load_dwordx4 v5, s[12:15], 0 offen offset:512 nt lds
    v_lshlrev_b32 v8, 16, v224
    v_and_b32 v9, 0xffff0000, v224
    v_lshlrev_b32 v10, 16, v225
    v_and_b32 v11, 0xffff0000, v225
    v_mul_f32 v8, s20, v8
    v_mul_f32 v9, s20, v9
    v_mul_f32 v10, s20, v10
    v_mul_f32 v11, s20, v11
    v_cvt_pk_bf16_f32 v224, v8, v9
    v_cvt_pk_bf16_f32 v225, v10, v11
    v_lshlrev_b32 v8, 16, v226
    v_and_b32 v9, 0xffff0000, v226
    v_lshlrev_b32 v10, 16, v227
    v_and_b32 v11, 0xffff0000, v227
    v_mul_f32 v8, s20, v8
    v_mul_f32 v9, s20, v9
    v_mul_f32 v10, s20, v10
    v_mul_f32 v11, s20, v11
    v_cvt_pk_bf16_f32 v226, v8, v9
    v_cvt_pk_bf16_f32 v227, v10, v11
    v_lshlrev_b32 v8, 16, v228
    v_and_b32 v9, 0xffff0000, v228
    v_lshlrev_b32 v10, 16, v229
    v_and_b32 v11, 0xffff0000, v229
    v_mul_f32 v8, s20, v8
    v_mul_f32 v9, s20, v9
    v_mul_f32 v10, s20, v10
    v_mul_f32 v11, s20, v11
    v_cvt_pk_bf16_f32 v228, v8, v9
    v_cvt_pk_bf16_f32 v229, v10, v11
    v_lshlrev_b32 v8, 16, v230
    v_and_b32 v9, 0xffff0000, v230
    v_lshlrev_b32 v10, 16, v231
    v_and_b32 v11, 0xffff0000, v231
    v_mul_f32 v8, s20, v8
    v_mul_f32 v9, s20, v9
    v_mul_f32 v10, s20, v10
    v_mul_f32 v11, s20, v11
    v_cvt_pk_bf16_f32 v230, v8, v9
    v_cvt_pk_bf16_f32 v231, v10, v11
    v_exp_f32 v72, v72
    v_exp_f32 v73, v73
    v_exp_f32 v74, v74
    v_exp_f32 v75, v75
    v_exp_f32 v104, v104
    v_exp_f32 v105, v105
    v_exp_f32 v106, v106
    v_exp_f32 v107, v107
    s_nop 0
    v_add_f32 v14, v14, v72
    v_add_f32 v14, v14, v73
    v_cvt_pk_bf16_f32 v72, v72, v73
    v_add_f32 v14, v14, v74
    s_waitcnt lgkmcnt(0)
    v_mfma_f32_16x16x32_bf16 v[76:79], v[32:35], v[232:235], v[76:79]
    v_add_f32 v14, v14, v75
    v_mfma_f32_16x16x32_bf16 v[76:79], v[36:39], v[236:239], v[76:79]
    ds_read_b128 v[32:35], v4 offset:256
    v_cvt_pk_bf16_f32 v73, v74, v75
    v_mfma_f32_16x16x32_bf16 v[108:111], v[40:43], v[232:235], v[108:111]
    ds_read_b128 v[36:39], v4 offset:320
    v_add_f32 v14, v14, v104
    v_mfma_f32_16x16x32_bf16 v[108:111], v[44:47], v[236:239], v[108:111]
    ds_read_b128 v[40:43], v4 offset:768
    v_cvt_pk_bf16_f32 v74, v104, v105
    v_mfma_f32_16x16x32_bf16 v[92:95], v[48:51], v[232:235], v[92:95]
    ds_read_b128 v[44:47], v4 offset:832
    v_add_f32 v14, v14, v105
    v_mfma_f32_16x16x32_bf16 v[92:95], v[52:55], v[236:239], v[92:95]
    ds_read_b128 v[48:51], v1 offset:256
    v_add_f32 v14, v14, v106
    v_mfma_f32_16x16x32_bf16 v[124:127], v[56:59], v[232:235], v[124:127]
    ds_read_b128 v[52:55], v1 offset:320
    v_cvt_pk_bf16_f32 v75, v106, v107
    v_mfma_f32_16x16x32_bf16 v[124:127], v[60:63], v[236:239], v[124:127]
    ds_read_b128 v[56:59], v1 offset:768
    v_add_f32 v14, v14, v107
    s_nop 1
    ds_read_b128 v[60:63], v1 offset:832
    s_waitcnt vmcnt(8)
    ds_read_b128 v[240:243], v7 offset:12800
    ds_read_b128 v[244:247], v2 offset:12800
    s_add_u32 m0, s30, 102464
    s_nop 0
    buffer_load_dwordx4 v5, s[12:15], 0 offen offset:1024 nt lds
    s_add_u32 m0, s30, 103008
    s_nop 0
    buffer_load_dwordx4 v5, s[12:15], 0 offen offset:1536 nt lds
    v_lshlrev_b32 v8, 16, v232
    v_and_b32 v9, 0xffff0000, v232
    v_lshlrev_b32 v10, 16, v233
    v_and_b32 v11, 0xffff0000, v233
    v_mul_f32 v8, s20, v8
    v_mul_f32 v9, s20, v9
    v_mul_f32 v10, s20, v10
    v_mul_f32 v11, s20, v11
    v_cvt_pk_bf16_f32 v232, v8, v9
    v_cvt_pk_bf16_f32 v233, v10, v11
    v_lshlrev_b32 v8, 16, v234
    v_and_b32 v9, 0xffff0000, v234
    v_lshlrev_b32 v10, 16, v235
    v_and_b32 v11, 0xffff0000, v235
    v_mul_f32 v8, s20, v8
    v_mul_f32 v9, s20, v9
    v_mul_f32 v10, s20, v10
    v_mul_f32 v11, s20, v11
    v_cvt_pk_bf16_f32 v234, v8, v9
    v_cvt_pk_bf16_f32 v235, v10, v11
    v_lshlrev_b32 v8, 16, v236
    v_and_b32 v9, 0xffff0000, v236
    v_lshlrev_b32 v10, 16, v237
    v_and_b32 v11, 0xffff0000, v237
    v_mul_f32 v8, s20, v8
    v_mul_f32 v9, s20, v9
    v_mul_f32 v10, s20, v10
    v_mul_f32 v11, s20, v11
    v_cvt_pk_bf16_f32 v236, v8, v9
    v_cvt_pk_bf16_f32 v237, v10, v11
    v_lshlrev_b32 v8, 16, v238
    v_and_b32 v9, 0xffff0000, v238
    v_lshlrev_b32 v10, 16, v239
    v_and_b32 v11, 0xffff0000, v239
    v_mul_f32 v8, s20, v8
    v_mul_f32 v9, s20, v9
    v_mul_f32 v10, s20, v10
    v_mul_f32 v11, s20, v11
    v_cvt_pk_bf16_f32 v238, v8, v9
    v_cvt_pk_bf16_f32 v239, v10, v11
    v_exp_f32 v88, v88
    v_exp_f32 v89, v89
    v_exp_f32 v90, v90
    v_exp_f32 v91, v91
    v_exp_f32 v120, v120
    v_exp_f32 v121, v121
    v_exp_f32 v122, v122
    v_exp_f32 v123, v123
    s_nop 0
    v_add_f32 v14, v14, v88
    v_add_f32 v14, v14, v89
    v_cvt_pk_bf16_f32 v88, v88, v89
    v_add_f32 v14, v14, v90
    s_waitcnt lgkmcnt(0)
    v_mfma_f32_16x16x32_bf16 v[76:79], v[32:35], v[240:243], v[76:79]
    v_add_f32 v14, v14, v91
    v_mfma_f32_16x16x32_bf16 v[76:79], v[36:39], v[244:247], v[76:79]
    ds_read_b128 v[32:35], v4 offset:384
    v_cvt_pk_bf16_f32 v89, v90, v91
    v_mfma_f32_16x16x32_bf16 v[108:111], v[40:43], v[240:243], v[108:111]
    ds_read_b128 v[36:39], v4 offset:448
    v_add_f32 v14, v14, v120
    v_mfma_f32_16x16x32_bf16 v[108:111], v[44:47], v[244:247], v[108:111]
    ds_read_b128 v[40:43], v4 offset:896
    v_cvt_pk_bf16_f32 v90, v120, v121
    v_mfma_f32_16x16x32_bf16 v[92:95], v[48:51], v[240:243], v[92:95]
    ds_read_b128 v[44:47], v4 offset:960
    v_add_f32 v14, v14, v121
    v_mfma_f32_16x16x32_bf16 v[92:95], v[52:55], v[244:247], v[92:95]
    ds_read_b128 v[48:51], v1 offset:384
    v_add_f32 v14, v14, v122
    v_mfma_f32_16x16x32_bf16 v[124:127], v[56:59], v[240:243], v[124:127]
    ds_read_b128 v[52:55], v1 offset:448
    v_cvt_pk_bf16_f32 v91, v122, v123
    v_mfma_f32_16x16x32_bf16 v[124:127], v[60:63], v[244:247], v[124:127]
    ds_read_b128 v[56:59], v1 offset:896
    v_add_f32 v14, v14, v123
    s_nop 1
    ds_read_b128 v[60:63], v1 offset:960
    s_waitcnt vmcnt(8)
    ds_read_b128 v[248:251], v7 offset:14848
    ds_read_b128 v[252:255], v2 offset:14848
    s_add_u32 m0, s30, 118272
    s_nop 0
    buffer_load_dwordx4 v5, s[12:15], s31 offen offset:0 nt lds
    s_add_u32 m0, s30, 118816
    s_nop 0
    buffer_load_dwordx4 v5, s[12:15], s31 offen offset:512 nt lds
    v_lshlrev_b32 v8, 16, v240
    v_and_b32 v9, 0xffff0000, v240
    v_lshlrev_b32 v10, 16, v241
    v_and_b32 v11, 0xffff0000, v241
    v_mul_f32 v8, s20, v8
    v_mul_f32 v9, s20, v9
    v_mul_f32 v10, s20, v10
    v_mul_f32 v11, s20, v11
    v_cvt_pk_bf16_f32 v240, v8, v9
    v_cvt_pk_bf16_f32 v241, v10, v11
    v_lshlrev_b32 v8, 16, v242
    v_and_b32 v9, 0xffff0000, v242
    v_lshlrev_b32 v10, 16, v243
    v_and_b32 v11, 0xffff0000, v243
    v_mul_f32 v8, s20, v8
    v_mul_f32 v9, s20, v9
    v_mul_f32 v10, s20, v10
    v_mul_f32 v11, s20, v11
    v_cvt_pk_bf16_f32 v242, v8, v9
    v_cvt_pk_bf16_f32 v243, v10, v11
    v_lshlrev_b32 v8, 16, v244
    v_and_b32 v9, 0xffff0000, v244
    v_lshlrev_b32 v10, 16, v245
    v_and_b32 v11, 0xffff0000, v245
    s_waitcnt lgkmcnt(0)
    v_mfma_f32_16x16x32_bf16 v[76:79], v[32:35], v[248:251], v[76:79]
    v_mul_f32 v8, s20, v8
    v_mul_f32 v9, s20, v9
    v_mfma_f32_16x16x32_bf16 v[76:79], v[36:39], v[252:255], v[76:79]
    v_mul_f32 v10, s20, v10
    v_mul_f32 v11, s20, v11
    v_mfma_f32_16x16x32_bf16 v[108:111], v[40:43], v[248:251], v[108:111]
    v_cvt_pk_bf16_f32 v244, v8, v9
    v_cvt_pk_bf16_f32 v245, v10, v11
    v_mfma_f32_16x16x32_bf16 v[108:111], v[44:47], v[252:255], v[108:111]
    v_lshlrev_b32 v8, 16, v246
    v_and_b32 v9, 0xffff0000, v246
    v_mfma_f32_16x16x32_bf16 v[92:95], v[48:51], v[248:251], v[92:95]
    v_lshlrev_b32 v10, 16, v247
    v_and_b32 v11, 0xffff0000, v247
    v_mfma_f32_16x16x32_bf16 v[92:95], v[52:55], v[252:255], v[92:95]
    v_mul_f32 v8, s20, v8
    v_mul_f32 v9, s20, v9
    v_mfma_f32_16x16x32_bf16 v[124:127], v[56:59], v[248:251], v[124:127]
    v_mul_f32 v10, s20, v10
    v_mul_f32 v11, s20, v11
    v_mfma_f32_16x16x32_bf16 v[124:127], v[60:63], v[252:255], v[124:127]
    v_cvt_pk_bf16_f32 v246, v8, v9
    v_cvt_pk_bf16_f32 v247, v10, v11
    s_add_u32 m0, s30, 119360
    s_nop 0
    buffer_load_dwordx4 v5, s[12:15], s31 offen offset:1024 nt lds
    s_add_u32 m0, s30, 119904
    s_nop 0
    buffer_load_dwordx4 v5, s[12:15], s31 offen offset:1536 nt lds
    v_lshlrev_b32 v8, 16, v248
    v_and_b32 v9, 0xffff0000, v248
    v_lshlrev_b32 v10, 16, v249
    v_and_b32 v11, 0xffff0000, v249
    v_mul_f32 v8, s20, v8
    v_mul_f32 v9, s20, v9
    v_mul_f32 v10, s20, v10
    v_mul_f32 v11, s20, v11
    v_cvt_pk_bf16_f32 v248, v8, v9
    v_cvt_pk_bf16_f32 v249, v10, v11
    v_lshlrev_b32 v8, 16, v250
    v_and_b32 v9, 0xffff0000, v250
    v_lshlrev_b32 v10, 16, v251
    v_and_b32 v11, 0xffff0000, v251
    v_mul_f32 v8, s20, v8
    v_mul_f32 v9, s20, v9
    v_mul_f32 v10, s20, v10
    v_mul_f32 v11, s20, v11
    v_cvt_pk_bf16_f32 v250, v8, v9
    v_cvt_pk_bf16_f32 v251, v10, v11
    v_lshlrev_b32 v8, 16, v252
    v_and_b32 v9, 0xffff0000, v252
    v_lshlrev_b32 v10, 16, v253
    v_and_b32 v11, 0xffff0000, v253
    v_mul_f32 v8, s20, v8
    v_mul_f32 v9, s20, v9
    v_mul_f32 v10, s20, v10
    v_mul_f32 v11, s20, v11
    v_cvt_pk_bf16_f32 v252, v8, v9
    v_cvt_pk_bf16_f32 v253, v10, v11
    v_lshlrev_b32 v8, 16, v254
    v_and_b32 v9, 0xffff0000, v254
    v_lshlrev_b32 v10, 16, v255
    v_and_b32 v11, 0xffff0000, v255
    v_mul_f32 v8, s20, v8
    v_mul_f32 v9, s20, v9
    v_mul_f32 v10, s20, v10
    v_mul_f32 v11, s20, v11
    v_cvt_pk_bf16_f32 v254, v8, v9
    v_cvt_pk_bf16_f32 v255, v10, v11
    v_max3_f32 v8, v76, v77, v78
    v_max3_f32 v8, v8, v79, v108
    v_max3_f32 v8, v8, v109, v110
    v_max3_f32 v8, v8, v111, v92
    v_max3_f32 v8, v8, v93, v94
    v_max3_f32 v8, v8, v95, v124
    v_max3_f32 v8, v8, v125, v126
    v_max_f32 v8, v8, v127
    v_mov_b32 v9, v8
    s_nop 1
    v_permlane16_swap_b32 v8, v9
    v_max_f32 v8, v8, v9
    v_mov_b32 v9, v8
    s_nop 1
    v_permlane32_swap_b32 v8, v9
    v_max_f32 v8, v8, v9
    v_mov_b32 v9, s26
    v_fma_f32 v28, -v8, s20, -v9
    v_fma_f32 v76, v76, s20, v28
    v_fma_f32 v77, v77, s20, v28
    v_fma_f32 v78, v78, s20, v28
    v_fma_f32 v79, v79, s20, v28
    v_fma_f32 v108, v108, s20, v28
    v_fma_f32 v109, v109, s20, v28
    v_fma_f32 v110, v110, s20, v28
    v_fma_f32 v111, v111, s20, v28
    v_fma_f32 v92, v92, s20, v28
    v_fma_f32 v93, v93, s20, v28
    v_fma_f32 v94, v94, s20, v28
    v_fma_f32 v95, v95, s20, v28
    v_fma_f32 v124, v124, s20, v28
    v_fma_f32 v125, v125, s20, v28
    v_fma_f32 v126, v126, s20, v28
    v_fma_f32 v127, v127, s20, v28
    v_mov_b32 v29, v28
    v_mov_b32 v30, v28
    v_mov_b32 v31, v28
    v_exp_f32 v76, v76
    v_exp_f32 v77, v77
    v_exp_f32 v78, v78
    v_exp_f32 v79, v79
    v_exp_f32 v108, v108
    v_exp_f32 v109, v109
    v_exp_f32 v110, v110
    v_exp_f32 v111, v111
    s_nop 0
    v_add_f32 v15, v15, v76
    v_add_f32 v15, v15, v77
    v_cvt_pk_bf16_f32 v76, v76, v77
    v_add_f32 v15, v15, v78
    v_add_f32 v15, v15, v79
    v_cvt_pk_bf16_f32 v77, v78, v79
    v_add_f32 v15, v15, v108
    v_cvt_pk_bf16_f32 v78, v108, v109
    v_add_f32 v15, v15, v109
    v_add_f32 v15, v15, v110
    v_cvt_pk_bf16_f32 v79, v110, v111
    v_add_f32 v15, v15, v111
    v_and_b32 v9, 63, v0
    v_and_b32 v10, 15, v9
    v_lshrrev_b32 v11, 4, v9
    v_mul_u32_u24 v10, 144, v10
    v_lshl_add_u32 v10, v11, 3, v10
    s_and_b32 s33, s29, 1
    s_mul_i32 s33, s33, 8448
    s_cmp_ge_u32 s29, 2
    s_cselect_b32 s34, 84480, 0
    s_add_u32 s33, s33, s34
    s_add_u32 s33, s33, 50688
    v_add_u32 v6, s33, v10
    v_lshrrev_b32 v10, 3, v9
    v_and_b32 v11, 7, v9
    v_lshlrev_b32 v11, 4, v11
    v_mul_u32_u24 v2, 144, v10
    v_add3_u32 v7, s33, v2, v11
    v_lshl_add_u32 v8, v10, 9, v11
    s_bfe_u32 s34, s2, 0x10003
    v_and_b32 v11, 0xfe, v0
    v_or_b32 v11, s34, v11
    v_lshlrev_b32 v11, 7, v11
    v_lshl_add_u32 v9, v9, 4, s33
    v_subrev_u32 v10, 67584, v3
    s_waitcnt vmcnt(8)
    s_barrier
    ds_read_b128 v[32:35], v1 offset:16896
    ds_read_b128 v[36:39], v1 offset:16960
    ds_read_b128 v[40:43], v1 offset:17024
    ds_read_b128 v[44:47], v1 offset:17088
    ds_read_b128 v[48:51], v1 offset:17152
    ds_read_b128 v[52:55], v1 offset:17216
    s_waitcnt lgkmcnt(4)
L_head:
    v_mfma_f32_16x16x32_bf16 v[96:99], v[32:35], v[128:131], v[16:19]
    v_exp_f32 v92, v92
    v_mfma_f32_16x16x32_bf16 v[96:99], v[36:39], v[132:135], v[96:99]
    v_exp_f32 v93, v93
    v_mfma_f32_16x16x32_bf16 v[100:103], v[32:35], v[160:163], v[20:23]
    s_add_u32 m0, s30, 33792
    ds_read_b128 v[56:59], v1 offset:17280
    v_add_f32 v15, v15, v92
    v_mfma_f32_16x16x32_bf16 v[100:103], v[36:39], v[164:167], v[100:103]
    buffer_load_dwordx4 v5, s[8:11], s37 offen offset:0 nt lds
    v_mfma_f32_16x16x32_bf16 v[104:107], v[32:35], v[192:195], v[24:27]
    v_exp_f32 v94, v94
    v_mfma_f32_16x16x32_bf16 v[104:107], v[36:39], v[196:199], v[104:107]
    v_exp_f32 v95, v95
    v_mfma_f32_16x16x32_bf16 v[108:111], v[32:35], v[224:227], v[28:31]
    ds_read_b128 v[60:63], v1 offset:17344
    v_add_f32 v15, v15, v93
    v_mfma_f32_16x16x32_bf16 v[108:111], v[36:39], v[228:231], v[108:111]
    s_waitcnt lgkmcnt(4)
    v_exp_f32 v124, v124
    v_mfma_f32_16x16x32_bf16 v[96:99], v[40:43], v[136:139], v[96:99]
    s_add_u32 m0, s30, 34336
    v_exp_f32 v125, v125
    v_mfma_f32_16x16x32_bf16 v[96:99], v[44:47], v[140:143], v[96:99]
    buffer_load_dwordx4 v5, s[8:11], s37 offen offset:512 nt lds
    v_mfma_f32_16x16x32_bf16 v[100:103], v[40:43], v[168:171], v[100:103]
    ds_read_b128 v[32:35], v1 offset:17408
    v_cvt_pk_bf16_f32 v92, v92, v93
    v_mfma_f32_16x16x32_bf16 v[100:103], v[44:47], v[172:175], v[100:103]
    v_exp_f32 v126, v126
    v_mfma_f32_16x16x32_bf16 v[104:107], v[40:43], v[200:203], v[104:107]
    v_add_f32 v15, v15, v94
    v_add_f32 v15, v15, v95
    v_mfma_f32_16x16x32_bf16 v[104:107], v[44:47], v[204:207], v[104:107]
    v_exp_f32 v127, v127
    v_mfma_f32_16x16x32_bf16 v[108:111], v[40:43], v[232:235], v[108:111]
    ds_read_b128 v[36:39], v1 offset:17472
    v_cvt_pk_bf16_f32 v93, v94, v95
    v_mfma_f32_16x16x32_bf16 v[108:111], v[44:47], v[236:239], v[108:111]
    s_waitcnt lgkmcnt(4)
    v_add_f32 v15, v15, v124
    v_cvt_pk_bf16_f32 v94, v124, v125
    v_mfma_f32_16x16x32_bf16 v[96:99], v[48:51], v[144:147], v[96:99]
    v_add_f32 v15, v15, v125
    v_add_f32 v15, v15, v126
    v_mfma_f32_16x16x32_bf16 v[96:99], v[52:55], v[148:151], v[96:99]
    s_add_u32 m0, s30, 34880
    ds_read_b128 v[40:43], v1 offset:17536
    v_cvt_pk_bf16_f32 v95, v126, v127
    v_mfma_f32_16x16x32_bf16 v[100:103], v[48:51], v[176:179], v[100:103]
    buffer_load_dwordx4 v5, s[8:11], s37 offen offset:1024 nt lds
    v_mfma_f32_16x16x32_bf16 v[100:103], v[52:55], v[180:183], v[100:103]
    v_add_f32 v15, v15, v127
    v_mfma_f32_16x16x32_bf16 v[104:107], v[48:51], v[208:211], v[104:107]
    v_mfma_f32_16x16x32_bf16 v[104:107], v[52:55], v[212:215], v[104:107]
    ds_read_b128 v[44:47], v1 offset:17600
    v_mfma_f32_16x16x32_bf16 v[108:111], v[48:51], v[240:243], v[108:111]
    v_mfma_f32_16x16x32_bf16 v[108:111], v[52:55], v[244:247], v[108:111]
    s_waitcnt lgkmcnt(4)
    v_mfma_f32_16x16x32_bf16 v[96:99], v[56:59], v[152:155], v[96:99]
    v_mfma_f32_16x16x32_bf16 v[96:99], v[60:63], v[156:159], v[96:99]
    s_add_u32 m0, s30, 35424
    ds_read_b128 v[48:51], v1 offset:17664
    v_mfma_f32_16x16x32_bf16 v[100:103], v[56:59], v[184:187], v[100:103]
    buffer_load_dwordx4 v5, s[8:11], s37 offen offset:1536 nt lds
    v_mfma_f32_16x16x32_bf16 v[100:103], v[60:63], v[188:191], v[100:103]
    v_mfma_f32_16x16x32_bf16 v[104:107], v[56:59], v[216:219], v[104:107]
    v_mfma_f32_16x16x32_bf16 v[104:107], v[60:63], v[220:223], v[104:107]
    ds_read_b128 v[52:55], v1 offset:17728
    v_mfma_f32_16x16x32_bf16 v[108:111], v[56:59], v[248:251], v[108:111]
    v_mfma_f32_16x16x32_bf16 v[108:111], v[60:63], v[252:255], v[108:111]
    s_waitcnt lgkmcnt(4)
    v_exp_f32 v96, v96
    v_mfma_f32_16x16x32_bf16 v[112:115], v[32:35], v[128:131], v[16:19]
    s_add_u32 m0, s30, 50688
    ds_read_b128 v[56:59], v1 offset:17792
    v_add_f32 v12, v12, v96
    v_mfma_f32_16x16x32_bf16 v[112:115], v[36:39], v[132:135], v[112:115]
    buffer_load_dwordx4 v5, s[8:11], s23 offen offset:0 nt lds
    v_mfma_f32_16x16x32_bf16 v[116:119], v[32:35], v[160:163], v[20:23]
    v_exp_f32 v97, v97
    v_mfma_f32_16x16x32_bf16 v[116:119], v[36:39], v[164:167], v[116:119]
    v_exp_f32 v98, v98
    v_mfma_f32_16x16x32_bf16 v[120:123], v[32:35], v[192:195], v[24:27]
    ds_read_b128 v[60:63], v1 offset:17856
    v_add_f32 v12, v12, v97
    v_mfma_f32_16x16x32_bf16 v[120:123], v[36:39], v[196:199], v[120:123]
    s_add_u32 m0, s30, 51232
    v_exp_f32 v99, v99
    v_mfma_f32_16x16x32_bf16 v[124:127], v[32:35], v[224:227], v[28:31]
    buffer_load_dwordx4 v5, s[8:11], s23 offen offset:512 nt lds
    v_mfma_f32_16x16x32_bf16 v[124:127], v[36:39], v[228:231], v[124:127]
    s_waitcnt lgkmcnt(4)
    v_exp_f32 v100, v100
    v_mfma_f32_16x16x32_bf16 v[112:115], v[40:43], v[136:139], v[112:115]
    v_exp_f32 v101, v101
    v_mfma_f32_16x16x32_bf16 v[112:115], v[44:47], v[140:143], v[112:115]
    v_exp_f32 v102, v102
    v_mfma_f32_16x16x32_bf16 v[116:119], v[40:43], v[168:171], v[116:119]
    s_add_u32 m0, s30, 51776
    v_cvt_pk_bf16_f32 v96, v96, v97
    v_add_f32 v12, v12, v98
    v_mfma_f32_16x16x32_bf16 v[116:119], v[44:47], v[172:175], v[116:119]
    buffer_load_dwordx4 v5, s[8:11], s23 offen offset:1024 nt lds
    v_mfma_f32_16x16x32_bf16 v[120:123], v[40:43], v[200:203], v[120:123]
    v_exp_f32 v103, v103
    v_mfma_f32_16x16x32_bf16 v[120:123], v[44:47], v[204:207], v[120:123]
    s_waitcnt vmcnt(7) lgkmcnt(0)
    v_add_f32 v12, v12, v99
    v_cvt_pk_bf16_f32 v97, v98, v99
    v_mfma_f32_16x16x32_bf16 v[124:127], v[40:43], v[232:235], v[124:127]
    s_barrier
    v_mfma_f32_16x16x32_bf16 v[124:127], v[44:47], v[236:239], v[124:127]
    ds_read_b64_tr_b16 v[32:33], v3 offset:33792
    v_add_f32 v13, v13, v100
    v_mfma_f32_16x16x32_bf16 v[112:115], v[48:51], v[144:147], v[112:115]
    ds_read_b64_tr_b16 v[34:35], v3 offset:34304
    v_add_f32 v13, v13, v101
    v_mfma_f32_16x16x32_bf16 v[112:115], v[52:55], v[148:151], v[112:115]
    ds_read_b64_tr_b16 v[36:37], v3 offset:50688
    v_cvt_pk_bf16_f32 v100, v100, v101
    v_mfma_f32_16x16x32_bf16 v[116:119], v[48:51], v[176:179], v[116:119]
    ds_read_b64_tr_b16 v[38:39], v3 offset:51200
    v_add_f32 v13, v13, v102
    v_mfma_f32_16x16x32_bf16 v[116:119], v[52:55], v[180:183], v[116:119]
    s_add_u32 m0, s30, 52320
    ds_read_b64_tr_b16 v[40:41], v3 offset:33824
    v_add_f32 v13, v13, v103
    v_mfma_f32_16x16x32_bf16 v[120:123], v[48:51], v[208:211], v[120:123]
    buffer_load_dwordx4 v5, s[8:11], s23 offen offset:1536 nt lds
    v_mfma_f32_16x16x32_bf16 v[120:123], v[52:55], v[212:215], v[120:123]
    ds_read_b64_tr_b16 v[42:43], v3 offset:34336
    v_cvt_pk_bf16_f32 v101, v102, v103
    v_mfma_f32_16x16x32_bf16 v[124:127], v[48:51], v[240:243], v[124:127]
    v_exp_f32 v104, v104
    v_mfma_f32_16x16x32_bf16 v[124:127], v[52:55], v[244:247], v[124:127]
    ds_read_b64_tr_b16 v[44:45], v3 offset:50720
    v_add_f32 v14, v14, v104
    v_mfma_f32_16x16x32_bf16 v[112:115], v[56:59], v[152:155], v[112:115]
    v_exp_f32 v105, v105
    v_mfma_f32_16x16x32_bf16 v[112:115], v[60:63], v[156:159], v[112:115]
    s_add_u32 m0, s30, 67584
    ds_read_b64_tr_b16 v[46:47], v3 offset:51232
    v_add_f32 v14, v14, v105
    v_mfma_f32_16x16x32_bf16 v[116:119], v[56:59], v[184:187], v[116:119]
    buffer_load_dwordx4 v5, s[12:15], s32 offen offset:0 nt lds
    v_mfma_f32_16x16x32_bf16 v[116:119], v[60:63], v[188:191], v[116:119]
    ds_read_b64_tr_b16 v[48:49], v3 offset:33856
    v_cvt_pk_bf16_f32 v104, v104, v105
    v_mfma_f32_16x16x32_bf16 v[120:123], v[56:59], v[216:219], v[120:123]
    v_exp_f32 v106, v106
    v_mfma_f32_16x16x32_bf16 v[120:123], v[60:63], v[220:223], v[120:123]
    ds_read_b64_tr_b16 v[50:51], v3 offset:34368
    v_add_f32 v14, v14, v106
    v_mfma_f32_16x16x32_bf16 v[124:127], v[56:59], v[248:251], v[124:127]
    ds_read_b64_tr_b16 v[52:53], v3 offset:50752
    v_mfma_f32_16x16x32_bf16 v[124:127], v[60:63], v[252:255], v[124:127]
    s_waitcnt lgkmcnt(7)
    v_exp_f32 v107, v107
    v_mfma_f32_16x16x32_bf16 a[0:3], v[32:35], v[64:67], a[0:3]
    s_add_u32 m0, s30, 68128
    ds_read_b64_tr_b16 v[54:55], v3 offset:51264
    v_add_f32 v14, v14, v107
    v_mfma_f32_16x16x32_bf16 a[0:3], v[36:39], v[80:83], a[0:3]
    buffer_load_dwordx4 v5, s[12:15], s32 offen offset:512 nt lds
    v_mfma_f32_16x16x32_bf16 a[4:7], v[32:35], v[68:71], a[4:7]
    ds_read_b64_tr_b16 v[56:57], v3 offset:33888
    v_cvt_pk_bf16_f32 v105, v106, v107
    v_mfma_f32_16x16x32_bf16 a[4:7], v[36:39], v[84:87], a[4:7]
    v_exp_f32 v112, v112
    v_mfma_f32_16x16x32_bf16 a[8:11], v[32:35], v[72:75], a[8:11]
    ds_read_b64_tr_b16 v[58:59], v3 offset:34400
    v_add_f32 v12, v12, v112
    v_mfma_f32_16x16x32_bf16 a[8:11], v[36:39], v[88:91], a[8:11]
    v_exp_f32 v113, v113
    v_mfma_f32_16x16x32_bf16 a[12:15], v[32:35], v[76:79], a[12:15]
    ds_read_b64_tr_b16 v[60:61], v3 offset:50784
    v_cvt_pk_bf16_f32 v98, v112, v113
    v_mfma_f32_16x16x32_bf16 a[12:15], v[36:39], v[92:95], a[12:15]
    s_waitcnt lgkmcnt(7)
    v_exp_f32 v114, v114
    v_mfma_f32_16x16x32_bf16 a[16:19], v[40:43], v[64:67], a[16:19]
    s_add_u32 m0, s30, 68672
    ds_read_b64_tr_b16 v[62:63], v3 offset:51296
    v_add_f32 v12, v12, v113
    v_mfma_f32_16x16x32_bf16 a[16:19], v[44:47], v[80:83], a[16:19]
    buffer_load_dwordx4 v5, s[12:15], s32 offen offset:1024 nt lds
    v_mfma_f32_16x16x32_bf16 a[20:23], v[40:43], v[68:71], a[20:23]
    ds_read_b64_tr_b16 v[32:33], v3 offset:33920
    v_add_f32 v12, v12, v114
    v_mfma_f32_16x16x32_bf16 a[20:23], v[44:47], v[84:87], a[20:23]
    v_exp_f32 v115, v115
    v_mfma_f32_16x16x32_bf16 a[24:27], v[40:43], v[72:75], a[24:27]
    ds_read_b64_tr_b16 v[34:35], v3 offset:34432
    v_cvt_pk_bf16_f32 v99, v114, v115
    v_mfma_f32_16x16x32_bf16 a[24:27], v[44:47], v[88:91], a[24:27]
    v_exp_f32 v116, v116
    v_mfma_f32_16x16x32_bf16 a[28:31], v[40:43], v[76:79], a[28:31]
    ds_read_b64_tr_b16 v[36:37], v3 offset:50816
    v_add_f32 v12, v12, v115
    v_mfma_f32_16x16x32_bf16 a[28:31], v[44:47], v[92:95], a[28:31]
    s_waitcnt lgkmcnt(7)
    v_exp_f32 v117, v117
    v_mfma_f32_16x16x32_bf16 a[32:35], v[48:51], v[64:67], a[32:35]
    s_add_u32 m0, s30, 69216
    ds_read_b64_tr_b16 v[38:39], v3 offset:51328
    v_add_f32 v13, v13, v116
    v_mfma_f32_16x16x32_bf16 a[32:35], v[52:55], v[80:83], a[32:35]
    buffer_load_dwordx4 v5, s[12:15], s32 offen offset:1536 nt lds
    v_mfma_f32_16x16x32_bf16 a[36:39], v[48:51], v[68:71], a[36:39]
    ds_read_b64_tr_b16 v[40:41], v3 offset:33952
    v_cvt_pk_bf16_f32 v102, v116, v117
    v_mfma_f32_16x16x32_bf16 a[36:39], v[52:55], v[84:87], a[36:39]
    v_exp_f32 v118, v118
    v_mfma_f32_16x16x32_bf16 a[40:43], v[48:51], v[72:75], a[40:43]
    ds_read_b64_tr_b16 v[42:43], v3 offset:34464
    v_add_f32 v13, v13, v117
    v_mfma_f32_16x16x32_bf16 a[40:43], v[52:55], v[88:91], a[40:43]
    s_add_u32 m0, s30, 84480
    ds_read_b64_tr_b16 v[44:45], v3 offset:50848
    v_add_f32 v13, v13, v118
    v_mfma_f32_16x16x32_bf16 a[44:47], v[48:51], v[76:79], a[44:47]
    buffer_load_dwordx4 v5, s[12:15], s37 offen offset:0 nt lds
    v_mfma_f32_16x16x32_bf16 a[44:47], v[52:55], v[92:95], a[44:47]
    s_waitcnt lgkmcnt(7)
    ds_read_b64_tr_b16 v[46:47], v3 offset:51360
    v_mfma_f32_16x16x32_bf16 a[48:51], v[56:59], v[64:67], a[48:51]
    v_exp_f32 v119, v119
    v_mfma_f32_16x16x32_bf16 a[48:51], v[60:63], v[80:83], a[48:51]
    ds_read_b64_tr_b16 v[48:49], v3 offset:33984
    v_cvt_pk_bf16_f32 v103, v118, v119
    v_mfma_f32_16x16x32_bf16 a[52:55], v[56:59], v[68:71], a[52:55]
    v_exp_f32 v120, v120
    v_mfma_f32_16x16x32_bf16 a[52:55], v[60:63], v[84:87], a[52:55]
    s_add_u32 m0, s30, 85024
    ds_read_b64_tr_b16 v[50:51], v3 offset:34496
    v_add_f32 v13, v13, v119
    v_mfma_f32_16x16x32_bf16 a[56:59], v[56:59], v[72:75], a[56:59]
    buffer_load_dwordx4 v5, s[12:15], s37 offen offset:512 nt lds
    v_mfma_f32_16x16x32_bf16 a[56:59], v[60:63], v[88:91], a[56:59]
    ds_read_b64_tr_b16 v[52:53], v3 offset:50880
    v_add_f32 v14, v14, v120
    v_mfma_f32_16x16x32_bf16 a[60:63], v[56:59], v[76:79], a[60:63]
    v_exp_f32 v121, v121
    v_mfma_f32_16x16x32_bf16 a[60:63], v[60:63], v[92:95], a[60:63]
    s_waitcnt lgkmcnt(7)
    ds_read_b64_tr_b16 v[54:55], v3 offset:51392
    v_cvt_pk_bf16_f32 v106, v120, v121
    v_mfma_f32_16x16x32_bf16 a[64:67], v[32:35], v[64:67], a[64:67]
    v_exp_f32 v122, v122
    v_mfma_f32_16x16x32_bf16 a[64:67], v[36:39], v[80:83], a[64:67]
    s_add_u32 m0, s30, 85568
    ds_read_b64_tr_b16 v[56:57], v3 offset:34016
    v_add_f32 v14, v14, v121
    v_mfma_f32_16x16x32_bf16 a[68:71], v[32:35], v[68:71], a[68:71]
    buffer_load_dwordx4 v5, s[12:15], s37 offen offset:1024 nt lds
    v_mfma_f32_16x16x32_bf16 a[68:71], v[36:39], v[84:87], a[68:71]
    ds_read_b64_tr_b16 v[58:59], v3 offset:34528
    v_add_f32 v14, v14, v122
    v_mfma_f32_16x16x32_bf16 a[72:75], v[32:35], v[72:75], a[72:75]
    v_exp_f32 v123, v123
    v_mfma_f32_16x16x32_bf16 a[72:75], v[36:39], v[88:91], a[72:75]
    ds_read_b64_tr_b16 v[60:61], v3 offset:50912
    v_cvt_pk_bf16_f32 v107, v122, v123
    v_mfma_f32_16x16x32_bf16 a[76:79], v[32:35], v[76:79], a[76:79]
    v_add_f32 v14, v14, v123
    v_mfma_f32_16x16x32_bf16 a[76:79], v[36:39], v[92:95], a[76:79]
    s_waitcnt lgkmcnt(7)
    ds_read_b64_tr_b16 v[62:63], v3 offset:51424
    v_mfma_f32_16x16x32_bf16 a[80:83], v[40:43], v[64:67], a[80:83]
    v_mfma_f32_16x16x32_bf16 a[80:83], v[44:47], v[80:83], a[80:83]
    s_add_u32 m0, s30, 86112
    ds_read_b64_tr_b16 v[32:33], v3 offset:34048
    v_mfma_f32_16x16x32_bf16 a[84:87], v[40:43], v[68:71], a[84:87]
    buffer_load_dwordx4 v5, s[12:15], s37 offen offset:1536 nt lds
    v_mfma_f32_16x16x32_bf16 a[84:87], v[44:47], v[84:87], a[84:87]
    ds_read_b64_tr_b16 v[34:35], v3 offset:34560
    v_mfma_f32_16x16x32_bf16 a[88:91], v[40:43], v[72:75], a[88:91]
    ds_read_b64_tr_b16 v[36:37], v3 offset:50944
    v_mfma_f32_16x16x32_bf16 a[88:91], v[44:47], v[88:91], a[88:91]
    v_mfma_f32_16x16x32_bf16 a[92:95], v[40:43], v[76:79], a[92:95]
    ds_read_b64_tr_b16 v[38:39], v3 offset:51456
    v_mfma_f32_16x16x32_bf16 a[92:95], v[44:47], v[92:95], a[92:95]
    s_waitcnt lgkmcnt(8)
    v_mfma_f32_16x16x32_bf16 a[96:99], v[48:51], v[64:67], a[96:99]
    s_add_u32 m0, s30, 0
    ds_read_b64_tr_b16 v[40:41], v3 offset:34080
    v_mfma_f32_16x16x32_bf16 a[96:99], v[52:55], v[80:83], a[96:99]
    buffer_load_dwordx4 v5, s[8:11], s22 offen offset:0 nt lds
    v_mfma_f32_16x16x32_bf16 a[100:103], v[48:51], v[68:71], a[100:103]
    ds_read_b64_tr_b16 v[42:43], v3 offset:34592
    v_mfma_f32_16x16x32_bf16 a[100:103], v[52:55], v[84:87], a[100:103]
    v_mfma_f32_16x16x32_bf16 a[104:107], v[48:51], v[72:75], a[104:107]
    ds_read_b64_tr_b16 v[44:45], v3 offset:50976
    v_mfma_f32_16x16x32_bf16 a[104:107], v[52:55], v[88:91], a[104:107]
    v_mfma_f32_16x16x32_bf16 a[108:111], v[48:51], v[76:79], a[108:111]
    ds_read_b64_tr_b16 v[46:47], v3 offset:51488
    v_mfma_f32_16x16x32_bf16 a[108:111], v[52:55], v[92:95], a[108:111]
    s_waitcnt lgkmcnt(8)
    v_mfma_f32_16x16x32_bf16 a[112:115], v[56:59], v[64:67], a[112:115]
    s_add_u32 m0, s30, 544
    ds_read_b64_tr_b16 v[48:49], v3 offset:34112
    v_mfma_f32_16x16x32_bf16 a[112:115], v[60:63], v[80:83], a[112:115]
    buffer_load_dwordx4 v5, s[8:11], s22 offen offset:512 nt lds
    v_mfma_f32_16x16x32_bf16 a[116:119], v[56:59], v[68:71], a[116:119]
    ds_read_b64_tr_b16 v[50:51], v3 offset:34624
    v_mfma_f32_16x16x32_bf16 a[116:119], v[60:63], v[84:87], a[116:119]
    v_mfma_f32_16x16x32_bf16 a[120:123], v[56:59], v[72:75], a[120:123]
    ds_read_b64_tr_b16 v[52:53], v3 offset:51008
    v_mfma_f32_16x16x32_bf16 a[120:123], v[60:63], v[88:91], a[120:123]
    v_mfma_f32_16x16x32_bf16 a[124:127], v[56:59], v[76:79], a[124:127]
    ds_read_b64_tr_b16 v[54:55], v3 offset:51520
    v_mfma_f32_16x16x32_bf16 a[124:127], v[60:63], v[92:95], a[124:127]
    s_waitcnt lgkmcnt(8)
    v_mfma_f32_16x16x32_bf16 a[128:131], v[32:35], v[64:67], a[128:131]
    s_add_u32 m0, s30, 1088
    ds_read_b64_tr_b16 v[56:57], v3 offset:34144
    v_mfma_f32_16x16x32_bf16 a[128:131], v[36:39], v[80:83], a[128:131]
    buffer_load_dwordx4 v5, s[8:11], s22 offen offset:1024 nt lds
    v_mfma_f32_16x16x32_bf16 a[132:135], v[32:35], v[68:71], a[132:135]
    ds_read_b64_tr_b16 v[58:59], v3 offset:34656
    v_mfma_f32_16x16x32_bf16 a[132:135], v[36:39], v[84:87], a[132:135]
    ds_read_b64_tr_b16 v[60:61], v3 offset:51040
    v_mfma_f32_16x16x32_bf16 a[136:139], v[32:35], v[72:75], a[136:139]
    v_mfma_f32_16x16x32_bf16 a[136:139], v[36:39], v[88:91], a[136:139]
    s_add_u32 m0, s30, 1632
    ds_read_b64_tr_b16 v[62:63], v3 offset:51552
    v_mfma_f32_16x16x32_bf16 a[140:143], v[32:35], v[76:79], a[140:143]
    buffer_load_dwordx4 v5, s[8:11], s22 offen offset:1536 nt lds
    v_mfma_f32_16x16x32_bf16 a[140:143], v[36:39], v[92:95], a[140:143]
    s_waitcnt lgkmcnt(8)
    ds_read_b64_tr_b16 v[32:33], v3 offset:34176
    v_mfma_f32_16x16x32_bf16 a[144:147], v[40:43], v[64:67], a[144:147]
    v_mfma_f32_16x16x32_bf16 a[144:147], v[44:47], v[80:83], a[144:147]
    ds_read_b64_tr_b16 v[34:35], v3 offset:34688
    v_mfma_f32_16x16x32_bf16 a[148:151], v[40:43], v[68:71], a[148:151]
    v_mfma_f32_16x16x32_bf16 a[148:151], v[44:47], v[84:87], a[148:151]
    s_add_u32 m0, s30, 16896
    ds_read_b64_tr_b16 v[36:37], v3 offset:51072
    v_mfma_f32_16x16x32_bf16 a[152:155], v[40:43], v[72:75], a[152:155]
    buffer_load_dwordx4 v5, s[8:11], s24 offen offset:0 nt lds
    v_mfma_f32_16x16x32_bf16 a[152:155], v[44:47], v[88:91], a[152:155]
    ds_read_b64_tr_b16 v[38:39], v3 offset:51584
    v_mfma_f32_16x16x32_bf16 a[156:159], v[40:43], v[76:79], a[156:159]
    v_mfma_f32_16x16x32_bf16 a[156:159], v[44:47], v[92:95], a[156:159]
    s_waitcnt lgkmcnt(8)
    ds_read_b64_tr_b16 v[40:41], v3 offset:34208
    v_mfma_f32_16x16x32_bf16 a[160:163], v[48:51], v[64:67], a[160:163]
    v_mfma_f32_16x16x32_bf16 a[160:163], v[52:55], v[80:83], a[160:163]
    s_add_u32 m0, s30, 17440
    ds_read_b64_tr_b16 v[42:43], v3 offset:34720
    v_mfma_f32_16x16x32_bf16 a[164:167], v[48:51], v[68:71], a[164:167]
    buffer_load_dwordx4 v5, s[8:11], s24 offen offset:512 nt lds
    v_mfma_f32_16x16x32_bf16 a[164:167], v[52:55], v[84:87], a[164:167]
    ds_read_b64_tr_b16 v[44:45], v3 offset:51104
    v_mfma_f32_16x16x32_bf16 a[168:171], v[48:51], v[72:75], a[168:171]
    v_mfma_f32_16x16x32_bf16 a[168:171], v[52:55], v[88:91], a[168:171]
    ds_read_b64_tr_b16 v[46:47], v3 offset:51616
    v_mfma_f32_16x16x32_bf16 a[172:175], v[48:51], v[76:79], a[172:175]
    v_mfma_f32_16x16x32_bf16 a[172:175], v[52:55], v[92:95], a[172:175]
    s_waitcnt lgkmcnt(8)
    ds_read_b64_tr_b16 v[48:49], v3 offset:34240
    v_mfma_f32_16x16x32_bf16 a[176:179], v[56:59], v[64:67], a[176:179]
    v_mfma_f32_16x16x32_bf16 a[176:179], v[60:63], v[80:83], a[176:179]
    ds_read_b64_tr_b16 v[50:51], v3 offset:34752
    v_mfma_f32_16x16x32_bf16 a[180:183], v[56:59], v[68:71], a[180:183]
    s_add_u32 m0, s30, 17984
    ds_read_b64_tr_b16 v[52:53], v3 offset:51136
    v_mfma_f32_16x16x32_bf16 a[180:183], v[60:63], v[84:87], a[180:183]
    buffer_load_dwordx4 v5, s[8:11], s24 offen offset:1024 nt lds
    v_mfma_f32_16x16x32_bf16 a[184:187], v[56:59], v[72:75], a[184:187]
    ds_read_b64_tr_b16 v[54:55], v3 offset:51648
    v_mfma_f32_16x16x32_bf16 a[184:187], v[60:63], v[88:91], a[184:187]
    v_mfma_f32_16x16x32_bf16 a[188:191], v[56:59], v[76:79], a[188:191]
    ds_read_b64_tr_b16 v[56:57], v3 offset:34272
    v_mfma_f32_16x16x32_bf16 a[188:191], v[60:63], v[92:95], a[188:191]
    s_waitcnt lgkmcnt(9)
    v_mfma_f32_16x16x32_bf16 a[192:195], v[32:35], v[64:67], a[192:195]
    s_add_u32 m0, s30, 18528
    ds_read_b64_tr_b16 v[58:59], v3 offset:34784
    v_mfma_f32_16x16x32_bf16 a[192:195], v[36:39], v[80:83], a[192:195]
    buffer_load_dwordx4 v5, s[8:11], s24 offen offset:1536 nt lds
    v_mfma_f32_16x16x32_bf16 a[196:199], v[32:35], v[68:71], a[196:199]
    ds_read_b64_tr_b16 v[60:61], v3 offset:51168
    v_mfma_f32_16x16x32_bf16 a[196:199], v[36:39], v[84:87], a[196:199]
    v_mfma_f32_16x16x32_bf16 a[200:203], v[32:35], v[72:75], a[200:203]
    ds_read_b64_tr_b16 v[62:63], v3 offset:51680
    v_mfma_f32_16x16x32_bf16 a[200:203], v[36:39], v[88:91], a[200:203]
    v_mfma_f32_16x16x32_bf16 a[204:207], v[32:35], v[76:79], a[204:207]
    v_mfma_f32_16x16x32_bf16 a[204:207], v[36:39], v[92:95], a[204:207]
    s_waitcnt lgkmcnt(8)
    v_mfma_f32_16x16x32_bf16 a[208:211], v[40:43], v[64:67], a[208:211]
    v_mfma_f32_16x16x32_bf16 a[208:211], v[44:47], v[80:83], a[208:211]
    v_mfma_f32_16x16x32_bf16 a[212:215], v[40:43], v[68:71], a[212:215]
    v_mfma_f32_16x16x32_bf16 a[212:215], v[44:47], v[84:87], a[212:215]
    v_mfma_f32_16x16x32_bf16 a[216:219], v[40:43], v[72:75], a[216:219]
    v_mfma_f32_16x16x32_bf16 a[216:219], v[44:47], v[88:91], a[216:219]
    s_waitcnt vmcnt(16) lgkmcnt(0)
    v_mfma_f32_16x16x32_bf16 a[220:223], v[40:43], v[76:79], a[220:223]
    s_barrier
    v_mfma_f32_16x16x32_bf16 a[220:223], v[44:47], v[92:95], a[220:223]
    v_mfma_f32_16x16x32_bf16 a[224:227], v[48:51], v[64:67], a[224:227]
    ds_read_b128 v[32:35], v1 offset:33792
    v_mfma_f32_16x16x32_bf16 a[224:227], v[52:55], v[80:83], a[224:227]
    v_mfma_f32_16x16x32_bf16 a[228:231], v[48:51], v[68:71], a[228:231]
    v_mfma_f32_16x16x32_bf16 a[228:231], v[52:55], v[84:87], a[228:231]
    v_mfma_f32_16x16x32_bf16 a[232:235], v[48:51], v[72:75], a[232:235]
    ds_read_b128 v[36:39], v1 offset:33856
    v_mfma_f32_16x16x32_bf16 a[232:235], v[52:55], v[88:91], a[232:235]
    v_mfma_f32_16x16x32_bf16 a[236:239], v[48:51], v[76:79], a[236:239]
    v_mfma_f32_16x16x32_bf16 a[236:239], v[52:55], v[92:95], a[236:239]
    ds_read_b128 v[40:43], v1 offset:33920
    v_mfma_f32_16x16x32_bf16 a[240:243], v[56:59], v[64:67], a[240:243]
    v_mfma_f32_16x16x32_bf16 a[240:243], v[60:63], v[80:83], a[240:243]
    v_mfma_f32_16x16x32_bf16 a[244:247], v[56:59], v[68:71], a[244:247]
    v_mfma_f32_16x16x32_bf16 a[244:247], v[60:63], v[84:87], a[244:247]
    ds_read_b128 v[44:47], v1 offset:33984
    v_mfma_f32_16x16x32_bf16 a[248:251], v[56:59], v[72:75], a[248:251]
    v_mfma_f32_16x16x32_bf16 a[248:251], v[60:63], v[88:91], a[248:251]
    v_mfma_f32_16x16x32_bf16 a[252:255], v[56:59], v[76:79], a[252:255]
    s_waitcnt lgkmcnt(2)
    ds_read_b128 v[48:51], v1 offset:34048
    v_mfma_f32_16x16x32_bf16 a[252:255], v[60:63], v[92:95], a[252:255]
L_loopF:
    v_mfma_f32_16x16x32_bf16 v[80:83], v[32:35], v[128:131], v[16:19]
    s_add_u32 m0, s30, 101376
    v_exp_f32 v108, v108
    v_mfma_f32_16x16x32_bf16 v[80:83], v[36:39], v[132:135], v[80:83]
    buffer_load_dwordx4 v5, s[12:15], s23 offen offset:0 nt lds
    v_mfma_f32_16x16x32_bf16 v[84:87], v[32:35], v[160:163], v[20:23]
    v_exp_f32 v109, v109
    v_mfma_f32_16x16x32_bf16 v[84:87], v[36:39], v[164:167], v[84:87]
    s_add_u32 m0, s30, 101920
    ds_read_b128 v[52:55], v1 offset:34112
    v_add_f32 v15, v15, v108
    v_mfma_f32_16x16x32_bf16 v[88:91], v[32:35], v[192:195], v[24:27]
    buffer_load_dwordx4 v5, s[12:15], s23 offen offset:512 nt lds
    v_mfma_f32_16x16x32_bf16 v[88:91], v[36:39], v[196:199], v[88:91]
    v_exp_f32 v110, v110
    v_mfma_f32_16x16x32_bf16 v[92:95], v[32:35], v[224:227], v[28:31]
    ds_read_b128 v[56:59], v1 offset:34176
    v_add_f32 v15, v15, v109
    v_mfma_f32_16x16x32_bf16 v[92:95], v[36:39], v[228:231], v[92:95]
    s_waitcnt lgkmcnt(3)
    v_exp_f32 v111, v111
    v_mfma_f32_16x16x32_bf16 v[80:83], v[40:43], v[136:139], v[80:83]
    s_add_u32 m0, s30, 102464
    v_exp_f32 v124, v124
    v_mfma_f32_16x16x32_bf16 v[80:83], v[44:47], v[140:143], v[80:83]
    buffer_load_dwordx4 v5, s[12:15], s23 offen offset:1024 nt lds
    v_mfma_f32_16x16x32_bf16 v[84:87], v[40:43], v[168:171], v[84:87]
    ds_read_b128 v[60:63], v1 offset:34240
    v_cvt_pk_bf16_f32 v108, v108, v109
    v_mfma_f32_16x16x32_bf16 v[84:87], v[44:47], v[172:175], v[84:87]
    s_add_u32 m0, s30, 103008
    v_exp_f32 v125, v125
    v_mfma_f32_16x16x32_bf16 v[88:91], v[40:43], v[200:203], v[88:91]
    buffer_load_dwordx4 v5, s[12:15], s23 offen offset:1536 nt lds
    v_mfma_f32_16x16x32_bf16 v[88:91], v[44:47], v[204:207], v[88:91]
    v_exp_f32 v126, v126
    v_mfma_f32_16x16x32_bf16 v[92:95], v[40:43], v[232:235], v[92:95]
    ds_read_b128 v[32:35], v1 offset:34304
    v_add_f32 v15, v15, v110
    v_mfma_f32_16x16x32_bf16 v[92:95], v[44:47], v[236:239], v[92:95]
    s_waitcnt lgkmcnt(3)
    v_exp_f32 v127, v127
    v_mfma_f32_16x16x32_bf16 v[80:83], v[48:51], v[144:147], v[80:83]
    s_add_u32 m0, s30, 118272
    v_add_f32 v15, v15, v111
    v_cvt_pk_bf16_f32 v109, v110, v111
    v_mfma_f32_16x16x32_bf16 v[80:83], v[52:55], v[148:151], v[80:83]
    buffer_load_dwordx4 v5, s[12:15], s25 offen offset:0 nt lds
    v_mfma_f32_16x16x32_bf16 v[84:87], v[48:51], v[176:179], v[84:87]
    ds_read_b128 v[36:39], v1 offset:34368
    v_add_f32 v15, v15, v124
    v_mfma_f32_16x16x32_bf16 v[84:87], v[52:55], v[180:183], v[84:87]
    s_add_u32 m0, s30, 118816
    v_cvt_pk_bf16_f32 v110, v124, v125
    v_add_f32 v15, v15, v125
    v_mfma_f32_16x16x32_bf16 v[88:91], v[48:51], v[208:211], v[88:91]
    buffer_load_dwordx4 v5, s[12:15], s25 offen offset:512 nt lds
    v_mfma_f32_16x16x32_bf16 v[88:91], v[52:55], v[212:215], v[88:91]
    ds_read_b128 v[40:43], v1 offset:34432
    v_add_f32 v15, v15, v126
    v_mfma_f32_16x16x32_bf16 v[92:95], v[48:51], v[240:243], v[92:95]
    v_cvt_pk_bf16_f32 v111, v126, v127
    v_add_f32 v15, v15, v127
    v_mfma_f32_16x16x32_bf16 v[92:95], v[52:55], v[244:247], v[92:95]
    s_waitcnt lgkmcnt(3)
    v_mfma_f32_16x16x32_bf16 v[80:83], v[56:59], v[152:155], v[80:83]
    v_mfma_f32_16x16x32_bf16 v[80:83], v[60:63], v[156:159], v[80:83]
    s_add_u32 m0, s30, 119360
    ds_read_b128 v[44:47], v1 offset:34496
    v_mfma_f32_16x16x32_bf16 v[84:87], v[56:59], v[184:187], v[84:87]
    buffer_load_dwordx4 v5, s[12:15], s25 offen offset:1024 nt lds
    v_mfma_f32_16x16x32_bf16 v[84:87], v[60:63], v[188:191], v[84:87]
    v_mfma_f32_16x16x32_bf16 v[88:91], v[56:59], v[216:219], v[88:91]
    v_mfma_f32_16x16x32_bf16 v[88:91], v[60:63], v[220:223], v[88:91]
    s_add_u32 m0, s30, 119904
    ds_read_b128 v[48:51], v1 offset:34560
    v_mfma_f32_16x16x32_bf16 v[92:95], v[56:59], v[248:251], v[92:95]
    buffer_load_dwordx4 v5, s[12:15], s25 offen offset:1536 nt lds
    v_mfma_f32_16x16x32_bf16 v[92:95], v[60:63], v[252:255], v[92:95]
    s_waitcnt lgkmcnt(3)
    v_exp_f32 v80, v80
    v_mfma_f32_16x16x32_bf16 v[112:115], v[32:35], v[128:131], v[16:19]
    v_exp_f32 v81, v81
    v_mfma_f32_16x16x32_bf16 v[112:115], v[36:39], v[132:135], v[112:115]
    ds_read_b128 v[52:55], v1 offset:34624
    v_add_f32 v12, v12, v80
    v_mfma_f32_16x16x32_bf16 v[116:119], v[32:35], v[160:163], v[20:23]
    v_exp_f32 v82, v82
    v_mfma_f32_16x16x32_bf16 v[116:119], v[36:39], v[164:167], v[116:119]
    v_exp_f32 v83, v83
    v_mfma_f32_16x16x32_bf16 v[120:123], v[32:35], v[192:195], v[24:27]
    ds_read_b128 v[56:59], v1 offset:34688
    v_add_f32 v12, v12, v81
    v_mfma_f32_16x16x32_bf16 v[120:123], v[36:39], v[196:199], v[120:123]
    v_exp_f32 v84, v84
    v_mfma_f32_16x16x32_bf16 v[124:127], v[32:35], v[224:227], v[28:31]
    v_exp_f32 v85, v85
    v_mfma_f32_16x16x32_bf16 v[124:127], v[36:39], v[228:231], v[124:127]
    s_waitcnt lgkmcnt(3)
    v_exp_f32 v86, v86
    v_mfma_f32_16x16x32_bf16 v[112:115], v[40:43], v[136:139], v[112:115]
    s_add_u32 s28, s28, 1
    ds_read_b128 v[60:63], v1 offset:34752
    v_cvt_pk_bf16_f32 v80, v80, v81
    v_mfma_f32_16x16x32_bf16 v[112:115], v[44:47], v[140:143], v[112:115]
    s_add_u32 s22, s22, 32768
    v_add_f32 v12, v12, v82
    v_add_f32 v12, v12, v83
    v_mfma_f32_16x16x32_bf16 v[116:119], v[40:43], v[168:171], v[116:119]
    s_add_u32 s24, s24, 32768
    v_exp_f32 v87, v87
    v_mfma_f32_16x16x32_bf16 v[116:119], v[44:47], v[172:175], v[116:119]
    s_add_u32 s23, s23, 32768
    v_exp_f32 v88, v88
    v_mfma_f32_16x16x32_bf16 v[120:123], v[40:43], v[200:203], v[120:123]
    s_add_u32 s25, s25, 32768
    ds_read_b128 v[32:35], v1 offset:50688
    v_cvt_pk_bf16_f32 v81, v82, v83
    v_mfma_f32_16x16x32_bf16 v[120:123], v[44:47], v[204:207], v[120:123]
    v_exp_f32 v89, v89
    v_mfma_f32_16x16x32_bf16 v[124:127], v[40:43], v[232:235], v[124:127]
    v_add_f32 v13, v13, v84
    v_add_f32 v13, v13, v85
    v_mfma_f32_16x16x32_bf16 v[124:127], v[44:47], v[236:239], v[124:127]
    s_waitcnt lgkmcnt(3)
    v_exp_f32 v90, v90
    v_mfma_f32_16x16x32_bf16 v[112:115], v[48:51], v[144:147], v[112:115]
    ds_read_b128 v[36:39], v1 offset:50752
    v_cvt_pk_bf16_f32 v84, v84, v85
    v_mfma_f32_16x16x32_bf16 v[112:115], v[52:55], v[148:151], v[112:115]
    v_add_f32 v13, v13, v86
    v_add_f32 v13, v13, v87
    v_mfma_f32_16x16x32_bf16 v[116:119], v[48:51], v[176:179], v[116:119]
    v_exp_f32 v91, v91
    v_mfma_f32_16x16x32_bf16 v[116:119], v[52:55], v[180:183], v[116:119]
    ds_read_b128 v[40:43], v1 offset:50816
    v_cvt_pk_bf16_f32 v85, v86, v87
    v_mfma_f32_16x16x32_bf16 v[120:123], v[48:51], v[208:211], v[120:123]
    v_exp_f32 v92, v92
    v_mfma_f32_16x16x32_bf16 v[120:123], v[52:55], v[212:215], v[120:123]
    v_exp_f32 v93, v93
    v_mfma_f32_16x16x32_bf16 v[124:127], v[48:51], v[240:243], v[124:127]
    v_add_f32 v14, v14, v88
    v_add_f32 v14, v14, v89
    v_mfma_f32_16x16x32_bf16 v[124:127], v[52:55], v[244:247], v[124:127]
    s_waitcnt lgkmcnt(3)
    ds_read_b128 v[44:47], v1 offset:50880
    v_cvt_pk_bf16_f32 v88, v88, v89
    v_mfma_f32_16x16x32_bf16 v[112:115], v[56:59], v[152:155], v[112:115]
    v_exp_f32 v94, v94
    v_mfma_f32_16x16x32_bf16 v[112:115], v[60:63], v[156:159], v[112:115]
    v_add_f32 v14, v14, v90
    v_add_f32 v14, v14, v91
    v_mfma_f32_16x16x32_bf16 v[116:119], v[56:59], v[184:187], v[116:119]
    v_exp_f32 v95, v95
    v_mfma_f32_16x16x32_bf16 v[116:119], v[60:63], v[188:191], v[116:119]
    ds_read_b128 v[48:51], v1 offset:50944
    v_cvt_pk_bf16_f32 v89, v90, v91
    v_mfma_f32_16x16x32_bf16 v[120:123], v[56:59], v[216:219], v[120:123]
    v_add_f32 v15, v15, v92
    v_add_f32 v15, v15, v93
    v_mfma_f32_16x16x32_bf16 v[120:123], v[60:63], v[220:223], v[120:123]
    v_cvt_pk_bf16_f32 v92, v92, v93
    v_add_f32 v15, v15, v94
    v_mfma_f32_16x16x32_bf16 v[124:127], v[56:59], v[248:251], v[124:127]
    v_add_f32 v15, v15, v95
    v_cvt_pk_bf16_f32 v93, v94, v95
    v_mfma_f32_16x16x32_bf16 v[124:127], v[60:63], v[252:255], v[124:127]
    s_waitcnt lgkmcnt(3)
    ds_read_b128 v[52:55], v1 offset:51008
    v_mfma_f32_16x16x32_bf16 v[64:67], v[32:35], v[128:131], v[16:19]
    v_exp_f32 v112, v112
    v_mfma_f32_16x16x32_bf16 v[64:67], v[36:39], v[132:135], v[64:67]
    v_exp_f32 v113, v113
    v_mfma_f32_16x16x32_bf16 v[68:71], v[32:35], v[160:163], v[20:23]
    ds_read_b128 v[56:59], v1 offset:51072
    v_add_f32 v12, v12, v112
    v_mfma_f32_16x16x32_bf16 v[68:71], v[36:39], v[164:167], v[68:71]
    v_exp_f32 v114, v114
    v_mfma_f32_16x16x32_bf16 v[72:75], v[32:35], v[192:195], v[24:27]
    v_exp_f32 v115, v115
    v_mfma_f32_16x16x32_bf16 v[72:75], v[36:39], v[196:199], v[72:75]
    v_exp_f32 v116, v116
    v_mfma_f32_16x16x32_bf16 v[76:79], v[32:35], v[224:227], v[28:31]
    ds_read_b128 v[60:63], v1 offset:51136
    v_cvt_pk_bf16_f32 v82, v112, v113
    v_mfma_f32_16x16x32_bf16 v[76:79], v[36:39], v[228:231], v[76:79]
    s_waitcnt lgkmcnt(4)
    v_exp_f32 v117, v117
    v_mfma_f32_16x16x32_bf16 v[64:67], v[40:43], v[136:139], v[64:67]
    v_add_f32 v12, v12, v113
    v_add_f32 v12, v12, v114
    v_mfma_f32_16x16x32_bf16 v[64:67], v[44:47], v[140:143], v[64:67]
    v_exp_f32 v118, v118
    v_mfma_f32_16x16x32_bf16 v[68:71], v[40:43], v[168:171], v[68:71]
    ds_read_b128 v[32:35], v1 offset:51200
    v_cvt_pk_bf16_f32 v83, v114, v115
    v_mfma_f32_16x16x32_bf16 v[68:71], v[44:47], v[172:175], v[68:71]
    v_exp_f32 v119, v119
    v_mfma_f32_16x16x32_bf16 v[72:75], v[40:43], v[200:203], v[72:75]
    v_add_f32 v12, v12, v115
    v_add_f32 v13, v13, v116
    v_mfma_f32_16x16x32_bf16 v[72:75], v[44:47], v[204:207], v[72:75]
    v_exp_f32 v120, v120
    v_mfma_f32_16x16x32_bf16 v[76:79], v[40:43], v[232:235], v[76:79]
    ds_read_b128 v[36:39], v1 offset:51264
    v_cvt_pk_bf16_f32 v86, v116, v117
    v_mfma_f32_16x16x32_bf16 v[76:79], v[44:47], v[236:239], v[76:79]
    s_waitcnt lgkmcnt(4)
    v_exp_f32 v121, v121
    v_mfma_f32_16x16x32_bf16 v[64:67], v[48:51], v[144:147], v[64:67]
    v_add_f32 v13, v13, v117
    v_add_f32 v13, v13, v118
    v_mfma_f32_16x16x32_bf16 v[64:67], v[52:55], v[148:151], v[64:67]
    ds_read_b128 v[40:43], v1 offset:51328
    v_cvt_pk_bf16_f32 v87, v118, v119
    v_mfma_f32_16x16x32_bf16 v[68:71], v[48:51], v[176:179], v[68:71]
    v_exp_f32 v122, v122
    v_mfma_f32_16x16x32_bf16 v[68:71], v[52:55], v[180:183], v[68:71]
    v_exp_f32 v123, v123
    v_mfma_f32_16x16x32_bf16 v[72:75], v[48:51], v[208:211], v[72:75]
    v_add_f32 v13, v13, v119
    v_add_f32 v14, v14, v120
    v_mfma_f32_16x16x32_bf16 v[72:75], v[52:55], v[212:215], v[72:75]
    ds_read_b128 v[44:47], v1 offset:51392
    v_cvt_pk_bf16_f32 v90, v120, v121
    v_mfma_f32_16x16x32_bf16 v[76:79], v[48:51], v[240:243], v[76:79]
    v_exp_f32 v124, v124
    v_mfma_f32_16x16x32_bf16 v[76:79], v[52:55], v[244:247], v[76:79]
    s_waitcnt lgkmcnt(4)
    v_exp_f32 v125, v125
    v_mfma_f32_16x16x32_bf16 v[64:67], v[56:59], v[152:155], v[64:67]
    v_add_f32 v14, v14, v121
    v_add_f32 v14, v14, v122
    v_mfma_f32_16x16x32_bf16 v[64:67], v[60:63], v[156:159], v[64:67]
    ds_read_b128 v[48:51], v1 offset:51456
    v_cvt_pk_bf16_f32 v91, v122, v123
    v_mfma_f32_16x16x32_bf16 v[68:71], v[56:59], v[184:187], v[68:71]
    v_exp_f32 v126, v126
    v_mfma_f32_16x16x32_bf16 v[68:71], v[60:63], v[188:191], v[68:71]
    v_exp_f32 v127, v127
    v_mfma_f32_16x16x32_bf16 v[72:75], v[56:59], v[216:219], v[72:75]
    v_add_f32 v14, v14, v123
    v_add_f32 v15, v15, v124
    v_mfma_f32_16x16x32_bf16 v[72:75], v[60:63], v[220:223], v[72:75]
    ds_read_b128 v[52:55], v1 offset:51520
    v_cvt_pk_bf16_f32 v94, v124, v125
    v_mfma_f32_16x16x32_bf16 v[76:79], v[56:59], v[248:251], v[76:79]
    v_add_f32 v15, v15, v125
    v_add_f32 v15, v15, v126
    v_mfma_f32_16x16x32_bf16 v[76:79], v[60:63], v[252:255], v[76:79]
    s_waitcnt lgkmcnt(4)
    v_exp_f32 v64, v64
    v_mfma_f32_16x16x32_bf16 v[112:115], v[32:35], v[128:131], v[16:19]
    ds_read_b128 v[56:59], v1 offset:51584
    v_cvt_pk_bf16_f32 v95, v126, v127
    v_mfma_f32_16x16x32_bf16 v[112:115], v[36:39], v[132:135], v[112:115]
    v_exp_f32 v65, v65
    v_mfma_f32_16x16x32_bf16 v[116:119], v[32:35], v[160:163], v[20:23]
    v_exp_f32 v66, v66
    v_mfma_f32_16x16x32_bf16 v[116:119], v[36:39], v[164:167], v[116:119]
    v_exp_f32 v67, v67
    v_mfma_f32_16x16x32_bf16 v[120:123], v[32:35], v[192:195], v[24:27]
    ds_read_b128 v[60:63], v1 offset:51648
    v_add_f32 v15, v15, v127
    v_mfma_f32_16x16x32_bf16 v[120:123], v[36:39], v[196:199], v[120:123]
    v_exp_f32 v68, v68
    v_mfma_f32_16x16x32_bf16 v[124:127], v[32:35], v[224:227], v[28:31]
    v_exp_f32 v69, v69
    v_mfma_f32_16x16x32_bf16 v[124:127], v[36:39], v[228:231], v[124:127]
    s_waitcnt lgkmcnt(4)
    v_add_f32 v12, v12, v64
    v_add_f32 v12, v12, v65
    v_mfma_f32_16x16x32_bf16 v[112:115], v[40:43], v[136:139], v[112:115]
    v_exp_f32 v70, v70
    v_mfma_f32_16x16x32_bf16 v[112:115], v[44:47], v[140:143], v[112:115]
    v_cvt_pk_bf16_f32 v64, v64, v65
    v_add_f32 v12, v12, v66
    v_mfma_f32_16x16x32_bf16 v[116:119], v[40:43], v[168:171], v[116:119]
    v_exp_f32 v71, v71
    v_mfma_f32_16x16x32_bf16 v[116:119], v[44:47], v[172:175], v[116:119]
    v_add_f32 v12, v12, v67
    v_cvt_pk_bf16_f32 v65, v66, v67
    v_mfma_f32_16x16x32_bf16 v[120:123], v[40:43], v[200:203], v[120:123]
    v_exp_f32 v72, v72
    v_mfma_f32_16x16x32_bf16 v[120:123], v[44:47], v[204:207], v[120:123]
    s_waitcnt vmcnt(16) lgkmcnt(0)
    v_exp_f32 v73, v73
    v_mfma_f32_16x16x32_bf16 v[124:127], v[40:43], v[232:235], v[124:127]
    s_barrier
    v_mfma_f32_16x16x32_bf16 v[124:127], v[44:47], v[236:239], v[124:127]
    ds_read_b64_tr_b16 v[32:33], v3 offset:0
    v_add_f32 v13, v13, v68
    v_mfma_f32_16x16x32_bf16 v[112:115], v[48:51], v[144:147], v[112:115]
    ds_read_b64_tr_b16 v[34:35], v3 offset:512
    v_add_f32 v13, v13, v69
    v_mfma_f32_16x16x32_bf16 v[112:115], v[52:55], v[148:151], v[112:115]
    ds_read_b64_tr_b16 v[36:37], v3 offset:16896
    v_cvt_pk_bf16_f32 v68, v68, v69
    v_mfma_f32_16x16x32_bf16 v[116:119], v[48:51], v[176:179], v[116:119]
    ds_read_b64_tr_b16 v[38:39], v3 offset:17408
    v_add_f32 v13, v13, v70
    v_mfma_f32_16x16x32_bf16 v[116:119], v[52:55], v[180:183], v[116:119]
    s_add_u32 m0, s30, 33792
    ds_read_b64_tr_b16 v[40:41], v3 offset:32
    v_add_f32 v13, v13, v71
    v_mfma_f32_16x16x32_bf16 v[120:123], v[48:51], v[208:211], v[120:123]
    buffer_load_dwordx4 v5, s[8:11], s22 offen offset:0 nt lds
    v_mfma_f32_16x16x32_bf16 v[120:123], v[52:55], v[212:215], v[120:123]
    ds_read_b64_tr_b16 v[42:43], v3 offset:544
    v_cvt_pk_bf16_f32 v69, v70, v71
    v_mfma_f32_16x16x32_bf16 v[124:127], v[48:51], v[240:243], v[124:127]
    v_exp_f32 v74, v74
    v_mfma_f32_16x16x32_bf16 v[124:127], v[52:55], v[244:247], v[124:127]
    s_add_u32 m0, s30, 34336
    ds_read_b64_tr_b16 v[44:45], v3 offset:16928
    v_add_f32 v14, v14, v72
    v_mfma_f32_16x16x32_bf16 v[112:115], v[56:59], v[152:155], v[112:115]
    buffer_load_dwordx4 v5, s[8:11], s22 offen offset:512 nt lds
    v_mfma_f32_16x16x32_bf16 v[112:115], v[60:63], v[156:159], v[112:115]
    ds_read_b64_tr_b16 v[46:47], v3 offset:17440
    v_add_f32 v14, v14, v73
    v_mfma_f32_16x16x32_bf16 v[116:119], v[56:59], v[184:187], v[116:119]
    v_exp_f32 v75, v75
    v_mfma_f32_16x16x32_bf16 v[116:119], v[60:63], v[188:191], v[116:119]
    s_add_u32 m0, s30, 34880
    ds_read_b64_tr_b16 v[48:49], v3 offset:64
    v_cvt_pk_bf16_f32 v72, v72, v73
    v_mfma_f32_16x16x32_bf16 v[120:123], v[56:59], v[216:219], v[120:123]
    buffer_load_dwordx4 v5, s[8:11], s22 offen offset:1024 nt lds
    v_mfma_f32_16x16x32_bf16 v[120:123], v[60:63], v[220:223], v[120:123]
    ds_read_b64_tr_b16 v[50:51], v3 offset:576
    v_add_f32 v14, v14, v74
    v_mfma_f32_16x16x32_bf16 v[124:127], v[56:59], v[248:251], v[124:127]
    ds_read_b64_tr_b16 v[52:53], v3 offset:16960
    v_add_f32 v14, v14, v75
    v_mfma_f32_16x16x32_bf16 v[124:127], v[60:63], v[252:255], v[124:127]
    s_waitcnt lgkmcnt(7)
    v_exp_f32 v112, v112
    v_mfma_f32_16x16x32_bf16 a[0:3], v[32:35], v[96:99], a[0:3]
    s_add_u32 m0, s30, 35424
    ds_read_b64_tr_b16 v[54:55], v3 offset:17472
    v_cvt_pk_bf16_f32 v73, v74, v75
    v_mfma_f32_16x16x32_bf16 a[0:3], v[36:39], v[80:83], a[0:3]
    buffer_load_dwordx4 v5, s[8:11], s22 offen offset:1536 nt lds
    v_mfma_f32_16x16x32_bf16 a[4:7], v[32:35], v[100:103], a[4:7]
    ds_read_b64_tr_b16 v[56:57], v3 offset:96
    v_add_f32 v12, v12, v112
    v_mfma_f32_16x16x32_bf16 a[4:7], v[36:39], v[84:87], a[4:7]
    v_exp_f32 v113, v113
    v_mfma_f32_16x16x32_bf16 a[8:11], v[32:35], v[104:107], a[8:11]
    ds_read_b64_tr_b16 v[58:59], v3 offset:608
    v_cvt_pk_bf16_f32 v66, v112, v113
    v_mfma_f32_16x16x32_bf16 a[8:11], v[36:39], v[88:91], a[8:11]
    v_exp_f32 v114, v114
    v_mfma_f32_16x16x32_bf16 a[12:15], v[32:35], v[108:111], a[12:15]
    ds_read_b64_tr_b16 v[60:61], v3 offset:16992
    v_add_f32 v12, v12, v113
    v_mfma_f32_16x16x32_bf16 a[12:15], v[36:39], v[92:95], a[12:15]
    s_waitcnt lgkmcnt(7)
    v_exp_f32 v115, v115
    v_mfma_f32_16x16x32_bf16 a[16:19], v[40:43], v[96:99], a[16:19]
    s_cmp_eq_u32 s28, 13
    ds_read_b64_tr_b16 v[62:63], v3 offset:17504
    v_add_f32 v12, v12, v114
    v_mfma_f32_16x16x32_bf16 a[16:19], v[44:47], v[80:83], a[16:19]
    s_cbranch_scc1 L_tailF
    v_mfma_f32_16x16x32_bf16 a[20:23], v[40:43], v[100:103], a[20:23]
    ds_read_b64_tr_b16 v[32:33], v3 offset:128
    v_cvt_pk_bf16_f32 v67, v114, v115
    v_mfma_f32_16x16x32_bf16 a[20:23], v[44:47], v[84:87], a[20:23]
    v_exp_f32 v116, v116
    v_mfma_f32_16x16x32_bf16 a[24:27], v[40:43], v[104:107], a[24:27]
    ds_read_b64_tr_b16 v[34:35], v3 offset:640
    v_add_f32 v12, v12, v115
    v_mfma_f32_16x16x32_bf16 a[24:27], v[44:47], v[88:91], a[24:27]
    v_exp_f32 v117, v117
    v_mfma_f32_16x16x32_bf16 a[28:31], v[40:43], v[108:111], a[28:31]
    ds_read_b64_tr_b16 v[36:37], v3 offset:17024
    v_add_f32 v13, v13, v116
    v_mfma_f32_16x16x32_bf16 a[28:31], v[44:47], v[92:95], a[28:31]
    s_waitcnt lgkmcnt(7)
    v_exp_f32 v118, v118
    v_mfma_f32_16x16x32_bf16 a[32:35], v[48:51], v[96:99], a[32:35]
    s_add_u32 m0, s30, 50688
    ds_read_b64_tr_b16 v[38:39], v3 offset:17536
    v_cvt_pk_bf16_f32 v70, v116, v117
    v_mfma_f32_16x16x32_bf16 a[32:35], v[52:55], v[80:83], a[32:35]
    buffer_load_dwordx4 v5, s[8:11], s24 offen offset:0 nt lds
    v_mfma_f32_16x16x32_bf16 a[36:39], v[48:51], v[100:103], a[36:39]
    ds_read_b64_tr_b16 v[40:41], v3 offset:160
    v_add_f32 v13, v13, v117
    v_mfma_f32_16x16x32_bf16 a[36:39], v[52:55], v[84:87], a[36:39]
    v_exp_f32 v119, v119
    v_mfma_f32_16x16x32_bf16 a[40:43], v[48:51], v[104:107], a[40:43]
    ds_read_b64_tr_b16 v[42:43], v3 offset:672
    v_add_f32 v13, v13, v118
    v_mfma_f32_16x16x32_bf16 a[40:43], v[52:55], v[88:91], a[40:43]
    ds_read_b64_tr_b16 v[44:45], v3 offset:17056
    v_cvt_pk_bf16_f32 v71, v118, v119
    v_mfma_f32_16x16x32_bf16 a[44:47], v[48:51], v[108:111], a[44:47]
    v_exp_f32 v120, v120
    v_mfma_f32_16x16x32_bf16 a[44:47], v[52:55], v[92:95], a[44:47]
    s_waitcnt lgkmcnt(7)
    ds_read_b64_tr_b16 v[46:47], v3 offset:17568
    v_add_f32 v13, v13, v119
    v_mfma_f32_16x16x32_bf16 a[48:51], v[56:59], v[96:99], a[48:51]
    v_exp_f32 v121, v121
    v_mfma_f32_16x16x32_bf16 a[48:51], v[60:63], v[80:83], a[48:51]
    ds_read_b64_tr_b16 v[48:49], v3 offset:192
    v_add_f32 v14, v14, v120
    v_mfma_f32_16x16x32_bf16 a[52:55], v[56:59], v[100:103], a[52:55]
    v_exp_f32 v122, v122
    v_mfma_f32_16x16x32_bf16 a[52:55], v[60:63], v[84:87], a[52:55]
    s_add_u32 m0, s30, 51232
    ds_read_b64_tr_b16 v[50:51], v3 offset:704
    v_cvt_pk_bf16_f32 v74, v120, v121
    v_mfma_f32_16x16x32_bf16 a[56:59], v[56:59], v[104:107], a[56:59]
    buffer_load_dwordx4 v5, s[8:11], s24 offen offset:512 nt lds
    v_mfma_f32_16x16x32_bf16 a[56:59], v[60:63], v[88:91], a[56:59]
    ds_read_b64_tr_b16 v[52:53], v3 offset:17088
    v_add_f32 v14, v14, v121
    v_mfma_f32_16x16x32_bf16 a[60:63], v[56:59], v[108:111], a[60:63]
    v_exp_f32 v123, v123
    v_mfma_f32_16x16x32_bf16 a[60:63], v[60:63], v[92:95], a[60:63]
    s_waitcnt lgkmcnt(7)
    ds_read_b64_tr_b16 v[54:55], v3 offset:17600
    v_add_f32 v14, v14, v122
    v_mfma_f32_16x16x32_bf16 a[64:67], v[32:35], v[96:99], a[64:67]
    v_cvt_pk_bf16_f32 v75, v122, v123
    v_add_f32 v14, v14, v123
    v_mfma_f32_16x16x32_bf16 a[64:67], v[36:39], v[80:83], a[64:67]
    ds_read_b64_tr_b16 v[56:57], v3 offset:224
    v_mfma_f32_16x16x32_bf16 a[68:71], v[32:35], v[100:103], a[68:71]
    v_mfma_f32_16x16x32_bf16 a[68:71], v[36:39], v[84:87], a[68:71]
    ds_read_b64_tr_b16 v[58:59], v3 offset:736
    v_mfma_f32_16x16x32_bf16 a[72:75], v[32:35], v[104:107], a[72:75]
    v_mfma_f32_16x16x32_bf16 a[72:75], v[36:39], v[88:91], a[72:75]
    s_add_u32 m0, s30, 51776
    ds_read_b64_tr_b16 v[60:61], v3 offset:17120
    v_mfma_f32_16x16x32_bf16 a[76:79], v[32:35], v[108:111], a[76:79]
    buffer_load_dwordx4 v5, s[8:11], s24 offen offset:1024 nt lds
    v_mfma_f32_16x16x32_bf16 a[76:79], v[36:39], v[92:95], a[76:79]
    s_waitcnt lgkmcnt(7)
    ds_read_b64_tr_b16 v[62:63], v3 offset:17632
    v_mfma_f32_16x16x32_bf16 a[80:83], v[40:43], v[96:99], a[80:83]
    v_mfma_f32_16x16x32_bf16 a[80:83], v[44:47], v[80:83], a[80:83]
    ds_read_b64_tr_b16 v[32:33], v3 offset:256
    v_mfma_f32_16x16x32_bf16 a[84:87], v[40:43], v[100:103], a[84:87]
    v_mfma_f32_16x16x32_bf16 a[84:87], v[44:47], v[84:87], a[84:87]
    ds_read_b64_tr_b16 v[34:35], v3 offset:768
    v_mfma_f32_16x16x32_bf16 a[88:91], v[40:43], v[104:107], a[88:91]
    ds_read_b64_tr_b16 v[36:37], v3 offset:17152
    v_mfma_f32_16x16x32_bf16 a[88:91], v[44:47], v[88:91], a[88:91]
    v_mfma_f32_16x16x32_bf16 a[92:95], v[40:43], v[108:111], a[92:95]
    ds_read_b64_tr_b16 v[38:39], v3 offset:17664
    v_mfma_f32_16x16x32_bf16 a[92:95], v[44:47], v[92:95], a[92:95]
    s_waitcnt lgkmcnt(8)
    v_mfma_f32_16x16x32_bf16 a[96:99], v[48:51], v[96:99], a[96:99]
    s_add_u32 m0, s30, 52320
    ds_read_b64_tr_b16 v[40:41], v3 offset:288
    v_mfma_f32_16x16x32_bf16 a[96:99], v[52:55], v[80:83], a[96:99]
    buffer_load_dwordx4 v5, s[8:11], s24 offen offset:1536 nt lds
    v_mfma_f32_16x16x32_bf16 a[100:103], v[48:51], v[100:103], a[100:103]
    ds_read_b64_tr_b16 v[42:43], v3 offset:800
    v_mfma_f32_16x16x32_bf16 a[100:103], v[52:55], v[84:87], a[100:103]
    v_mfma_f32_16x16x32_bf16 a[104:107], v[48:51], v[104:107], a[104:107]
    ds_read_b64_tr_b16 v[44:45], v3 offset:17184
    v_mfma_f32_16x16x32_bf16 a[104:107], v[52:55], v[88:91], a[104:107]
    v_mfma_f32_16x16x32_bf16 a[108:111], v[48:51], v[108:111], a[108:111]
    ds_read_b64_tr_b16 v[46:47], v3 offset:17696
    v_mfma_f32_16x16x32_bf16 a[108:111], v[52:55], v[92:95], a[108:111]
    s_waitcnt lgkmcnt(8)
    v_mfma_f32_16x16x32_bf16 a[112:115], v[56:59], v[96:99], a[112:115]
    ds_read_b64_tr_b16 v[48:49], v3 offset:320
    v_mfma_f32_16x16x32_bf16 a[112:115], v[60:63], v[80:83], a[112:115]
    v_mfma_f32_16x16x32_bf16 a[116:119], v[56:59], v[100:103], a[116:119]
    ds_read_b64_tr_b16 v[50:51], v3 offset:832
    v_mfma_f32_16x16x32_bf16 a[116:119], v[60:63], v[84:87], a[116:119]
    v_mfma_f32_16x16x32_bf16 a[120:123], v[56:59], v[104:107], a[120:123]
    ds_read_b64_tr_b16 v[52:53], v3 offset:17216
    v_mfma_f32_16x16x32_bf16 a[120:123], v[60:63], v[88:91], a[120:123]
    v_mfma_f32_16x16x32_bf16 a[124:127], v[56:59], v[108:111], a[124:127]
    ds_read_b64_tr_b16 v[54:55], v3 offset:17728
    v_mfma_f32_16x16x32_bf16 a[124:127], v[60:63], v[92:95], a[124:127]
    s_waitcnt lgkmcnt(8)
    v_mfma_f32_16x16x32_bf16 a[128:131], v[32:35], v[96:99], a[128:131]
    ds_read_b64_tr_b16 v[56:57], v3 offset:352
    v_mfma_f32_16x16x32_bf16 a[128:131], v[36:39], v[80:83], a[128:131]
    v_mfma_f32_16x16x32_bf16 a[132:135], v[32:35], v[100:103], a[132:135]
    ds_read_b64_tr_b16 v[58:59], v3 offset:864
    v_mfma_f32_16x16x32_bf16 a[132:135], v[36:39], v[84:87], a[132:135]
    ds_read_b64_tr_b16 v[60:61], v3 offset:17248
    v_mfma_f32_16x16x32_bf16 a[136:139], v[32:35], v[104:107], a[136:139]
    v_mfma_f32_16x16x32_bf16 a[136:139], v[36:39], v[88:91], a[136:139]
    ds_read_b64_tr_b16 v[62:63], v3 offset:17760
    v_mfma_f32_16x16x32_bf16 a[140:143], v[32:35], v[108:111], a[140:143]
    v_mfma_f32_16x16x32_bf16 a[140:143], v[36:39], v[92:95], a[140:143]
    s_waitcnt lgkmcnt(8)
    ds_read_b64_tr_b16 v[32:33], v3 offset:384
    v_mfma_f32_16x16x32_bf16 a[144:147], v[40:43], v[96:99], a[144:147]
    v_mfma_f32_16x16x32_bf16 a[144:147], v[44:47], v[80:83], a[144:147]
    ds_read_b64_tr_b16 v[34:35], v3 offset:896
    v_mfma_f32_16x16x32_bf16 a[148:151], v[40:43], v[100:103], a[148:151]
    v_mfma_f32_16x16x32_bf16 a[148:151], v[44:47], v[84:87], a[148:151]
    ds_read_b64_tr_b16 v[36:37], v3 offset:17280
    v_mfma_f32_16x16x32_bf16 a[152:155], v[40:43], v[104:107], a[152:155]
    v_mfma_f32_16x16x32_bf16 a[152:155], v[44:47], v[88:91], a[152:155]
    ds_read_b64_tr_b16 v[38:39], v3 offset:17792
    v_mfma_f32_16x16x32_bf16 a[156:159], v[40:43], v[108:111], a[156:159]
    v_mfma_f32_16x16x32_bf16 a[156:159], v[44:47], v[92:95], a[156:159]
    s_waitcnt lgkmcnt(8)
    ds_read_b64_tr_b16 v[40:41], v3 offset:416
    v_mfma_f32_16x16x32_bf16 a[160:163], v[48:51], v[96:99], a[160:163]
    v_mfma_f32_16x16x32_bf16 a[160:163], v[52:55], v[80:83], a[160:163]
    ds_read_b64_tr_b16 v[42:43], v3 offset:928
    v_mfma_f32_16x16x32_bf16 a[164:167], v[48:51], v[100:103], a[164:167]
    v_mfma_f32_16x16x32_bf16 a[164:167], v[52:55], v[84:87], a[164:167]
    ds_read_b64_tr_b16 v[44:45], v3 offset:17312
    v_mfma_f32_16x16x32_bf16 a[168:171], v[48:51], v[104:107], a[168:171]
    v_mfma_f32_16x16x32_bf16 a[168:171], v[52:55], v[88:91], a[168:171]
    ds_read_b64_tr_b16 v[46:47], v3 offset:17824
    v_mfma_f32_16x16x32_bf16 a[172:175], v[48:51], v[108:111], a[172:175]
    v_mfma_f32_16x16x32_bf16 a[172:175], v[52:55], v[92:95], a[172:175]
    s_waitcnt lgkmcnt(8)
    ds_read_b64_tr_b16 v[48:49], v3 offset:448
    v_mfma_f32_16x16x32_bf16 a[176:179], v[56:59], v[96:99], a[176:179]
    v_mfma_f32_16x16x32_bf16 a[176:179], v[60:63], v[80:83], a[176:179]
    ds_read_b64_tr_b16 v[50:51], v3 offset:960
    v_mfma_f32_16x16x32_bf16 a[180:183], v[56:59], v[100:103], a[180:183]
    ds_read_b64_tr_b16 v[52:53], v3 offset:17344
    v_mfma_f32_16x16x32_bf16 a[180:183], v[60:63], v[84:87], a[180:183]
    v_mfma_f32_16x16x32_bf16 a[184:187], v[56:59], v[104:107], a[184:187]
    ds_read_b64_tr_b16 v[54:55], v3 offset:17856
    v_mfma_f32_16x16x32_bf16 a[184:187], v[60:63], v[88:91], a[184:187]
    v_mfma_f32_16x16x32_bf16 a[188:191], v[56:59], v[108:111], a[188:191]
    ds_read_b64_tr_b16 v[56:57], v3 offset:480
    v_mfma_f32_16x16x32_bf16 a[188:191], v[60:63], v[92:95], a[188:191]
    s_waitcnt lgkmcnt(9)
    v_mfma_f32_16x16x32_bf16 a[192:195], v[32:35], v[96:99], a[192:195]
    ds_read_b64_tr_b16 v[58:59], v3 offset:992
    v_mfma_f32_16x16x32_bf16 a[192:195], v[36:39], v[80:83], a[192:195]
    v_mfma_f32_16x16x32_bf16 a[196:199], v[32:35], v[100:103], a[196:199]
    ds_read_b64_tr_b16 v[60:61], v3 offset:17376
    v_mfma_f32_16x16x32_bf16 a[196:199], v[36:39], v[84:87], a[196:199]
    v_mfma_f32_16x16x32_bf16 a[200:203], v[32:35], v[104:107], a[200:203]
    ds_read_b64_tr_b16 v[62:63], v3 offset:17888
    v_mfma_f32_16x16x32_bf16 a[200:203], v[36:39], v[88:91], a[200:203]
    v_mfma_f32_16x16x32_bf16 a[204:207], v[32:35], v[108:111], a[204:207]
    v_mfma_f32_16x16x32_bf16 a[204:207], v[36:39], v[92:95], a[204:207]
    s_waitcnt lgkmcnt(8)
    v_mfma_f32_16x16x32_bf16 a[208:211], v[40:43], v[96:99], a[208:211]
    v_mfma_f32_16x16x32_bf16 a[208:211], v[44:47], v[80:83], a[208:211]
    v_mfma_f32_16x16x32_bf16 a[212:215], v[40:43], v[100:103], a[212:215]
    v_mfma_f32_16x16x32_bf16 a[212:215], v[44:47], v[84:87], a[212:215]
    v_mfma_f32_16x16x32_bf16 a[216:219], v[40:43], v[104:107], a[216:219]
    v_mfma_f32_16x16x32_bf16 a[216:219], v[44:47], v[88:91], a[216:219]
    s_waitcnt vmcnt(16) lgkmcnt(0)
    v_mfma_f32_16x16x32_bf16 a[220:223], v[40:43], v[108:111], a[220:223]
    s_barrier
    v_mfma_f32_16x16x32_bf16 a[220:223], v[44:47], v[92:95], a[220:223]
    v_mfma_f32_16x16x32_bf16 a[224:227], v[48:51], v[96:99], a[224:227]
    ds_read_b128 v[32:35], v1 offset:0
    v_mfma_f32_16x16x32_bf16 a[224:227], v[52:55], v[80:83], a[224:227]
    v_mfma_f32_16x16x32_bf16 a[228:231], v[48:51], v[100:103], a[228:231]
    v_mfma_f32_16x16x32_bf16 a[228:231], v[52:55], v[84:87], a[228:231]
    v_mfma_f32_16x16x32_bf16 a[232:235], v[48:51], v[104:107], a[232:235]
    ds_read_b128 v[36:39], v1 offset:64
    v_mfma_f32_16x16x32_bf16 a[232:235], v[52:55], v[88:91], a[232:235]
    v_mfma_f32_16x16x32_bf16 a[236:239], v[48:51], v[108:111], a[236:239]
    v_mfma_f32_16x16x32_bf16 a[236:239], v[52:55], v[92:95], a[236:239]
    ds_read_b128 v[40:43], v1 offset:128
    v_mfma_f32_16x16x32_bf16 a[240:243], v[56:59], v[96:99], a[240:243]
    v_mfma_f32_16x16x32_bf16 a[240:243], v[60:63], v[80:83], a[240:243]
    v_mfma_f32_16x16x32_bf16 a[244:247], v[56:59], v[100:103], a[244:247]
    v_mfma_f32_16x16x32_bf16 a[244:247], v[60:63], v[84:87], a[244:247]
    ds_read_b128 v[44:47], v1 offset:192
    v_mfma_f32_16x16x32_bf16 a[248:251], v[56:59], v[104:107], a[248:251]
    v_mfma_f32_16x16x32_bf16 a[248:251], v[60:63], v[88:91], a[248:251]
    v_mfma_f32_16x16x32_bf16 a[252:255], v[56:59], v[108:111], a[252:255]
    s_waitcnt lgkmcnt(2)
    ds_read_b128 v[48:51], v1 offset:256
    v_mfma_f32_16x16x32_bf16 a[252:255], v[60:63], v[92:95], a[252:255]
    v_mfma_f32_16x16x32_bf16 v[80:83], v[32:35], v[128:131], v[16:19]
    s_add_u32 m0, s30, 67584
    v_exp_f32 v76, v76
    v_mfma_f32_16x16x32_bf16 v[80:83], v[36:39], v[132:135], v[80:83]
    buffer_load_dwordx4 v5, s[12:15], s23 offen offset:0 nt lds
    v_mfma_f32_16x16x32_bf16 v[84:87], v[32:35], v[160:163], v[20:23]
    v_exp_f32 v77, v77
    v_mfma_f32_16x16x32_bf16 v[84:87], v[36:39], v[164:167], v[84:87]
    s_add_u32 m0, s30, 68128
    ds_read_b128 v[52:55], v1 offset:320
    v_add_f32 v15, v15, v76
    v_mfma_f32_16x16x32_bf16 v[88:91], v[32:35], v[192:195], v[24:27]
    buffer_load_dwordx4 v5, s[12:15], s23 offen offset:512 nt lds
    v_mfma_f32_16x16x32_bf16 v[88:91], v[36:39], v[196:199], v[88:91]
    v_exp_f32 v78, v78
    v_mfma_f32_16x16x32_bf16 v[92:95], v[32:35], v[224:227], v[28:31]
    ds_read_b128 v[56:59], v1 offset:384
    v_add_f32 v15, v15, v77
    v_mfma_f32_16x16x32_bf16 v[92:95], v[36:39], v[228:231], v[92:95]
    s_waitcnt lgkmcnt(3)
    v_exp_f32 v79, v79
    v_mfma_f32_16x16x32_bf16 v[80:83], v[40:43], v[136:139], v[80:83]
    s_add_u32 m0, s30, 68672
    v_exp_f32 v124, v124
    v_mfma_f32_16x16x32_bf16 v[80:83], v[44:47], v[140:143], v[80:83]
    buffer_load_dwordx4 v5, s[12:15], s23 offen offset:1024 nt lds
    v_mfma_f32_16x16x32_bf16 v[84:87], v[40:43], v[168:171], v[84:87]
    ds_read_b128 v[60:63], v1 offset:448
    v_cvt_pk_bf16_f32 v76, v76, v77
    v_mfma_f32_16x16x32_bf16 v[84:87], v[44:47], v[172:175], v[84:87]
    s_add_u32 m0, s30, 69216
    v_exp_f32 v125, v125
    v_mfma_f32_16x16x32_bf16 v[88:91], v[40:43], v[200:203], v[88:91]
    buffer_load_dwordx4 v5, s[12:15], s23 offen offset:1536 nt lds
    v_mfma_f32_16x16x32_bf16 v[88:91], v[44:47], v[204:207], v[88:91]
    v_exp_f32 v126, v126
    v_mfma_f32_16x16x32_bf16 v[92:95], v[40:43], v[232:235], v[92:95]
    ds_read_b128 v[32:35], v1 offset:512
    v_add_f32 v15, v15, v78
    v_mfma_f32_16x16x32_bf16 v[92:95], v[44:47], v[236:239], v[92:95]
    s_waitcnt lgkmcnt(3)
    v_exp_f32 v127, v127
    v_mfma_f32_16x16x32_bf16 v[80:83], v[48:51], v[144:147], v[80:83]
    s_add_u32 m0, s30, 84480
    v_add_f32 v15, v15, v79
    v_cvt_pk_bf16_f32 v77, v78, v79
    v_mfma_f32_16x16x32_bf16 v[80:83], v[52:55], v[148:151], v[80:83]
    buffer_load_dwordx4 v5, s[12:15], s25 offen offset:0 nt lds
    v_mfma_f32_16x16x32_bf16 v[84:87], v[48:51], v[176:179], v[84:87]
    ds_read_b128 v[36:39], v1 offset:576
    v_add_f32 v15, v15, v124
    v_mfma_f32_16x16x32_bf16 v[84:87], v[52:55], v[180:183], v[84:87]
    s_add_u32 m0, s30, 85024
    v_cvt_pk_bf16_f32 v78, v124, v125
    v_add_f32 v15, v15, v125
    v_mfma_f32_16x16x32_bf16 v[88:91], v[48:51], v[208:211], v[88:91]
    buffer_load_dwordx4 v5, s[12:15], s25 offen offset:512 nt lds
    v_mfma_f32_16x16x32_bf16 v[88:91], v[52:55], v[212:215], v[88:91]
    ds_read_b128 v[40:43], v1 offset:640
    v_add_f32 v15, v15, v126
    v_mfma_f32_16x16x32_bf16 v[92:95], v[48:51], v[240:243], v[92:95]
    v_cvt_pk_bf16_f32 v79, v126, v127
    v_add_f32 v15, v15, v127
    v_mfma_f32_16x16x32_bf16 v[92:95], v[52:55], v[244:247], v[92:95]
    s_waitcnt lgkmcnt(3)
    v_mfma_f32_16x16x32_bf16 v[80:83], v[56:59], v[152:155], v[80:83]
    v_mfma_f32_16x16x32_bf16 v[80:83], v[60:63], v[156:159], v[80:83]
    s_add_u32 m0, s30, 85568
    ds_read_b128 v[44:47], v1 offset:704
    v_mfma_f32_16x16x32_bf16 v[84:87], v[56:59], v[184:187], v[84:87]
    buffer_load_dwordx4 v5, s[12:15], s25 offen offset:1024 nt lds
    v_mfma_f32_16x16x32_bf16 v[84:87], v[60:63], v[188:191], v[84:87]
    v_mfma_f32_16x16x32_bf16 v[88:91], v[56:59], v[216:219], v[88:91]
    v_mfma_f32_16x16x32_bf16 v[88:91], v[60:63], v[220:223], v[88:91]
    s_add_u32 m0, s30, 86112
    ds_read_b128 v[48:51], v1 offset:768
    v_mfma_f32_16x16x32_bf16 v[92:95], v[56:59], v[248:251], v[92:95]
    buffer_load_dwordx4 v5, s[12:15], s25 offen offset:1536 nt lds
    v_mfma_f32_16x16x32_bf16 v[92:95], v[60:63], v[252:255], v[92:95]
    s_waitcnt lgkmcnt(3)
    v_exp_f32 v80, v80
    v_mfma_f32_16x16x32_bf16 v[112:115], v[32:35], v[128:131], v[16:19]
    v_exp_f32 v81, v81
    v_mfma_f32_16x16x32_bf16 v[112:115], v[36:39], v[132:135], v[112:115]
    ds_read_b128 v[52:55], v1 offset:832
    v_add_f32 v12, v12, v80
    v_mfma_f32_16x16x32_bf16 v[116:119], v[32:35], v[160:163], v[20:23]
    v_exp_f32 v82, v82
    v_mfma_f32_16x16x32_bf16 v[116:119], v[36:39], v[164:167], v[116:119]
    v_exp_f32 v83, v83
    v_mfma_f32_16x16x32_bf16 v[120:123], v[32:35], v[192:195], v[24:27]
    ds_read_b128 v[56:59], v1 offset:896
    v_add_f32 v12, v12, v81
    v_mfma_f32_16x16x32_bf16 v[120:123], v[36:39], v[196:199], v[120:123]
    v_exp_f32 v84, v84
    v_mfma_f32_16x16x32_bf16 v[124:127], v[32:35], v[224:227], v[28:31]
    v_exp_f32 v85, v85
    v_mfma_f32_16x16x32_bf16 v[124:127], v[36:39], v[228:231], v[124:127]
    s_waitcnt lgkmcnt(3)
    v_exp_f32 v86, v86
    v_mfma_f32_16x16x32_bf16 v[112:115], v[40:43], v[136:139], v[112:115]
    s_add_u32 s28, s28, 1
    ds_read_b128 v[60:63], v1 offset:960
    v_cvt_pk_bf16_f32 v80, v80, v81
    v_mfma_f32_16x16x32_bf16 v[112:115], v[44:47], v[140:143], v[112:115]
    s_add_u32 s22, s22, 32768
    v_add_f32 v12, v12, v82
    v_add_f32 v12, v12, v83
    v_mfma_f32_16x16x32_bf16 v[116:119], v[40:43], v[168:171], v[116:119]
    s_add_u32 s24, s24, 32768
    v_exp_f32 v87, v87
    v_mfma_f32_16x16x32_bf16 v[116:119], v[44:47], v[172:175], v[116:119]
    s_add_u32 s23, s23, 32768
    v_exp_f32 v88, v88
    v_mfma_f32_16x16x32_bf16 v[120:123], v[40:43], v[200:203], v[120:123]
    s_add_u32 s25, s25, 32768
    ds_read_b128 v[32:35], v1 offset:16896
    v_cvt_pk_bf16_f32 v81, v82, v83
    v_mfma_f32_16x16x32_bf16 v[120:123], v[44:47], v[204:207], v[120:123]
    v_exp_f32 v89, v89
    v_mfma_f32_16x16x32_bf16 v[124:127], v[40:43], v[232:235], v[124:127]
    v_add_f32 v13, v13, v84
    v_add_f32 v13, v13, v85
    v_mfma_f32_16x16x32_bf16 v[124:127], v[44:47], v[236:239], v[124:127]
    s_waitcnt lgkmcnt(3)
    v_exp_f32 v90, v90
    v_mfma_f32_16x16x32_bf16 v[112:115], v[48:51], v[144:147], v[112:115]
    ds_read_b128 v[36:39], v1 offset:16960
    v_cvt_pk_bf16_f32 v84, v84, v85
    v_mfma_f32_16x16x32_bf16 v[112:115], v[52:55], v[148:151], v[112:115]
    v_add_f32 v13, v13, v86
    v_add_f32 v13, v13, v87
    v_mfma_f32_16x16x32_bf16 v[116:119], v[48:51], v[176:179], v[116:119]
    v_exp_f32 v91, v91
    v_mfma_f32_16x16x32_bf16 v[116:119], v[52:55], v[180:183], v[116:119]
    ds_read_b128 v[40:43], v1 offset:17024
    v_cvt_pk_bf16_f32 v85, v86, v87
    v_mfma_f32_16x16x32_bf16 v[120:123], v[48:51], v[208:211], v[120:123]
    v_exp_f32 v92, v92
    v_mfma_f32_16x16x32_bf16 v[120:123], v[52:55], v[212:215], v[120:123]
    v_exp_f32 v93, v93
    v_mfma_f32_16x16x32_bf16 v[124:127], v[48:51], v[240:243], v[124:127]
    v_add_f32 v14, v14, v88
    v_add_f32 v14, v14, v89
    v_mfma_f32_16x16x32_bf16 v[124:127], v[52:55], v[244:247], v[124:127]
    s_waitcnt lgkmcnt(3)
    ds_read_b128 v[44:47], v1 offset:17088
    v_cvt_pk_bf16_f32 v88, v88, v89
    v_mfma_f32_16x16x32_bf16 v[112:115], v[56:59], v[152:155], v[112:115]
    v_exp_f32 v94, v94
    v_mfma_f32_16x16x32_bf16 v[112:115], v[60:63], v[156:159], v[112:115]
    v_add_f32 v14, v14, v90
    v_add_f32 v14, v14, v91
    v_mfma_f32_16x16x32_bf16 v[116:119], v[56:59], v[184:187], v[116:119]
    v_exp_f32 v95, v95
    v_mfma_f32_16x16x32_bf16 v[116:119], v[60:63], v[188:191], v[116:119]
    ds_read_b128 v[48:51], v1 offset:17152
    v_cvt_pk_bf16_f32 v89, v90, v91
    v_mfma_f32_16x16x32_bf16 v[120:123], v[56:59], v[216:219], v[120:123]
    v_add_f32 v15, v15, v92
    v_add_f32 v15, v15, v93
    v_mfma_f32_16x16x32_bf16 v[120:123], v[60:63], v[220:223], v[120:123]
    v_cvt_pk_bf16_f32 v92, v92, v93
    v_add_f32 v15, v15, v94
    v_mfma_f32_16x16x32_bf16 v[124:127], v[56:59], v[248:251], v[124:127]
    v_add_f32 v15, v15, v95
    v_cvt_pk_bf16_f32 v93, v94, v95
    v_mfma_f32_16x16x32_bf16 v[124:127], v[60:63], v[252:255], v[124:127]
    s_waitcnt lgkmcnt(3)
    ds_read_b128 v[52:55], v1 offset:17216
    v_mfma_f32_16x16x32_bf16 v[96:99], v[32:35], v[128:131], v[16:19]
    v_exp_f32 v112, v112
    v_mfma_f32_16x16x32_bf16 v[96:99], v[36:39], v[132:135], v[96:99]
    v_exp_f32 v113, v113
    v_mfma_f32_16x16x32_bf16 v[100:103], v[32:35], v[160:163], v[20:23]
    ds_read_b128 v[56:59], v1 offset:17280
    v_add_f32 v12, v12, v112
    v_mfma_f32_16x16x32_bf16 v[100:103], v[36:39], v[164:167], v[100:103]
    v_exp_f32 v114, v114
    v_mfma_f32_16x16x32_bf16 v[104:107], v[32:35], v[192:195], v[24:27]
    v_exp_f32 v115, v115
    v_mfma_f32_16x16x32_bf16 v[104:107], v[36:39], v[196:199], v[104:107]
    v_exp_f32 v116, v116
    v_mfma_f32_16x16x32_bf16 v[108:111], v[32:35], v[224:227], v[28:31]
    ds_read_b128 v[60:63], v1 offset:17344
    v_cvt_pk_bf16_f32 v82, v112, v113
    v_mfma_f32_16x16x32_bf16 v[108:111], v[36:39], v[228:231], v[108:111]
    s_waitcnt lgkmcnt(4)
    v_exp_f32 v117, v117
    v_mfma_f32_16x16x32_bf16 v[96:99], v[40:43], v[136:139], v[96:99]
    v_add_f32 v12, v12, v113
    v_add_f32 v12, v12, v114
    v_mfma_f32_16x16x32_bf16 v[96:99], v[44:47], v[140:143], v[96:99]
    v_exp_f32 v118, v118
    v_mfma_f32_16x16x32_bf16 v[100:103], v[40:43], v[168:171], v[100:103]
    ds_read_b128 v[32:35], v1 offset:17408
    v_cvt_pk_bf16_f32 v83, v114, v115
    v_mfma_f32_16x16x32_bf16 v[100:103], v[44:47], v[172:175], v[100:103]
    v_exp_f32 v119, v119
    v_mfma_f32_16x16x32_bf16 v[104:107], v[40:43], v[200:203], v[104:107]
    v_add_f32 v12, v12, v115
    v_add_f32 v13, v13, v116
    v_mfma_f32_16x16x32_bf16 v[104:107], v[44:47], v[204:207], v[104:107]
    v_exp_f32 v120, v120
    v_mfma_f32_16x16x32_bf16 v[108:111], v[40:43], v[232:235], v[108:111]
    ds_read_b128 v[36:39], v1 offset:17472
    v_cvt_pk_bf16_f32 v86, v116, v117
    v_mfma_f32_16x16x32_bf16 v[108:111], v[44:47], v[236:239], v[108:111]
    s_waitcnt lgkmcnt(4)
    v_exp_f32 v121, v121
    v_mfma_f32_16x16x32_bf16 v[96:99], v[48:51], v[144:147], v[96:99]
    v_add_f32 v13, v13, v117
    v_add_f32 v13, v13, v118
    v_mfma_f32_16x16x32_bf16 v[96:99], v[52:55], v[148:151], v[96:99]
    ds_read_b128 v[40:43], v1 offset:17536
    v_cvt_pk_bf16_f32 v87, v118, v119
    v_mfma_f32_16x16x32_bf16 v[100:103], v[48:51], v[176:179], v[100:103]
    v_exp_f32 v122, v122
    v_mfma_f32_16x16x32_bf16 v[100:103], v[52:55], v[180:183], v[100:103]
    v_exp_f32 v123, v123
    v_mfma_f32_16x16x32_bf16 v[104:107], v[48:51], v[208:211], v[104:107]
    v_add_f32 v13, v13, v119
    v_add_f32 v14, v14, v120
    v_mfma_f32_16x16x32_bf16 v[104:107], v[52:55], v[212:215], v[104:107]
    ds_read_b128 v[44:47], v1 offset:17600
    v_cvt_pk_bf16_f32 v90, v120, v121
    v_mfma_f32_16x16x32_bf16 v[108:111], v[48:51], v[240:243], v[108:111]
    v_exp_f32 v124, v124
    v_mfma_f32_16x16x32_bf16 v[108:111], v[52:55], v[244:247], v[108:111]
    s_waitcnt lgkmcnt(4)
    v_exp_f32 v125, v125
    v_mfma_f32_16x16x32_bf16 v[96:99], v[56:59], v[152:155], v[96:99]
    v_add_f32 v14, v14, v121
    v_add_f32 v14, v14, v122
    v_mfma_f32_16x16x32_bf16 v[96:99], v[60:63], v[156:159], v[96:99]
    ds_read_b128 v[48:51], v1 offset:17664
    v_cvt_pk_bf16_f32 v91, v122, v123
    v_mfma_f32_16x16x32_bf16 v[100:103], v[56:59], v[184:187], v[100:103]
    v_exp_f32 v126, v126
    v_mfma_f32_16x16x32_bf16 v[100:103], v[60:63], v[188:191], v[100:103]
    v_exp_f32 v127, v127
    v_mfma_f32_16x16x32_bf16 v[104:107], v[56:59], v[216:219], v[104:107]
    v_add_f32 v14, v14, v123
    v_add_f32 v15, v15, v124
    v_mfma_f32_16x16x32_bf16 v[104:107], v[60:63], v[220:223], v[104:107]
    ds_read_b128 v[52:55], v1 offset:17728
    v_cvt_pk_bf16_f32 v94, v124, v125
    v_mfma_f32_16x16x32_bf16 v[108:111], v[56:59], v[248:251], v[108:111]
    v_add_f32 v15, v15, v125
    v_add_f32 v15, v15, v126
    v_mfma_f32_16x16x32_bf16 v[108:111], v[60:63], v[252:255], v[108:111]
    s_waitcnt lgkmcnt(4)
    v_exp_f32 v96, v96
    v_mfma_f32_16x16x32_bf16 v[112:115], v[32:35], v[128:131], v[16:19]
    ds_read_b128 v[56:59], v1 offset:17792
    v_cvt_pk_bf16_f32 v95, v126, v127
    v_mfma_f32_16x16x32_bf16 v[112:115], v[36:39], v[132:135], v[112:115]
    v_exp_f32 v97, v97
    v_mfma_f32_16x16x32_bf16 v[116:119], v[32:35], v[160:163], v[20:23]
    v_exp_f32 v98, v98
    v_mfma_f32_16x16x32_bf16 v[116:119], v[36:39], v[164:167], v[116:119]
    v_exp_f32 v99, v99
    v_mfma_f32_16x16x32_bf16 v[120:123], v[32:35], v[192:195], v[24:27]
    ds_read_b128 v[60:63], v1 offset:17856
    v_add_f32 v15, v15, v127
    v_mfma_f32_16x16x32_bf16 v[120:123], v[36:39], v[196:199], v[120:123]
    v_exp_f32 v100, v100
    v_mfma_f32_16x16x32_bf16 v[124:127], v[32:35], v[224:227], v[28:31]
    v_exp_f32 v101, v101
    v_mfma_f32_16x16x32_bf16 v[124:127], v[36:39], v[228:231], v[124:127]
    s_waitcnt lgkmcnt(4)
    v_add_f32 v12, v12, v96
    v_add_f32 v12, v12, v97
    v_mfma_f32_16x16x32_bf16 v[112:115], v[40:43], v[136:139], v[112:115]
    v_exp_f32 v102, v102
    v_mfma_f32_16x16x32_bf16 v[112:115], v[44:47], v[140:143], v[112:115]
    v_cvt_pk_bf16_f32 v96, v96, v97
    v_add_f32 v12, v12, v98
    v_mfma_f32_16x16x32_bf16 v[116:119], v[40:43], v[168:171], v[116:119]
    v_exp_f32 v103, v103
    v_mfma_f32_16x16x32_bf16 v[116:119], v[44:47], v[172:175], v[116:119]
    v_add_f32 v12, v12, v99
    v_cvt_pk_bf16_f32 v97, v98, v99
    v_mfma_f32_16x16x32_bf16 v[120:123], v[40:43], v[200:203], v[120:123]
    v_exp_f32 v104, v104
    v_mfma_f32_16x16x32_bf16 v[120:123], v[44:47], v[204:207], v[120:123]
    s_waitcnt vmcnt(16) lgkmcnt(0)
    v_exp_f32 v105, v105
    v_mfma_f32_16x16x32_bf16 v[124:127], v[40:43], v[232:235], v[124:127]
    s_barrier
    v_mfma_f32_16x16x32_bf16 v[124:127], v[44:47], v[236:239], v[124:127]
    ds_read_b64_tr_b16 v[32:33], v3 offset:33792
    v_add_f32 v13, v13, v100
    v_mfma_f32_16x16x32_bf16 v[112:115], v[48:51], v[144:147], v[112:115]
    ds_read_b64_tr_b16 v[34:35], v3 offset:34304
    v_add_f32 v13, v13, v101
    v_mfma_f32_16x16x32_bf16 v[112:115], v[52:55], v[148:151], v[112:115]
    ds_read_b64_tr_b16 v[36:37], v3 offset:50688
    v_cvt_pk_bf16_f32 v100, v100, v101
    v_mfma_f32_16x16x32_bf16 v[116:119], v[48:51], v[176:179], v[116:119]
    ds_read_b64_tr_b16 v[38:39], v3 offset:51200
    v_add_f32 v13, v13, v102
    v_mfma_f32_16x16x32_bf16 v[116:119], v[52:55], v[180:183], v[116:119]
    s_add_u32 m0, s30, 0
    ds_read_b64_tr_b16 v[40:41], v3 offset:33824
    v_add_f32 v13, v13, v103
    v_mfma_f32_16x16x32_bf16 v[120:123], v[48:51], v[208:211], v[120:123]
    buffer_load_dwordx4 v5, s[8:11], s22 offen offset:0 nt lds
    v_mfma_f32_16x16x32_bf16 v[120:123], v[52:55], v[212:215], v[120:123]
    ds_read_b64_tr_b16 v[42:43], v3 offset:34336
    v_cvt_pk_bf16_f32 v101, v102, v103
    v_mfma_f32_16x16x32_bf16 v[124:127], v[48:51], v[240:243], v[124:127]
    v_exp_f32 v106, v106
    v_mfma_f32_16x16x32_bf16 v[124:127], v[52:55], v[244:247], v[124:127]
    s_add_u32 m0, s30, 544
    ds_read_b64_tr_b16 v[44:45], v3 offset:50720
    v_add_f32 v14, v14, v104
    v_mfma_f32_16x16x32_bf16 v[112:115], v[56:59], v[152:155], v[112:115]
    buffer_load_dwordx4 v5, s[8:11], s22 offen offset:512 nt lds
    v_mfma_f32_16x16x32_bf16 v[112:115], v[60:63], v[156:159], v[112:115]
    ds_read_b64_tr_b16 v[46:47], v3 offset:51232
    v_add_f32 v14, v14, v105
    v_mfma_f32_16x16x32_bf16 v[116:119], v[56:59], v[184:187], v[116:119]
    v_exp_f32 v107, v107
    v_mfma_f32_16x16x32_bf16 v[116:119], v[60:63], v[188:191], v[116:119]
    s_add_u32 m0, s30, 1088
    ds_read_b64_tr_b16 v[48:49], v3 offset:33856
    v_cvt_pk_bf16_f32 v104, v104, v105
    v_mfma_f32_16x16x32_bf16 v[120:123], v[56:59], v[216:219], v[120:123]
    buffer_load_dwordx4 v5, s[8:11], s22 offen offset:1024 nt lds
    v_mfma_f32_16x16x32_bf16 v[120:123], v[60:63], v[220:223], v[120:123]
    ds_read_b64_tr_b16 v[50:51], v3 offset:34368
    v_add_f32 v14, v14, v106
    v_mfma_f32_16x16x32_bf16 v[124:127], v[56:59], v[248:251], v[124:127]
    ds_read_b64_tr_b16 v[52:53], v3 offset:50752
    v_add_f32 v14, v14, v107
    v_mfma_f32_16x16x32_bf16 v[124:127], v[60:63], v[252:255], v[124:127]
    s_waitcnt lgkmcnt(7)
    v_exp_f32 v112, v112
    v_mfma_f32_16x16x32_bf16 a[0:3], v[32:35], v[64:67], a[0:3]
    s_add_u32 m0, s30, 1632
    ds_read_b64_tr_b16 v[54:55], v3 offset:51264
    v_cvt_pk_bf16_f32 v105, v106, v107
    v_mfma_f32_16x16x32_bf16 a[0:3], v[36:39], v[80:83], a[0:3]
    buffer_load_dwordx4 v5, s[8:11], s22 offen offset:1536 nt lds
    v_mfma_f32_16x16x32_bf16 a[4:7], v[32:35], v[68:71], a[4:7]
    ds_read_b64_tr_b16 v[56:57], v3 offset:33888
    v_add_f32 v12, v12, v112
    v_mfma_f32_16x16x32_bf16 a[4:7], v[36:39], v[84:87], a[4:7]
    v_exp_f32 v113, v113
    v_mfma_f32_16x16x32_bf16 a[8:11], v[32:35], v[72:75], a[8:11]
    ds_read_b64_tr_b16 v[58:59], v3 offset:34400
    v_cvt_pk_bf16_f32 v98, v112, v113
    v_mfma_f32_16x16x32_bf16 a[8:11], v[36:39], v[88:91], a[8:11]
    v_exp_f32 v114, v114
    v_mfma_f32_16x16x32_bf16 a[12:15], v[32:35], v[76:79], a[12:15]
    ds_read_b64_tr_b16 v[60:61], v3 offset:50784
    v_add_f32 v12, v12, v113
    v_mfma_f32_16x16x32_bf16 a[12:15], v[36:39], v[92:95], a[12:15]
    s_waitcnt lgkmcnt(7)
    v_exp_f32 v115, v115
    v_mfma_f32_16x16x32_bf16 a[16:19], v[40:43], v[64:67], a[16:19]
    s_cmp_ge_u32 s28, 12
    ds_read_b64_tr_b16 v[62:63], v3 offset:51296
    v_add_f32 v12, v12, v114
    v_mfma_f32_16x16x32_bf16 a[16:19], v[44:47], v[80:83], a[16:19]
    s_cbranch_scc1 L_pf
L_pfback:
    v_mfma_f32_16x16x32_bf16 a[20:23], v[40:43], v[68:71], a[20:23]
    ds_read_b64_tr_b16 v[32:33], v3 offset:33920
    v_cvt_pk_bf16_f32 v99, v114, v115
    v_mfma_f32_16x16x32_bf16 a[20:23], v[44:47], v[84:87], a[20:23]
    v_exp_f32 v116, v116
    v_mfma_f32_16x16x32_bf16 a[24:27], v[40:43], v[72:75], a[24:27]
    ds_read_b64_tr_b16 v[34:35], v3 offset:34432
    v_add_f32 v12, v12, v115
    v_mfma_f32_16x16x32_bf16 a[24:27], v[44:47], v[88:91], a[24:27]
    v_exp_f32 v117, v117
    v_mfma_f32_16x16x32_bf16 a[28:31], v[40:43], v[76:79], a[28:31]
    ds_read_b64_tr_b16 v[36:37], v3 offset:50816
    v_add_f32 v13, v13, v116
    v_mfma_f32_16x16x32_bf16 a[28:31], v[44:47], v[92:95], a[28:31]
    s_waitcnt lgkmcnt(7)
    v_exp_f32 v118, v118
    v_mfma_f32_16x16x32_bf16 a[32:35], v[48:51], v[64:67], a[32:35]
    s_add_u32 m0, s30, 16896
    ds_read_b64_tr_b16 v[38:39], v3 offset:51328
    v_cvt_pk_bf16_f32 v102, v116, v117
    v_mfma_f32_16x16x32_bf16 a[32:35], v[52:55], v[80:83], a[32:35]
    buffer_load_dwordx4 v5, s[8:11], s24 offen offset:0 nt lds
    v_mfma_f32_16x16x32_bf16 a[36:39], v[48:51], v[68:71], a[36:39]
    ds_read_b64_tr_b16 v[40:41], v3 offset:33952
    v_add_f32 v13, v13, v117
    v_mfma_f32_16x16x32_bf16 a[36:39], v[52:55], v[84:87], a[36:39]
    v_exp_f32 v119, v119
    v_mfma_f32_16x16x32_bf16 a[40:43], v[48:51], v[72:75], a[40:43]
    ds_read_b64_tr_b16 v[42:43], v3 offset:34464
    v_add_f32 v13, v13, v118
    v_mfma_f32_16x16x32_bf16 a[40:43], v[52:55], v[88:91], a[40:43]
    ds_read_b64_tr_b16 v[44:45], v3 offset:50848
    v_cvt_pk_bf16_f32 v103, v118, v119
    v_mfma_f32_16x16x32_bf16 a[44:47], v[48:51], v[76:79], a[44:47]
    v_exp_f32 v120, v120
    v_mfma_f32_16x16x32_bf16 a[44:47], v[52:55], v[92:95], a[44:47]
    s_waitcnt lgkmcnt(7)
    ds_read_b64_tr_b16 v[46:47], v3 offset:51360
    v_add_f32 v13, v13, v119
    v_mfma_f32_16x16x32_bf16 a[48:51], v[56:59], v[64:67], a[48:51]
    v_exp_f32 v121, v121
    v_mfma_f32_16x16x32_bf16 a[48:51], v[60:63], v[80:83], a[48:51]
    ds_read_b64_tr_b16 v[48:49], v3 offset:33984
    v_add_f32 v14, v14, v120
    v_mfma_f32_16x16x32_bf16 a[52:55], v[56:59], v[68:71], a[52:55]
    v_exp_f32 v122, v122
    v_mfma_f32_16x16x32_bf16 a[52:55], v[60:63], v[84:87], a[52:55]
    s_add_u32 m0, s30, 17440
    ds_read_b64_tr_b16 v[50:51], v3 offset:34496
    v_cvt_pk_bf16_f32 v106, v120, v121
    v_mfma_f32_16x16x32_bf16 a[56:59], v[56:59], v[72:75], a[56:59]
    buffer_load_dwordx4 v5, s[8:11], s24 offen offset:512 nt lds
    v_mfma_f32_16x16x32_bf16 a[56:59], v[60:63], v[88:91], a[56:59]
    ds_read_b64_tr_b16 v[52:53], v3 offset:50880
    v_add_f32 v14, v14, v121
    v_mfma_f32_16x16x32_bf16 a[60:63], v[56:59], v[76:79], a[60:63]
    v_exp_f32 v123, v123
    v_mfma_f32_16x16x32_bf16 a[60:63], v[60:63], v[92:95], a[60:63]
    s_waitcnt lgkmcnt(7)
    ds_read_b64_tr_b16 v[54:55], v3 offset:51392
    v_add_f32 v14, v14, v122
    v_mfma_f32_16x16x32_bf16 a[64:67], v[32:35], v[64:67], a[64:67]
    v_cvt_pk_bf16_f32 v107, v122, v123
    v_add_f32 v14, v14, v123
    v_mfma_f32_16x16x32_bf16 a[64:67], v[36:39], v[80:83], a[64:67]
    ds_read_b64_tr_b16 v[56:57], v3 offset:34016
    v_mfma_f32_16x16x32_bf16 a[68:71], v[32:35], v[68:71], a[68:71]
    v_mfma_f32_16x16x32_bf16 a[68:71], v[36:39], v[84:87], a[68:71]
    ds_read_b64_tr_b16 v[58:59], v3 offset:34528
    v_mfma_f32_16x16x32_bf16 a[72:75], v[32:35], v[72:75], a[72:75]
    v_mfma_f32_16x16x32_bf16 a[72:75], v[36:39], v[88:91], a[72:75]
    s_add_u32 m0, s30, 17984
    ds_read_b64_tr_b16 v[60:61], v3 offset:50912
    v_mfma_f32_16x16x32_bf16 a[76:79], v[32:35], v[76:79], a[76:79]
    buffer_load_dwordx4 v5, s[8:11], s24 offen offset:1024 nt lds
    v_mfma_f32_16x16x32_bf16 a[76:79], v[36:39], v[92:95], a[76:79]
    s_waitcnt lgkmcnt(7)
    ds_read_b64_tr_b16 v[62:63], v3 offset:51424
    v_mfma_f32_16x16x32_bf16 a[80:83], v[40:43], v[64:67], a[80:83]
    v_mfma_f32_16x16x32_bf16 a[80:83], v[44:47], v[80:83], a[80:83]
    ds_read_b64_tr_b16 v[32:33], v3 offset:34048
    v_mfma_f32_16x16x32_bf16 a[84:87], v[40:43], v[68:71], a[84:87]
    v_mfma_f32_16x16x32_bf16 a[84:87], v[44:47], v[84:87], a[84:87]
    ds_read_b64_tr_b16 v[34:35], v3 offset:34560
    v_mfma_f32_16x16x32_bf16 a[88:91], v[40:43], v[72:75], a[88:91]
    ds_read_b64_tr_b16 v[36:37], v3 offset:50944
    v_mfma_f32_16x16x32_bf16 a[88:91], v[44:47], v[88:91], a[88:91]
    v_mfma_f32_16x16x32_bf16 a[92:95], v[40:43], v[76:79], a[92:95]
    ds_read_b64_tr_b16 v[38:39], v3 offset:51456
    v_mfma_f32_16x16x32_bf16 a[92:95], v[44:47], v[92:95], a[92:95]
    s_waitcnt lgkmcnt(8)
    v_mfma_f32_16x16x32_bf16 a[96:99], v[48:51], v[64:67], a[96:99]
    s_add_u32 m0, s30, 18528
    ds_read_b64_tr_b16 v[40:41], v3 offset:34080
    v_mfma_f32_16x16x32_bf16 a[96:99], v[52:55], v[80:83], a[96:99]
    buffer_load_dwordx4 v5, s[8:11], s24 offen offset:1536 nt lds
    v_mfma_f32_16x16x32_bf16 a[100:103], v[48:51], v[68:71], a[100:103]
    ds_read_b64_tr_b16 v[42:43], v3 offset:34592
    v_mfma_f32_16x16x32_bf16 a[100:103], v[52:55], v[84:87], a[100:103]
    v_mfma_f32_16x16x32_bf16 a[104:107], v[48:51], v[72:75], a[104:107]
    ds_read_b64_tr_b16 v[44:45], v3 offset:50976
    v_mfma_f32_16x16x32_bf16 a[104:107], v[52:55], v[88:91], a[104:107]
    v_mfma_f32_16x16x32_bf16 a[108:111], v[48:51], v[76:79], a[108:111]
    ds_read_b64_tr_b16 v[46:47], v3 offset:51488
    v_mfma_f32_16x16x32_bf16 a[108:111], v[52:55], v[92:95], a[108:111]
    s_waitcnt lgkmcnt(8)
    v_mfma_f32_16x16x32_bf16 a[112:115], v[56:59], v[64:67], a[112:115]
    ds_read_b64_tr_b16 v[48:49], v3 offset:34112
    v_mfma_f32_16x16x32_bf16 a[112:115], v[60:63], v[80:83], a[112:115]
    v_mfma_f32_16x16x32_bf16 a[116:119], v[56:59], v[68:71], a[116:119]
    ds_read_b64_tr_b16 v[50:51], v3 offset:34624
    v_mfma_f32_16x16x32_bf16 a[116:119], v[60:63], v[84:87], a[116:119]
    v_mfma_f32_16x16x32_bf16 a[120:123], v[56:59], v[72:75], a[120:123]
    ds_read_b64_tr_b16 v[52:53], v3 offset:51008
    v_mfma_f32_16x16x32_bf16 a[120:123], v[60:63], v[88:91], a[120:123]
    v_mfma_f32_16x16x32_bf16 a[124:127], v[56:59], v[76:79], a[124:127]
    ds_read_b64_tr_b16 v[54:55], v3 offset:51520
    v_mfma_f32_16x16x32_bf16 a[124:127], v[60:63], v[92:95], a[124:127]
    s_waitcnt lgkmcnt(8)
    v_mfma_f32_16x16x32_bf16 a[128:131], v[32:35], v[64:67], a[128:131]
    ds_read_b64_tr_b16 v[56:57], v3 offset:34144
    v_mfma_f32_16x16x32_bf16 a[128:131], v[36:39], v[80:83], a[128:131]
    v_mfma_f32_16x16x32_bf16 a[132:135], v[32:35], v[68:71], a[132:135]
    ds_read_b64_tr_b16 v[58:59], v3 offset:34656
    v_mfma_f32_16x16x32_bf16 a[132:135], v[36:39], v[84:87], a[132:135]
    ds_read_b64_tr_b16 v[60:61], v3 offset:51040
    v_mfma_f32_16x16x32_bf16 a[136:139], v[32:35], v[72:75], a[136:139]
    v_mfma_f32_16x16x32_bf16 a[136:139], v[36:39], v[88:91], a[136:139]
    ds_read_b64_tr_b16 v[62:63], v3 offset:51552
    v_mfma_f32_16x16x32_bf16 a[140:143], v[32:35], v[76:79], a[140:143]
    v_mfma_f32_16x16x32_bf16 a[140:143], v[36:39], v[92:95], a[140:143]
    s_waitcnt lgkmcnt(8)
    ds_read_b64_tr_b16 v[32:33], v3 offset:34176
    v_mfma_f32_16x16x32_bf16 a[144:147], v[40:43], v[64:67], a[144:147]
    v_mfma_f32_16x16x32_bf16 a[144:147], v[44:47], v[80:83], a[144:147]
    ds_read_b64_tr_b16 v[34:35], v3 offset:34688
    v_mfma_f32_16x16x32_bf16 a[148:151], v[40:43], v[68:71], a[148:151]
    v_mfma_f32_16x16x32_bf16 a[148:151], v[44:47], v[84:87], a[148:151]
    ds_read_b64_tr_b16 v[36:37], v3 offset:51072
    v_mfma_f32_16x16x32_bf16 a[152:155], v[40:43], v[72:75], a[152:155]
    v_mfma_f32_16x16x32_bf16 a[152:155], v[44:47], v[88:91], a[152:155]
    ds_read_b64_tr_b16 v[38:39], v3 offset:51584
    v_mfma_f32_16x16x32_bf16 a[156:159], v[40:43], v[76:79], a[156:159]
    v_mfma_f32_16x16x32_bf16 a[156:159], v[44:47], v[92:95], a[156:159]
    s_waitcnt lgkmcnt(8)
    ds_read_b64_tr_b16 v[40:41], v3 offset:34208
    v_mfma_f32_16x16x32_bf16 a[160:163], v[48:51], v[64:67], a[160:163]
    v_mfma_f32_16x16x32_bf16 a[160:163], v[52:55], v[80:83], a[160:163]
    ds_read_b64_tr_b16 v[42:43], v3 offset:34720
    v_mfma_f32_16x16x32_bf16 a[164:167], v[48:51], v[68:71], a[164:167]
    v_mfma_f32_16x16x32_bf16 a[164:167], v[52:55], v[84:87], a[164:167]
    ds_read_b64_tr_b16 v[44:45], v3 offset:51104
    v_mfma_f32_16x16x32_bf16 a[168:171], v[48:51], v[72:75], a[168:171]
    v_mfma_f32_16x16x32_bf16 a[168:171], v[52:55], v[88:91], a[168:171]
    ds_read_b64_tr_b16 v[46:47], v3 offset:51616
    v_mfma_f32_16x16x32_bf16 a[172:175], v[48:51], v[76:79], a[172:175]
    v_mfma_f32_16x16x32_bf16 a[172:175], v[52:55], v[92:95], a[172:175]
    s_waitcnt lgkmcnt(8)
    ds_read_b64_tr_b16 v[48:49], v3 offset:34240
    v_mfma_f32_16x16x32_bf16 a[176:179], v[56:59], v[64:67], a[176:179]
    v_mfma_f32_16x16x32_bf16 a[176:179], v[60:63], v[80:83], a[176:179]
    ds_read_b64_tr_b16 v[50:51], v3 offset:34752
    v_mfma_f32_16x16x32_bf16 a[180:183], v[56:59], v[68:71], a[180:183]
    ds_read_b64_tr_b16 v[52:53], v3 offset:51136
    v_mfma_f32_16x16x32_bf16 a[180:183], v[60:63], v[84:87], a[180:183]
    v_mfma_f32_16x16x32_bf16 a[184:187], v[56:59], v[72:75], a[184:187]
    ds_read_b64_tr_b16 v[54:55], v3 offset:51648
    v_mfma_f32_16x16x32_bf16 a[184:187], v[60:63], v[88:91], a[184:187]
    v_mfma_f32_16x16x32_bf16 a[188:191], v[56:59], v[76:79], a[188:191]
    ds_read_b64_tr_b16 v[56:57], v3 offset:34272
    v_mfma_f32_16x16x32_bf16 a[188:191], v[60:63], v[92:95], a[188:191]
    s_waitcnt lgkmcnt(9)
    v_mfma_f32_16x16x32_bf16 a[192:195], v[32:35], v[64:67], a[192:195]
    ds_read_b64_tr_b16 v[58:59], v3 offset:34784
    v_mfma_f32_16x16x32_bf16 a[192:195], v[36:39], v[80:83], a[192:195]
    v_mfma_f32_16x16x32_bf16 a[196:199], v[32:35], v[68:71], a[196:199]
    ds_read_b64_tr_b16 v[60:61], v3 offset:51168
    v_mfma_f32_16x16x32_bf16 a[196:199], v[36:39], v[84:87], a[196:199]
    v_mfma_f32_16x16x32_bf16 a[200:203], v[32:35], v[72:75], a[200:203]
    ds_read_b64_tr_b16 v[62:63], v3 offset:51680
    v_mfma_f32_16x16x32_bf16 a[200:203], v[36:39], v[88:91], a[200:203]
    v_mfma_f32_16x16x32_bf16 a[204:207], v[32:35], v[76:79], a[204:207]
    v_mfma_f32_16x16x32_bf16 a[204:207], v[36:39], v[92:95], a[204:207]
    s_waitcnt lgkmcnt(8)
    v_mfma_f32_16x16x32_bf16 a[208:211], v[40:43], v[64:67], a[208:211]
    v_mfma_f32_16x16x32_bf16 a[208:211], v[44:47], v[80:83], a[208:211]
    v_mfma_f32_16x16x32_bf16 a[212:215], v[40:43], v[68:71], a[212:215]
    v_mfma_f32_16x16x32_bf16 a[212:215], v[44:47], v[84:87], a[212:215]
    v_mfma_f32_16x16x32_bf16 a[216:219], v[40:43], v[72:75], a[216:219]
    v_mfma_f32_16x16x32_bf16 a[216:219], v[44:47], v[88:91], a[216:219]
    s_waitcnt vmcnt(16) lgkmcnt(0)
    v_mfma_f32_16x16x32_bf16 a[220:223], v[40:43], v[76:79], a[220:223]
    s_barrier
    v_mfma_f32_16x16x32_bf16 a[220:223], v[44:47], v[92:95], a[220:223]
    v_mfma_f32_16x16x32_bf16 a[224:227], v[48:51], v[64:67], a[224:227]
    ds_read_b128 v[32:35], v1 offset:33792
    v_mfma_f32_16x16x32_bf16 a[224:227], v[52:55], v[80:83], a[224:227]
    v_mfma_f32_16x16x32_bf16 a[228:231], v[48:51], v[68:71], a[228:231]
    v_mfma_f32_16x16x32_bf16 a[228:231], v[52:55], v[84:87], a[228:231]
    v_mfma_f32_16x16x32_bf16 a[232:235], v[48:51], v[72:75], a[232:235]
    ds_read_b128 v[36:39], v1 offset:33856
    v_mfma_f32_16x16x32_bf16 a[232:235], v[52:55], v[88:91], a[232:235]
    v_mfma_f32_16x16x32_bf16 a[236:239], v[48:51], v[76:79], a[236:239]
    v_mfma_f32_16x16x32_bf16 a[236:239], v[52:55], v[92:95], a[236:239]
    ds_read_b128 v[40:43], v1 offset:33920
    v_mfma_f32_16x16x32_bf16 a[240:243], v[56:59], v[64:67], a[240:243]
    v_mfma_f32_16x16x32_bf16 a[240:243], v[60:63], v[80:83], a[240:243]
    v_mfma_f32_16x16x32_bf16 a[244:247], v[56:59], v[68:71], a[244:247]
    v_mfma_f32_16x16x32_bf16 a[244:247], v[60:63], v[84:87], a[244:247]
    ds_read_b128 v[44:47], v1 offset:33984
    v_mfma_f32_16x16x32_bf16 a[248:251], v[56:59], v[72:75], a[248:251]
    v_mfma_f32_16x16x32_bf16 a[248:251], v[60:63], v[88:91], a[248:251]
    v_mfma_f32_16x16x32_bf16 a[252:255], v[56:59], v[76:79], a[252:255]
    s_waitcnt lgkmcnt(2)
    ds_read_b128 v[48:51], v1 offset:34048
    v_mfma_f32_16x16x32_bf16 a[252:255], v[60:63], v[92:95], a[252:255]
    s_branch L_loopF
L_pf:
    s_cmp_eq_u32 s28, 12
    s_cbranch_scc0 L_pf0
    s_mov_b32 s33, 491520
    buffer_load_dword v2, v11, s[12:15], s33 offen
    s_branch L_pfback
L_pf0:
    s_branch L_pfback
L_tailF:
    s_waitcnt vmcnt(12)
    s_barrier
    v_mfma_f32_16x16x32_bf16 a[20:23], v[40:43], v[100:103], a[20:23]
    ds_write_b128 v9, v[80:83] offset:4096
    v_mfma_f32_16x16x32_bf16 a[20:23], v[44:47], v[84:87], a[20:23]
    v_exp_f32 v76, v76
    v_mfma_f32_16x16x32_bf16 a[24:27], v[40:43], v[104:107], a[24:27]
    ds_write_b128 v9, v[84:87] offset:5120
    v_mfma_f32_16x16x32_bf16 a[24:27], v[44:47], v[88:91], a[24:27]
    v_exp_f32 v77, v77
    v_mfma_f32_16x16x32_bf16 a[28:31], v[40:43], v[108:111], a[28:31]
    ds_read_b128 v[32:35], v1 offset:0
    v_add_f32 v15, v15, v76
    v_mfma_f32_16x16x32_bf16 a[28:31], v[44:47], v[92:95], a[28:31]
    s_waitcnt lgkmcnt(7)
    v_exp_f32 v78, v78
    v_mfma_f32_16x16x32_bf16 a[32:35], v[48:51], v[96:99], a[32:35]
    ds_write_b128 v9, v[88:91] offset:6144
    v_mfma_f32_16x16x32_bf16 a[32:35], v[52:55], v[80:83], a[32:35]
    v_exp_f32 v79, v79
    v_mfma_f32_16x16x32_bf16 a[36:39], v[48:51], v[100:103], a[36:39]
    ds_read_b128 v[36:39], v1 offset:64
    v_add_f32 v15, v15, v77
    v_mfma_f32_16x16x32_bf16 a[36:39], v[52:55], v[84:87], a[36:39]
    ds_write_b128 v9, v[92:95] offset:7168
    v_mfma_f32_16x16x32_bf16 a[40:43], v[48:51], v[104:107], a[40:43]
    v_exp_f32 v116, v116
    v_mfma_f32_16x16x32_bf16 a[40:43], v[52:55], v[88:91], a[40:43]
    ds_write_b128 v9, v[96:99] offset:0
    v_mfma_f32_16x16x32_bf16 a[44:47], v[48:51], v[108:111], a[44:47]
    ds_read_b128 v[40:43], v1 offset:128
    v_cvt_pk_bf16_f32 v76, v76, v77
    v_mfma_f32_16x16x32_bf16 a[44:47], v[52:55], v[92:95], a[44:47]
    s_waitcnt lgkmcnt(8)
    v_add_f32 v15, v15, v78
    v_add_f32 v15, v15, v79
    v_mfma_f32_16x16x32_bf16 a[48:51], v[56:59], v[96:99], a[48:51]
    v_exp_f32 v117, v117
    v_mfma_f32_16x16x32_bf16 a[48:51], v[60:63], v[80:83], a[48:51]
    ds_write_b128 v9, v[100:103] offset:1024
    v_mfma_f32_16x16x32_bf16 a[52:55], v[56:59], v[100:103], a[52:55]
    ds_read_b128 v[44:47], v1 offset:192
    v_cvt_pk_bf16_f32 v77, v78, v79
    v_mfma_f32_16x16x32_bf16 a[52:55], v[60:63], v[84:87], a[52:55]
    v_exp_f32 v118, v118
    v_mfma_f32_16x16x32_bf16 a[56:59], v[56:59], v[104:107], a[56:59]
    v_cvt_pk_bf16_f32 v67, v114, v115
    v_add_f32 v12, v12, v115
    v_mfma_f32_16x16x32_bf16 a[56:59], v[60:63], v[88:91], a[56:59]
    ds_write_b128 v9, v[104:107] offset:2048
    v_mfma_f32_16x16x32_bf16 a[60:63], v[56:59], v[108:111], a[60:63]
    ds_read_b128 v[48:51], v1 offset:256
    v_add_f32 v13, v13, v116
    v_mfma_f32_16x16x32_bf16 a[60:63], v[60:63], v[92:95], a[60:63]
    s_waitcnt lgkmcnt(7)
    v_exp_f32 v119, v119
    v_mfma_f32_16x16x32_bf16 v[80:83], v[32:35], v[128:131], v[16:19]
    v_exp_f32 v120, v120
    v_mfma_f32_16x16x32_bf16 v[80:83], v[36:39], v[132:135], v[80:83]
    ds_write_b128 v9, v[108:111] offset:3072
    v_mfma_f32_16x16x32_bf16 v[84:87], v[32:35], v[160:163], v[20:23]
    ds_read_b128 v[52:55], v1 offset:320
    v_cvt_pk_bf16_f32 v70, v116, v117
    v_mfma_f32_16x16x32_bf16 v[84:87], v[36:39], v[164:167], v[84:87]
    v_exp_f32 v121, v121
    v_mfma_f32_16x16x32_bf16 v[88:91], v[32:35], v[192:195], v[24:27]
    v_add_f32 v13, v13, v117
    v_add_f32 v13, v13, v118
    v_mfma_f32_16x16x32_bf16 v[88:91], v[36:39], v[196:199], v[88:91]
    v_exp_f32 v122, v122
    v_mfma_f32_16x16x32_bf16 v[92:95], v[32:35], v[224:227], v[28:31]
    ds_read_b128 v[56:59], v1 offset:384
    v_cvt_pk_bf16_f32 v71, v118, v119
    v_mfma_f32_16x16x32_bf16 v[92:95], v[36:39], v[228:231], v[92:95]
    s_waitcnt lgkmcnt(5)
    v_exp_f32 v123, v123
    v_mfma_f32_16x16x32_bf16 v[80:83], v[40:43], v[136:139], v[80:83]
    v_add_f32 v13, v13, v119
    v_add_f32 v14, v14, v120
    v_mfma_f32_16x16x32_bf16 v[80:83], v[44:47], v[140:143], v[80:83]
    v_exp_f32 v124, v124
    v_mfma_f32_16x16x32_bf16 v[84:87], v[40:43], v[168:171], v[84:87]
    ds_read_b128 v[60:63], v1 offset:448
    v_cvt_pk_bf16_f32 v74, v120, v121
    v_mfma_f32_16x16x32_bf16 v[84:87], v[44:47], v[172:175], v[84:87]
    v_exp_f32 v125, v125
    v_mfma_f32_16x16x32_bf16 v[88:91], v[40:43], v[200:203], v[88:91]
    v_add_f32 v14, v14, v121
    v_add_f32 v14, v14, v122
    v_mfma_f32_16x16x32_bf16 v[88:91], v[44:47], v[204:207], v[88:91]
    v_exp_f32 v126, v126
    v_mfma_f32_16x16x32_bf16 v[92:95], v[40:43], v[232:235], v[92:95]
    ds_read_b128 v[32:35], v1 offset:512
    v_cvt_pk_bf16_f32 v75, v122, v123
    v_mfma_f32_16x16x32_bf16 v[92:95], v[44:47], v[236:239], v[92:95]
    s_waitcnt lgkmcnt(3)
    v_exp_f32 v127, v127
    v_mfma_f32_16x16x32_bf16 v[80:83], v[48:51], v[144:147], v[80:83]
    v_add_f32 v14, v14, v123
    v_add_f32 v15, v15, v124
    v_mfma_f32_16x16x32_bf16 v[80:83], v[52:55], v[148:151], v[80:83]
    v_cvt_pk_bf16_f32 v78, v124, v125
    v_add_f32 v15, v15, v125
    v_mfma_f32_16x16x32_bf16 v[84:87], v[48:51], v[176:179], v[84:87]
    ds_read_b128 v[36:39], v1 offset:576
    v_add_f32 v15, v15, v126
    v_mfma_f32_16x16x32_bf16 v[84:87], v[52:55], v[180:183], v[84:87]
    v_cvt_pk_bf16_f32 v79, v126, v127
    v_add_f32 v15, v15, v127
    v_mfma_f32_16x16x32_bf16 v[88:91], v[48:51], v[208:211], v[88:91]
    v_mfma_f32_16x16x32_bf16 v[88:91], v[52:55], v[212:215], v[88:91]
    v_mfma_f32_16x16x32_bf16 v[92:95], v[48:51], v[240:243], v[92:95]
    ds_read_b128 v[40:43], v1 offset:640
    v_mfma_f32_16x16x32_bf16 v[92:95], v[52:55], v[244:247], v[92:95]
    s_waitcnt lgkmcnt(3)
    v_mfma_f32_16x16x32_bf16 v[80:83], v[56:59], v[152:155], v[80:83]
    v_mfma_f32_16x16x32_bf16 v[80:83], v[60:63], v[156:159], v[80:83]
    v_mfma_f32_16x16x32_bf16 v[84:87], v[56:59], v[184:187], v[84:87]
    ds_read_b128 v[44:47], v1 offset:704
    v_mfma_f32_16x16x32_bf16 v[84:87], v[60:63], v[188:191], v[84:87]
    v_mfma_f32_16x16x32_bf16 v[88:91], v[56:59], v[216:219], v[88:91]
    v_mfma_f32_16x16x32_bf16 v[88:91], v[60:63], v[220:223], v[88:91]
    v_mfma_f32_16x16x32_bf16 v[92:95], v[56:59], v[248:251], v[92:95]
    ds_read_b128 v[48:51], v1 offset:768
    v_mfma_f32_16x16x32_bf16 v[92:95], v[60:63], v[252:255], v[92:95]
    s_waitcnt lgkmcnt(3)
    v_exp_f32 v80, v80
    v_mfma_f32_16x16x32_bf16 v[112:115], v[32:35], v[128:131], v[16:19]
    v_exp_f32 v81, v81
    v_mfma_f32_16x16x32_bf16 v[112:115], v[36:39], v[132:135], v[112:115]
    v_exp_f32 v82, v82
    v_mfma_f32_16x16x32_bf16 v[116:119], v[32:35], v[160:163], v[20:23]
    ds_read_b128 v[52:55], v1 offset:832
    v_add_f32 v12, v12, v80
    v_mfma_f32_16x16x32_bf16 v[116:119], v[36:39], v[164:167], v[116:119]
    v_exp_f32 v83, v83
    v_mfma_f32_16x16x32_bf16 v[120:123], v[32:35], v[192:195], v[24:27]
    v_exp_f32 v84, v84
    v_mfma_f32_16x16x32_bf16 v[120:123], v[36:39], v[196:199], v[120:123]
    v_exp_f32 v85, v85
    v_mfma_f32_16x16x32_bf16 v[124:127], v[32:35], v[224:227], v[28:31]
    ds_read_b128 v[56:59], v1 offset:896
    v_add_f32 v12, v12, v81
    v_mfma_f32_16x16x32_bf16 v[124:127], v[36:39], v[228:231], v[124:127]
    s_waitcnt lgkmcnt(3)
    v_exp_f32 v86, v86
    v_mfma_f32_16x16x32_bf16 v[112:115], v[40:43], v[136:139], v[112:115]
    v_cvt_pk_bf16_f32 v80, v80, v81
    v_add_f32 v12, v12, v82
    v_mfma_f32_16x16x32_bf16 v[112:115], v[44:47], v[140:143], v[112:115]
    v_exp_f32 v87, v87
    v_mfma_f32_16x16x32_bf16 v[116:119], v[40:43], v[168:171], v[116:119]
    ds_read_b128 v[60:63], v1 offset:960
    v_add_f32 v12, v12, v83
    v_mfma_f32_16x16x32_bf16 v[116:119], v[44:47], v[172:175], v[116:119]
    v_exp_f32 v88, v88
    v_mfma_f32_16x16x32_bf16 v[120:123], v[40:43], v[200:203], v[120:123]
    v_cvt_pk_bf16_f32 v81, v82, v83
    v_add_f32 v13, v13, v84
    v_mfma_f32_16x16x32_bf16 v[120:123], v[44:47], v[204:207], v[120:123]
    v_exp_f32 v89, v89
    v_mfma_f32_16x16x32_bf16 v[124:127], v[40:43], v[232:235], v[124:127]
    ds_read_b128 v[32:35], v1 offset:16896
    v_add_f32 v13, v13, v85
    v_mfma_f32_16x16x32_bf16 v[124:127], v[44:47], v[236:239], v[124:127]
    s_waitcnt lgkmcnt(3)
    v_exp_f32 v90, v90
    v_mfma_f32_16x16x32_bf16 v[112:115], v[48:51], v[144:147], v[112:115]
    v_cvt_pk_bf16_f32 v84, v84, v85
    v_add_f32 v13, v13, v86
    v_mfma_f32_16x16x32_bf16 v[112:115], v[52:55], v[148:151], v[112:115]
    v_exp_f32 v91, v91
    v_mfma_f32_16x16x32_bf16 v[116:119], v[48:51], v[176:179], v[116:119]
    ds_read_b128 v[36:39], v1 offset:16960
    v_add_f32 v13, v13, v87
    v_mfma_f32_16x16x32_bf16 v[116:119], v[52:55], v[180:183], v[116:119]
    v_exp_f32 v92, v92
    v_mfma_f32_16x16x32_bf16 v[120:123], v[48:51], v[208:211], v[120:123]
    v_cvt_pk_bf16_f32 v85, v86, v87
    v_add_f32 v14, v14, v88
    v_mfma_f32_16x16x32_bf16 v[120:123], v[52:55], v[212:215], v[120:123]
    v_exp_f32 v93, v93
    v_mfma_f32_16x16x32_bf16 v[124:127], v[48:51], v[240:243], v[124:127]
    ds_read_b128 v[40:43], v1 offset:17024
    v_add_f32 v14, v14, v89
    v_mfma_f32_16x16x32_bf16 v[124:127], v[52:55], v[244:247], v[124:127]
    s_waitcnt lgkmcnt(3)
    v_exp_f32 v94, v94
    v_mfma_f32_16x16x32_bf16 v[112:115], v[56:59], v[152:155], v[112:115]
    v_cvt_pk_bf16_f32 v88, v88, v89
    v_add_f32 v14, v14, v90
    v_mfma_f32_16x16x32_bf16 v[112:115], v[60:63], v[156:159], v[112:115]
    v_exp_f32 v95, v95
    v_mfma_f32_16x16x32_bf16 v[116:119], v[56:59], v[184:187], v[116:119]
    ds_read_b128 v[44:47], v1 offset:17088
    v_add_f32 v14, v14, v91
    v_mfma_f32_16x16x32_bf16 v[116:119], v[60:63], v[188:191], v[116:119]
    v_cvt_pk_bf16_f32 v89, v90, v91
    v_add_f32 v15, v15, v92
    v_mfma_f32_16x16x32_bf16 v[120:123], v[56:59], v[216:219], v[120:123]
    v_add_f32 v15, v15, v93
    v_cvt_pk_bf16_f32 v92, v92, v93
    v_mfma_f32_16x16x32_bf16 v[120:123], v[60:63], v[220:223], v[120:123]
    v_add_f32 v15, v15, v94
    v_add_f32 v15, v15, v95
    v_mfma_f32_16x16x32_bf16 v[124:127], v[56:59], v[248:251], v[124:127]
    ds_read_b128 v[48:51], v1 offset:17152
    v_cvt_pk_bf16_f32 v93, v94, v95
    v_mfma_f32_16x16x32_bf16 v[124:127], v[60:63], v[252:255], v[124:127]
    s_waitcnt lgkmcnt(3)
    v_exp_f32 v112, v112
    v_mfma_f32_16x16x32_bf16 v[96:99], v[32:35], v[128:131], v[16:19]
    v_exp_f32 v113, v113
    v_mfma_f32_16x16x32_bf16 v[96:99], v[36:39], v[132:135], v[96:99]
    v_exp_f32 v114, v114
    v_mfma_f32_16x16x32_bf16 v[100:103], v[32:35], v[160:163], v[20:23]
    ds_read_b128 v[52:55], v1 offset:17216
    v_add_f32 v12, v12, v112
    v_mfma_f32_16x16x32_bf16 v[100:103], v[36:39], v[164:167], v[100:103]
    v_exp_f32 v115, v115
    v_mfma_f32_16x16x32_bf16 v[104:107], v[32:35], v[192:195], v[24:27]
    v_exp_f32 v116, v116
    v_mfma_f32_16x16x32_bf16 v[104:107], v[36:39], v[196:199], v[104:107]
    v_exp_f32 v117, v117
    v_mfma_f32_16x16x32_bf16 v[108:111], v[32:35], v[224:227], v[28:31]
    ds_read_b128 v[56:59], v1 offset:17280
    v_cvt_pk_bf16_f32 v82, v112, v113
    v_mfma_f32_16x16x32_bf16 v[108:111], v[36:39], v[228:231], v[108:111]
    s_waitcnt lgkmcnt(3)
    v_add_f32 v12, v12, v113
    v_add_f32 v12, v12, v114
    v_mfma_f32_16x16x32_bf16 v[96:99], v[40:43], v[136:139], v[96:99]
    v_exp_f32 v118, v118
    v_mfma_f32_16x16x32_bf16 v[96:99], v[44:47], v[140:143], v[96:99]
    v_cvt_pk_bf16_f32 v83, v114, v115
    v_add_f32 v12, v12, v115
    v_mfma_f32_16x16x32_bf16 v[100:103], v[40:43], v[168:171], v[100:103]
    ds_read_b128 v[60:63], v1 offset:17344
    v_add_f32 v13, v13, v116
    v_mfma_f32_16x16x32_bf16 v[100:103], v[44:47], v[172:175], v[100:103]
    ds_read_b128 v[32:35], v1 offset:17408
    v_cvt_pk_bf16_f32 v86, v116, v117
    v_mfma_f32_16x16x32_bf16 v[104:107], v[40:43], v[200:203], v[104:107]
    ds_read_b128 v[36:39], v1 offset:17472
    v_add_f32 v13, v13, v117
    v_mfma_f32_16x16x32_bf16 v[104:107], v[44:47], v[204:207], v[104:107]
    v_exp_f32 v119, v119
    v_mfma_f32_16x16x32_bf16 v[108:111], v[40:43], v[232:235], v[108:111]
    v_exp_f32 v120, v120
    v_mfma_f32_16x16x32_bf16 v[108:111], v[44:47], v[236:239], v[108:111]
    s_waitcnt lgkmcnt(4)
    v_exp_f32 v121, v121
    v_mfma_f32_16x16x32_bf16 v[96:99], v[48:51], v[144:147], v[96:99]
    ds_read_b128 v[40:43], v1 offset:17536
    v_add_f32 v13, v13, v118
    v_mfma_f32_16x16x32_bf16 v[96:99], v[52:55], v[148:151], v[96:99]
    v_exp_f32 v122, v122
    v_mfma_f32_16x16x32_bf16 v[100:103], v[48:51], v[176:179], v[100:103]
    v_cvt_pk_bf16_f32 v87, v118, v119
    v_add_f32 v13, v13, v119
    v_mfma_f32_16x16x32_bf16 v[100:103], v[52:55], v[180:183], v[100:103]
    v_exp_f32 v123, v123
    v_mfma_f32_16x16x32_bf16 v[104:107], v[48:51], v[208:211], v[104:107]
    ds_read_b128 v[44:47], v1 offset:17600
    v_add_f32 v14, v14, v120
    v_mfma_f32_16x16x32_bf16 v[104:107], v[52:55], v[212:215], v[104:107]
    v_exp_f32 v124, v124
    v_mfma_f32_16x16x32_bf16 v[108:111], v[48:51], v[240:243], v[108:111]
    v_exp_f32 v125, v125
    v_mfma_f32_16x16x32_bf16 v[108:111], v[52:55], v[244:247], v[108:111]
    s_waitcnt lgkmcnt(4)
    v_cvt_pk_bf16_f32 v90, v120, v121
    v_add_f32 v14, v14, v121
    v_mfma_f32_16x16x32_bf16 v[96:99], v[56:59], v[152:155], v[96:99]
    ds_read_b128 v[48:51], v1 offset:17664
    v_add_f32 v14, v14, v122
    v_mfma_f32_16x16x32_bf16 v[96:99], v[60:63], v[156:159], v[96:99]
    v_exp_f32 v126, v126
    v_mfma_f32_16x16x32_bf16 v[100:103], v[56:59], v[184:187], v[100:103]
    v_cvt_pk_bf16_f32 v91, v122, v123
    v_add_f32 v14, v14, v123
    v_mfma_f32_16x16x32_bf16 v[100:103], v[60:63], v[188:191], v[100:103]
    v_exp_f32 v127, v127
    v_mfma_f32_16x16x32_bf16 v[104:107], v[56:59], v[216:219], v[104:107]
    ds_read_b128 v[52:55], v1 offset:17728
    v_add_f32 v15, v15, v124
    v_mfma_f32_16x16x32_bf16 v[104:107], v[60:63], v[220:223], v[104:107]
    v_cvt_pk_bf16_f32 v94, v124, v125
    v_add_f32 v15, v15, v125
    v_mfma_f32_16x16x32_bf16 v[108:111], v[56:59], v[248:251], v[108:111]
    v_add_f32 v15, v15, v126
    v_cvt_pk_bf16_f32 v95, v126, v127
    v_mfma_f32_16x16x32_bf16 v[108:111], v[60:63], v[252:255], v[108:111]
    s_waitcnt lgkmcnt(4)
    v_exp_f32 v96, v96
    v_mfma_f32_16x16x32_bf16 v[112:115], v[32:35], v[128:131], v[16:19]
    ds_read_b128 v[56:59], v1 offset:17792
    v_add_f32 v15, v15, v127
    v_mfma_f32_16x16x32_bf16 v[112:115], v[36:39], v[132:135], v[112:115]
    v_exp_f32 v97, v97
    v_mfma_f32_16x16x32_bf16 v[116:119], v[32:35], v[160:163], v[20:23]
    v_exp_f32 v98, v98
    v_mfma_f32_16x16x32_bf16 v[116:119], v[36:39], v[164:167], v[116:119]
    v_exp_f32 v99, v99
    v_mfma_f32_16x16x32_bf16 v[120:123], v[32:35], v[192:195], v[24:27]
    ds_read_b128 v[60:63], v1 offset:17856
    v_add_f32 v12, v12, v96
    v_mfma_f32_16x16x32_bf16 v[120:123], v[36:39], v[196:199], v[120:123]
    v_exp_f32 v100, v100
    v_mfma_f32_16x16x32_bf16 v[124:127], v[32:35], v[224:227], v[28:31]
    v_exp_f32 v101, v101
    v_mfma_f32_16x16x32_bf16 v[124:127], v[36:39], v[228:231], v[124:127]
    s_waitcnt lgkmcnt(4)
    v_add_f32 v12, v12, v97
    v_cvt_pk_bf16_f32 v96, v96, v97
    v_mfma_f32_16x16x32_bf16 v[112:115], v[40:43], v[136:139], v[112:115]
    v_exp_f32 v102, v102
    v_mfma_f32_16x16x32_bf16 v[112:115], v[44:47], v[140:143], v[112:115]
    v_add_f32 v12, v12, v98
    v_add_f32 v12, v12, v99
    v_mfma_f32_16x16x32_bf16 v[116:119], v[40:43], v[168:171], v[116:119]
    v_exp_f32 v103, v103
    v_mfma_f32_16x16x32_bf16 v[116:119], v[44:47], v[172:175], v[116:119]
    v_exp_f32 v104, v104
    v_mfma_f32_16x16x32_bf16 v[120:123], v[40:43], v[200:203], v[120:123]
    v_cvt_pk_bf16_f32 v97, v98, v99
    v_add_f32 v13, v13, v100
    v_mfma_f32_16x16x32_bf16 v[120:123], v[44:47], v[204:207], v[120:123]
    s_waitcnt vmcnt(0) lgkmcnt(0)
    v_exp_f32 v105, v105
    v_mfma_f32_16x16x32_bf16 v[124:127], v[40:43], v[232:235], v[124:127]
    s_barrier
    v_mfma_f32_16x16x32_bf16 v[124:127], v[44:47], v[236:239], v[124:127]
    s_waitcnt lgkmcnt(0)
    ds_read_b64_tr_b16 v[32:33], v3 offset:33792
    v_add_f32 v13, v13, v101
    v_mfma_f32_16x16x32_bf16 v[112:115], v[48:51], v[144:147], v[112:115]
    ds_read_b64_tr_b16 v[34:35], v3 offset:34304
    v_cvt_pk_bf16_f32 v100, v100, v101
    v_mfma_f32_16x16x32_bf16 v[112:115], v[52:55], v[148:151], v[112:115]
    ds_read_b64_tr_b16 v[36:37], v3 offset:50688
    v_add_f32 v13, v13, v102
    v_mfma_f32_16x16x32_bf16 v[116:119], v[48:51], v[176:179], v[116:119]
    s_add_u32 m0, s30, 0
    ds_read_b64_tr_b16 v[38:39], v3 offset:51200
    v_add_f32 v13, v13, v103
    v_mfma_f32_16x16x32_bf16 v[116:119], v[52:55], v[180:183], v[116:119]
    buffer_load_dwordx4 v5, s[12:15], s23 offen offset:0 nt lds
    v_mfma_f32_16x16x32_bf16 v[120:123], v[48:51], v[208:211], v[120:123]
    ds_read_b64_tr_b16 v[40:41], v3 offset:33824
    v_cvt_pk_bf16_f32 v101, v102, v103
    v_mfma_f32_16x16x32_bf16 v[120:123], v[52:55], v[212:215], v[120:123]
    v_exp_f32 v106, v106
    v_mfma_f32_16x16x32_bf16 v[124:127], v[48:51], v[240:243], v[124:127]
    ds_read_b64_tr_b16 v[42:43], v3 offset:34336
    v_add_f32 v14, v14, v104
    v_mfma_f32_16x16x32_bf16 v[124:127], v[52:55], v[244:247], v[124:127]
    s_waitcnt lgkmcnt(6)
    v_exp_f32 v107, v107
    v_mfma_f32_16x16x32_bf16 v[112:115], v[56:59], v[152:155], v[112:115]
    s_add_u32 m0, s30, 544
    ds_read_b64_tr_b16 v[44:45], v3 offset:50720
    v_add_f32 v14, v14, v105
    v_mfma_f32_16x16x32_bf16 v[112:115], v[60:63], v[156:159], v[112:115]
    buffer_load_dwordx4 v5, s[12:15], s23 offen offset:512 nt lds
    v_mfma_f32_16x16x32_bf16 v[116:119], v[56:59], v[184:187], v[116:119]
    ds_read_b64_tr_b16 v[46:47], v3 offset:51232
    v_cvt_pk_bf16_f32 v104, v104, v105
    v_mfma_f32_16x16x32_bf16 v[116:119], v[60:63], v[188:191], v[116:119]
    v_exp_f32 v108, v108
    v_mfma_f32_16x16x32_bf16 v[120:123], v[56:59], v[216:219], v[120:123]
    s_add_u32 m0, s30, 1088
    ds_read_b64_tr_b16 v[48:49], v3 offset:33856
    v_add_f32 v14, v14, v106
    v_mfma_f32_16x16x32_bf16 v[120:123], v[60:63], v[220:223], v[120:123]
    buffer_load_dwordx4 v5, s[12:15], s23 offen offset:1024 nt lds
    v_mfma_f32_16x16x32_bf16 v[124:127], v[56:59], v[248:251], v[124:127]
    ds_read_b64_tr_b16 v[50:51], v3 offset:34368
    v_add_f32 v14, v14, v107
    v_mfma_f32_16x16x32_bf16 v[124:127], v[60:63], v[252:255], v[124:127]
    s_waitcnt lgkmcnt(6)
    v_exp_f32 v109, v109
    v_mfma_f32_16x16x32_bf16 a[0:3], v[32:35], v[64:67], a[0:3]
    s_add_u32 m0, s30, 1632
    ds_read_b64_tr_b16 v[52:53], v3 offset:50752
    v_cvt_pk_bf16_f32 v105, v106, v107
    v_mfma_f32_16x16x32_bf16 a[0:3], v[36:39], v[80:83], a[0:3]
    buffer_load_dwordx4 v5, s[12:15], s23 offen offset:1536 nt lds
    v_mfma_f32_16x16x32_bf16 a[4:7], v[32:35], v[68:71], a[4:7]
    ds_read_b64_tr_b16 v[54:55], v3 offset:51264
    v_add_f32 v15, v15, v108
    v_mfma_f32_16x16x32_bf16 a[4:7], v[36:39], v[84:87], a[4:7]
    v_exp_f32 v110, v110
    v_mfma_f32_16x16x32_bf16 a[8:11], v[32:35], v[72:75], a[8:11]
    s_add_u32 m0, s30, 16896
    ds_read_b64_tr_b16 v[56:57], v3 offset:33888
    v_add_f32 v15, v15, v109
    v_mfma_f32_16x16x32_bf16 a[8:11], v[36:39], v[88:91], a[8:11]
    buffer_load_dwordx4 v5, s[12:15], s25 offen offset:0 nt lds
    v_mfma_f32_16x16x32_bf16 a[12:15], v[32:35], v[76:79], a[12:15]
    ds_read_b64_tr_b16 v[58:59], v3 offset:34400
    v_cvt_pk_bf16_f32 v108, v108, v109
    v_mfma_f32_16x16x32_bf16 a[12:15], v[36:39], v[92:95], a[12:15]
    s_waitcnt lgkmcnt(6)
    v_exp_f32 v111, v111
    v_mfma_f32_16x16x32_bf16 a[16:19], v[40:43], v[64:67], a[16:19]
    s_add_u32 m0, s30, 17440
    ds_read_b64_tr_b16 v[60:61], v3 offset:50784
    v_add_f32 v15, v15, v110
    v_mfma_f32_16x16x32_bf16 a[16:19], v[44:47], v[80:83], a[16:19]
    buffer_load_dwordx4 v5, s[12:15], s25 offen offset:512 nt lds
    v_mfma_f32_16x16x32_bf16 a[20:23], v[40:43], v[68:71], a[20:23]
    ds_read_b64_tr_b16 v[62:63], v3 offset:51296
    v_add_f32 v15, v15, v111
    v_mfma_f32_16x16x32_bf16 a[20:23], v[44:47], v[84:87], a[20:23]
    s_add_u32 m0, s30, 17984
    v_exp_f32 v112, v112
    v_mfma_f32_16x16x32_bf16 a[24:27], v[40:43], v[72:75], a[24:27]
    buffer_load_dwordx4 v5, s[12:15], s25 offen offset:1024 nt lds
    v_mfma_f32_16x16x32_bf16 a[24:27], v[44:47], v[88:91], a[24:27]
    v_exp_f32 v113, v113
    v_mfma_f32_16x16x32_bf16 a[28:31], v[40:43], v[76:79], a[28:31]
    ds_read_b128 v[32:35], v1 offset:33792
    v_cvt_pk_bf16_f32 v109, v110, v111
    v_mfma_f32_16x16x32_bf16 a[28:31], v[44:47], v[92:95], a[28:31]
    s_waitcnt lgkmcnt(5)
    v_exp_f32 v114, v114
    v_mfma_f32_16x16x32_bf16 a[32:35], v[48:51], v[64:67], a[32:35]
    s_add_u32 m0, s30, 18528
    v_exp_f32 v115, v115
    v_mfma_f32_16x16x32_bf16 a[32:35], v[52:55], v[80:83], a[32:35]
    buffer_load_dwordx4 v5, s[12:15], s25 offen offset:1536 nt lds
    v_mfma_f32_16x16x32_bf16 a[36:39], v[48:51], v[68:71], a[36:39]
    ds_read_b128 v[36:39], v1 offset:33856
    v_add_f32 v12, v12, v112
    v_mfma_f32_16x16x32_bf16 a[36:39], v[52:55], v[84:87], a[36:39]
    v_exp_f32 v116, v116
    v_mfma_f32_16x16x32_bf16 a[40:43], v[48:51], v[72:75], a[40:43]
    v_exp_f32 v117, v117
    v_mfma_f32_16x16x32_bf16 a[40:43], v[52:55], v[88:91], a[40:43]
    v_cvt_pk_bf16_f32 v98, v112, v113
    v_add_f32 v12, v12, v113
    v_mfma_f32_16x16x32_bf16 a[44:47], v[48:51], v[76:79], a[44:47]
    ds_read_b128 v[40:43], v1 offset:33920
    v_add_f32 v12, v12, v114
    v_mfma_f32_16x16x32_bf16 a[44:47], v[52:55], v[92:95], a[44:47]
    s_waitcnt lgkmcnt(3)
    v_exp_f32 v118, v118
    v_mfma_f32_16x16x32_bf16 a[48:51], v[56:59], v[64:67], a[48:51]
    v_cvt_pk_bf16_f32 v99, v114, v115
    v_exp_f32 v119, v119
    v_mfma_f32_16x16x32_bf16 a[48:51], v[60:63], v[80:83], a[48:51]
    v_add_f32 v12, v12, v115
    v_exp_f32 v120, v120
    v_mfma_f32_16x16x32_bf16 a[52:55], v[56:59], v[68:71], a[52:55]
    ds_read_b128 v[44:47], v1 offset:33984
    v_add_f32 v13, v13, v116
    v_cvt_pk_bf16_f32 v102, v116, v117
    v_mfma_f32_16x16x32_bf16 a[52:55], v[60:63], v[84:87], a[52:55]
    v_exp_f32 v121, v121
    v_add_f32 v13, v13, v117
    v_mfma_f32_16x16x32_bf16 a[56:59], v[56:59], v[72:75], a[56:59]
    v_add_f32 v13, v13, v118
    v_exp_f32 v122, v122
    v_mfma_f32_16x16x32_bf16 a[56:59], v[60:63], v[88:91], a[56:59]
    v_cvt_pk_bf16_f32 v103, v118, v119
    v_exp_f32 v123, v123
    v_mfma_f32_16x16x32_bf16 a[60:63], v[56:59], v[76:79], a[60:63]
    ds_read_b128 v[48:51], v1 offset:34048
    v_add_f32 v13, v13, v119
    v_add_f32 v14, v14, v120
    v_mfma_f32_16x16x32_bf16 a[60:63], v[60:63], v[92:95], a[60:63]
    s_waitcnt lgkmcnt(3)
    v_exp_f32 v124, v124
    v_cvt_pk_bf16_f32 v106, v120, v121
    v_mfma_f32_16x16x32_bf16 v[112:115], v[32:35], v[128:131], v[16:19]
    v_exp_f32 v125, v125
    v_add_f32 v14, v14, v121
    v_mfma_f32_16x16x32_bf16 v[112:115], v[36:39], v[132:135], v[112:115]
    v_add_f32 v14, v14, v122
    v_exp_f32 v126, v126
    v_mfma_f32_16x16x32_bf16 v[116:119], v[32:35], v[160:163], v[20:23]
    ds_read_b128 v[52:55], v1 offset:34112
    v_cvt_pk_bf16_f32 v107, v122, v123
    v_add_f32 v14, v14, v123
    v_mfma_f32_16x16x32_bf16 v[116:119], v[36:39], v[164:167], v[116:119]
    v_exp_f32 v127, v127
    v_add_f32 v15, v15, v124
    v_mfma_f32_16x16x32_bf16 v[120:123], v[32:35], v[192:195], v[24:27]
    v_cvt_pk_bf16_f32 v110, v124, v125
    v_add_f32 v15, v15, v125
    v_add_f32 v15, v15, v126
    v_mfma_f32_16x16x32_bf16 v[120:123], v[36:39], v[196:199], v[120:123]
    v_cvt_pk_bf16_f32 v111, v126, v127
    v_add_f32 v15, v15, v127
    v_mfma_f32_16x16x32_bf16 v[124:127], v[32:35], v[224:227], v[28:31]
    ds_read_b128 v[56:59], v1 offset:34176
    v_mfma_f32_16x16x32_bf16 v[124:127], v[36:39], v[228:231], v[124:127]
    s_waitcnt lgkmcnt(3)
    v_mfma_f32_16x16x32_bf16 v[112:115], v[40:43], v[136:139], v[112:115]
    v_mfma_f32_16x16x32_bf16 v[112:115], v[44:47], v[140:143], v[112:115]
    v_mfma_f32_16x16x32_bf16 v[116:119], v[40:43], v[168:171], v[116:119]
    ds_read_b128 v[60:63], v1 offset:34240
    v_mfma_f32_16x16x32_bf16 v[116:119], v[44:47], v[172:175], v[116:119]
    v_mfma_f32_16x16x32_bf16 v[120:123], v[40:43], v[200:203], v[120:123]
    v_mfma_f32_16x16x32_bf16 v[120:123], v[44:47], v[204:207], v[120:123]
    v_mfma_f32_16x16x32_bf16 v[124:127], v[40:43], v[232:235], v[124:127]
    ds_read_b128 v[32:35], v1 offset:34304
    v_mfma_f32_16x16x32_bf16 v[124:127], v[44:47], v[236:239], v[124:127]
    s_waitcnt lgkmcnt(3)
    v_mfma_f32_16x16x32_bf16 v[112:115], v[48:51], v[144:147], v[112:115]
    v_mfma_f32_16x16x32_bf16 v[112:115], v[52:55], v[148:151], v[112:115]
    v_mfma_f32_16x16x32_bf16 v[116:119], v[48:51], v[176:179], v[116:119]
    ds_read_b128 v[36:39], v1 offset:34368
    v_mfma_f32_16x16x32_bf16 v[116:119], v[52:55], v[180:183], v[116:119]
    v_mfma_f32_16x16x32_bf16 v[120:123], v[48:51], v[208:211], v[120:123]
    v_mfma_f32_16x16x32_bf16 v[120:123], v[52:55], v[212:215], v[120:123]
    v_mfma_f32_16x16x32_bf16 v[124:127], v[48:51], v[240:243], v[124:127]
    ds_read_b128 v[40:43], v1 offset:34432
    v_mfma_f32_16x16x32_bf16 v[124:127], v[52:55], v[244:247], v[124:127]
    s_waitcnt lgkmcnt(3)
    v_mfma_f32_16x16x32_bf16 v[112:115], v[56:59], v[152:155], v[112:115]
    v_mfma_f32_16x16x32_bf16 v[112:115], v[60:63], v[156:159], v[112:115]
    v_mfma_f32_16x16x32_bf16 v[116:119], v[56:59], v[184:187], v[116:119]
    ds_read_b128 v[44:47], v1 offset:34496
    v_mfma_f32_16x16x32_bf16 v[116:119], v[60:63], v[188:191], v[116:119]
    v_mfma_f32_16x16x32_bf16 v[120:123], v[56:59], v[216:219], v[120:123]
    v_mfma_f32_16x16x32_bf16 v[120:123], v[60:63], v[220:223], v[120:123]
    v_mfma_f32_16x16x32_bf16 v[124:127], v[56:59], v[248:251], v[124:127]
    ds_read_b128 v[48:51], v1 offset:34560
    v_mfma_f32_16x16x32_bf16 v[124:127], v[60:63], v[252:255], v[124:127]
    s_waitcnt lgkmcnt(3)
    v_exp_f32 v112, v112
    v_mfma_f32_16x16x32_bf16 v[16:19], v[32:35], v[128:131], v[16:19]
    v_exp_f32 v113, v113
    v_mfma_f32_16x16x32_bf16 v[16:19], v[36:39], v[132:135], v[16:19]
    v_exp_f32 v114, v114
    v_mfma_f32_16x16x32_bf16 v[20:23], v[32:35], v[160:163], v[20:23]
    ds_read_b128 v[52:55], v1 offset:34624
    v_add_f32 v12, v12, v112
    v_mfma_f32_16x16x32_bf16 v[20:23], v[36:39], v[164:167], v[20:23]
    v_exp_f32 v115, v115
    v_mfma_f32_16x16x32_bf16 v[24:27], v[32:35], v[192:195], v[24:27]
    v_exp_f32 v116, v116
    v_mfma_f32_16x16x32_bf16 v[24:27], v[36:39], v[196:199], v[24:27]
    v_exp_f32 v117, v117
    v_mfma_f32_16x16x32_bf16 v[28:31], v[32:35], v[224:227], v[28:31]
    ds_read_b128 v[56:59], v1 offset:34688
    v_add_f32 v12, v12, v113
    v_mfma_f32_16x16x32_bf16 v[28:31], v[36:39], v[228:231], v[28:31]
    s_waitcnt lgkmcnt(3)
    v_exp_f32 v118, v118
    v_mfma_f32_16x16x32_bf16 v[16:19], v[40:43], v[136:139], v[16:19]
    v_cvt_pk_bf16_f32 v112, v112, v113
    v_add_f32 v12, v12, v114
    v_mfma_f32_16x16x32_bf16 v[16:19], v[44:47], v[140:143], v[16:19]
    v_exp_f32 v119, v119
    v_mfma_f32_16x16x32_bf16 v[20:23], v[40:43], v[168:171], v[20:23]
    ds_read_b128 v[60:63], v1 offset:34752
    v_add_f32 v12, v12, v115
    v_mfma_f32_16x16x32_bf16 v[20:23], v[44:47], v[172:175], v[20:23]
    v_exp_f32 v120, v120
    v_mfma_f32_16x16x32_bf16 v[24:27], v[40:43], v[200:203], v[24:27]
    ds_read_b64_tr_b16 v[32:33], v3 offset:33920
    v_cvt_pk_bf16_f32 v113, v114, v115
    v_mfma_f32_16x16x32_bf16 v[24:27], v[44:47], v[204:207], v[24:27]
    v_exp_f32 v121, v121
    v_mfma_f32_16x16x32_bf16 v[28:31], v[40:43], v[232:235], v[28:31]
    ds_read_b64_tr_b16 v[34:35], v3 offset:34432
    v_add_f32 v13, v13, v116
    v_mfma_f32_16x16x32_bf16 v[28:31], v[44:47], v[236:239], v[28:31]
    s_waitcnt lgkmcnt(4)
    v_add_f32 v13, v13, v117
    v_cvt_pk_bf16_f32 v116, v116, v117
    v_mfma_f32_16x16x32_bf16 v[16:19], v[48:51], v[144:147], v[16:19]
    ds_read_b64_tr_b16 v[36:37], v3 offset:50816
    v_add_f32 v13, v13, v118
    v_mfma_f32_16x16x32_bf16 v[16:19], v[52:55], v[148:151], v[16:19]
    v_exp_f32 v122, v122
    v_mfma_f32_16x16x32_bf16 v[20:23], v[48:51], v[176:179], v[20:23]
    ds_read_b64_tr_b16 v[38:39], v3 offset:51328
    v_add_f32 v13, v13, v119
    v_mfma_f32_16x16x32_bf16 v[20:23], v[52:55], v[180:183], v[20:23]
    v_exp_f32 v123, v123
    v_mfma_f32_16x16x32_bf16 v[24:27], v[48:51], v[208:211], v[24:27]
    ds_read_b64_tr_b16 v[40:41], v3 offset:33952
    v_cvt_pk_bf16_f32 v117, v118, v119
    v_mfma_f32_16x16x32_bf16 v[24:27], v[52:55], v[212:215], v[24:27]
    v_exp_f32 v124, v124
    v_mfma_f32_16x16x32_bf16 v[28:31], v[48:51], v[240:243], v[28:31]
    ds_read_b64_tr_b16 v[42:43], v3 offset:34464
    v_add_f32 v14, v14, v120
    v_mfma_f32_16x16x32_bf16 v[28:31], v[52:55], v[244:247], v[28:31]
    s_waitcnt lgkmcnt(6)
    v_exp_f32 v125, v125
    v_mfma_f32_16x16x32_bf16 v[16:19], v[56:59], v[152:155], v[16:19]
    ds_read_b64_tr_b16 v[44:45], v3 offset:50848
    v_add_f32 v14, v14, v121
    v_mfma_f32_16x16x32_bf16 v[16:19], v[60:63], v[156:159], v[16:19]
    v_exp_f32 v126, v126
    v_mfma_f32_16x16x32_bf16 v[20:23], v[56:59], v[184:187], v[20:23]
    ds_read_b64_tr_b16 v[46:47], v3 offset:51360
    v_cvt_pk_bf16_f32 v120, v120, v121
    v_mfma_f32_16x16x32_bf16 v[20:23], v[60:63], v[188:191], v[20:23]
    v_add_f32 v14, v14, v122
    v_add_f32 v14, v14, v123
    v_mfma_f32_16x16x32_bf16 v[24:27], v[56:59], v[216:219], v[24:27]
    ds_read_b64_tr_b16 v[48:49], v3 offset:33984
    v_cvt_pk_bf16_f32 v121, v122, v123
    v_mfma_f32_16x16x32_bf16 v[24:27], v[60:63], v[220:223], v[24:27]
    v_exp_f32 v127, v127
    v_mfma_f32_16x16x32_bf16 v[28:31], v[56:59], v[248:251], v[28:31]
    ds_read_b64_tr_b16 v[50:51], v3 offset:34496
    v_add_f32 v15, v15, v124
    v_mfma_f32_16x16x32_bf16 v[28:31], v[60:63], v[252:255], v[28:31]
    s_waitcnt lgkmcnt(6)
    v_exp_f32 v16, v16
    v_mfma_f32_16x16x32_bf16 a[64:67], v[32:35], v[64:67], a[64:67]
    ds_read_b64_tr_b16 v[52:53], v3 offset:50880
    v_add_f32 v15, v15, v125
    v_mfma_f32_16x16x32_bf16 a[64:67], v[36:39], v[80:83], a[64:67]
    ds_read_b128 v[224:227], v9 offset:0
    v_cvt_pk_bf16_f32 v124, v124, v125
    v_mfma_f32_16x16x32_bf16 a[68:71], v[32:35], v[68:71], a[68:71]
    ds_read_b64_tr_b16 v[54:55], v3 offset:51392
    v_add_f32 v15, v15, v126
    v_mfma_f32_16x16x32_bf16 a[68:71], v[36:39], v[84:87], a[68:71]
    v_exp_f32 v17, v17
    v_mfma_f32_16x16x32_bf16 a[72:75], v[32:35], v[72:75], a[72:75]
    ds_read_b64_tr_b16 v[56:57], v3 offset:34016
    v_add_f32 v15, v15, v127
    v_mfma_f32_16x16x32_bf16 a[72:75], v[36:39], v[88:91], a[72:75]
    ds_read_b128 v[228:231], v9 offset:1024
    v_cvt_pk_bf16_f32 v125, v126, v127
    v_mfma_f32_16x16x32_bf16 a[76:79], v[32:35], v[76:79], a[76:79]
    ds_read_b64_tr_b16 v[58:59], v3 offset:34528
    v_add_f32 v12, v12, v16
    v_mfma_f32_16x16x32_bf16 a[76:79], v[36:39], v[92:95], a[76:79]
    s_waitcnt lgkmcnt(8)
    v_exp_f32 v18, v18
    v_mfma_f32_16x16x32_bf16 a[80:83], v[40:43], v[64:67], a[80:83]
    ds_read_b64_tr_b16 v[60:61], v3 offset:50912
    v_cvt_pk_bf16_f32 v114, v16, v17
    v_mfma_f32_16x16x32_bf16 a[80:83], v[44:47], v[80:83], a[80:83]
    s_waitcnt vmcnt(0)
    ds_read_b128 v[232:235], v9 offset:2048
    v_add_f32 v12, v12, v17
    v_mfma_f32_16x16x32_bf16 a[84:87], v[40:43], v[68:71], a[84:87]
    s_barrier
    v_mfma_f32_16x16x32_bf16 a[84:87], v[44:47], v[84:87], a[84:87]
    ds_read_b64_tr_b16 v[62:63], v3 offset:51424
    v_add_f32 v12, v12, v18
    v_mfma_f32_16x16x32_bf16 a[88:91], v[40:43], v[72:75], a[88:91]
    ds_read_b64_tr_b16 v[32:33], v10 offset:0
    v_mfma_f32_16x16x32_bf16 a[88:91], v[44:47], v[88:91], a[88:91]
    ds_read_b128 v[236:239], v9 offset:3072
    v_mfma_f32_16x16x32_bf16 a[92:95], v[40:43], v[76:79], a[92:95]
    ds_read_b64_tr_b16 v[34:35], v10 offset:512
    v_mfma_f32_16x16x32_bf16 a[92:95], v[44:47], v[92:95], a[92:95]
    s_waitcnt lgkmcnt(9)
    v_exp_f32 v19, v19
    v_mfma_f32_16x16x32_bf16 a[96:99], v[48:51], v[64:67], a[96:99]
    ds_read_b64_tr_b16 v[36:37], v10 offset:16896
    v_cvt_pk_bf16_f32 v115, v18, v19
    v_mfma_f32_16x16x32_bf16 a[96:99], v[52:55], v[80:83], a[96:99]
    ds_read_b128 v[240:243], v9 offset:4096
    v_add_f32 v12, v12, v19
    v_mfma_f32_16x16x32_bf16 a[100:103], v[48:51], v[68:71], a[100:103]
    ds_read_b64_tr_b16 v[38:39], v10 offset:17408
    v_exp_f32 v20, v20
    v_mfma_f32_16x16x32_bf16 a[100:103], v[52:55], v[84:87], a[100:103]
    v_exp_f32 v21, v21
    v_add_f32 v13, v13, v20
    v_mfma_f32_16x16x32_bf16 a[104:107], v[48:51], v[72:75], a[104:107]
    ds_read_b64_tr_b16 v[40:41], v10 offset:32
    v_exp_f32 v22, v22
    v_mfma_f32_16x16x32_bf16 a[104:107], v[52:55], v[88:91], a[104:107]
    ds_read_b128 v[244:247], v9 offset:5120
    v_exp_f32 v23, v23
    v_mfma_f32_16x16x32_bf16 a[108:111], v[48:51], v[76:79], a[108:111]
    ds_read_b64_tr_b16 v[42:43], v10 offset:544
    v_exp_f32 v24, v24
    v_mfma_f32_16x16x32_bf16 a[108:111], v[52:55], v[92:95], a[108:111]
    s_waitcnt lgkmcnt(9)
    v_exp_f32 v25, v25
    v_cvt_pk_bf16_f32 v118, v20, v21
    v_mfma_f32_16x16x32_bf16 a[112:115], v[56:59], v[64:67], a[112:115]
    ds_read_b64_tr_b16 v[44:45], v10 offset:16928
    v_add_f32 v13, v13, v21
    v_add_f32 v13, v13, v22
    v_mfma_f32_16x16x32_bf16 a[112:115], v[60:63], v[80:83], a[112:115]
    ds_read_b128 v[248:251], v9 offset:6144
    v_exp_f32 v26, v26
    v_mfma_f32_16x16x32_bf16 a[116:119], v[56:59], v[68:71], a[116:119]
    ds_read_b64_tr_b16 v[46:47], v10 offset:17440
    v_cvt_pk_bf16_f32 v119, v22, v23
    v_add_f32 v13, v13, v23
    v_mfma_f32_16x16x32_bf16 a[116:119], v[60:63], v[84:87], a[116:119]
    v_exp_f32 v27, v27
    v_add_f32 v14, v14, v24
    v_mfma_f32_16x16x32_bf16 a[120:123], v[56:59], v[72:75], a[120:123]
    ds_read_b64_tr_b16 v[48:49], v10 offset:64
    v_exp_f32 v28, v28
    v_mfma_f32_16x16x32_bf16 a[120:123], v[60:63], v[88:91], a[120:123]
    ds_read_b128 v[252:255], v9 offset:7168
    v_exp_f32 v29, v29
    v_mfma_f32_16x16x32_bf16 a[124:127], v[56:59], v[76:79], a[124:127]
    ds_read_b64_tr_b16 v[50:51], v10 offset:576
    v_cvt_pk_bf16_f32 v122, v24, v25
    v_add_f32 v14, v14, v25
    v_mfma_f32_16x16x32_bf16 a[124:127], v[60:63], v[92:95], a[124:127]
    s_waitcnt lgkmcnt(9)
    v_add_f32 v14, v14, v26
    v_exp_f32 v30, v30
    v_mfma_f32_16x16x32_bf16 a[0:3], v[32:35], v[96:99], a[0:3]
    ds_read_b64_tr_b16 v[52:53], v10 offset:16960
    v_cvt_pk_bf16_f32 v123, v26, v27
    v_add_f32 v14, v14, v27
    v_mfma_f32_16x16x32_bf16 a[0:3], v[36:39], v[112:115], a[0:3]
    v_exp_f32 v31, v31
    v_add_f32 v15, v15, v28
    v_mfma_f32_16x16x32_bf16 a[4:7], v[32:35], v[100:103], a[4:7]
    ds_read_b64_tr_b16 v[54:55], v10 offset:17472
    v_cvt_pk_bf16_f32 v126, v28, v29
    v_add_f32 v15, v15, v29
    v_mfma_f32_16x16x32_bf16 a[4:7], v[36:39], v[116:119], a[4:7]
    v_add_f32 v15, v15, v30
    v_cvt_pk_bf16_f32 v127, v30, v31
    v_add_f32 v15, v15, v31
    v_mfma_f32_16x16x32_bf16 a[8:11], v[32:35], v[104:107], a[8:11]
    ds_read_b64_tr_b16 v[56:57], v10 offset:96
    v_mov_b32 v216, v12
    v_mov_b32 v217, v13
    v_mov_b32 v218, v14
    v_mfma_f32_16x16x32_bf16 a[8:11], v[36:39], v[120:123], a[8:11]
    v_mov_b32 v219, v15
    v_permlane16_swap_b32 v12, v216
    v_permlane16_swap_b32 v13, v217
    v_permlane16_swap_b32 v14, v218
    v_mfma_f32_16x16x32_bf16 a[12:15], v[32:35], v[108:111], a[12:15]
    ds_read_b64_tr_b16 v[58:59], v10 offset:608
    v_permlane16_swap_b32 v15, v219
    v_add_f32 v12, v12, v216
    v_add_f32 v13, v13, v217
    v_mfma_f32_16x16x32_bf16 a[12:15], v[36:39], v[124:127], a[12:15]
    s_waitcnt lgkmcnt(7)
    v_add_f32 v14, v14, v218
    v_add_f32 v15, v15, v219
    v_mov_b32 v216, v12
    v_mov_b32 v217, v13
    v_mfma_f32_16x16x32_bf16 a[16:19], v[40:43], v[96:99], a[16:19]
    ds_read_b64_tr_b16 v[60:61], v10 offset:16992
    v_mov_b32 v218, v14
    v_mov_b32 v219, v15
    v_permlane32_swap_b32 v12, v216
    v_mfma_f32_16x16x32_bf16 a[16:19], v[44:47], v[112:115], a[16:19]
    v_permlane32_swap_b32 v13, v217
    v_permlane32_swap_b32 v14, v218
    v_permlane32_swap_b32 v15, v219
    v_add_f32 v12, v12, v216
    v_mfma_f32_16x16x32_bf16 a[20:23], v[40:43], v[100:103], a[20:23]
    ds_read_b64_tr_b16 v[62:63], v10 offset:17504
    v_add_f32 v13, v13, v217
    v_add_f32 v14, v14, v218
    v_add_f32 v15, v15, v219
    v_mfma_f32_16x16x32_bf16 a[20:23], v[44:47], v[116:119], a[20:23]
    v_add_f32 v216, v12, v13
    v_add_f32 v217, v14, v15
    v_add_f32 v216, v216, v217
    v_cmp_nge_f32 vcc, 0x4b800000, v216
    v_mfma_f32_16x16x32_bf16 a[24:27], v[40:43], v[104:107], a[24:27]
    ds_read_b64_tr_b16 v[32:33], v10 offset:128
    v_rcp_f32 v12, v12
    v_mfma_f32_16x16x32_bf16 a[24:27], v[44:47], v[120:123], a[24:27]
    v_rcp_f32 v13, v13
    v_rcp_f32 v14, v14
    v_mfma_f32_16x16x32_bf16 a[28:31], v[40:43], v[108:111], a[28:31]
    ds_read_b64_tr_b16 v[34:35], v10 offset:640
    v_rcp_f32 v15, v15
    v_accvgpr_read_b32 v128, a0
    v_mfma_f32_16x16x32_bf16 a[28:31], v[44:47], v[124:127], a[28:31]
    s_waitcnt lgkmcnt(6)
    v_accvgpr_read_b32 v129, a1
    v_accvgpr_read_b32 v130, a2
    v_accvgpr_read_b32 v131, a3
    v_mul_f32 v128, v128, v12
    v_mfma_f32_16x16x32_bf16 a[32:35], v[48:51], v[96:99], a[32:35]
    s_cmp_lg_u64 vcc, 0
    ds_read_b64_tr_b16 v[36:37], v10 offset:17024
    v_mul_f32 v129, v129, v12
    v_mul_f32 v130, v130, v12
    v_mul_f32 v131, v131, v12
    v_mfma_f32_16x16x32_bf16 a[32:35], v[52:55], v[112:115], a[32:35]
    s_cselect_b32 s21, 1, 0
    v_cvt_pk_bf16_f32 v128, v128, v129
    v_cvt_pk_bf16_f32 v129, v130, v131
    v_accvgpr_read_b32 v132, a16
    v_accvgpr_read_b32 v133, a17
    v_mfma_f32_16x16x32_bf16 a[36:39], v[48:51], v[100:103], a[36:39]
    ds_read_b64_tr_b16 v[38:39], v10 offset:17536
    v_accvgpr_read_b32 v134, a18
    v_accvgpr_read_b32 v135, a19
    v_mul_f32 v132, v132, v12
    v_mfma_f32_16x16x32_bf16 a[36:39], v[52:55], v[116:119], a[36:39]
    ds_write_b64 v6, v[128:129] offset:0
    v_mul_f32 v133, v133, v12
    v_mfma_f32_16x16x32_bf16 a[40:43], v[48:51], v[104:107], a[40:43]
    ds_read_b64_tr_b16 v[40:41], v10 offset:160
    v_mul_f32 v134, v134, v12
    v_mul_f32 v135, v135, v12
    v_cvt_pk_bf16_f32 v132, v132, v133
    v_mfma_f32_16x16x32_bf16 a[40:43], v[52:55], v[120:123], a[40:43]
    v_cvt_pk_bf16_f32 v133, v134, v135
    v_mfma_f32_16x16x32_bf16 a[44:47], v[48:51], v[108:111], a[44:47]
    ds_read_b64_tr_b16 v[42:43], v10 offset:672
    v_mfma_f32_16x16x32_bf16 a[44:47], v[52:55], v[124:127], a[44:47]
    s_waitcnt lgkmcnt(7)
    v_mfma_f32_16x16x32_bf16 a[48:51], v[56:59], v[96:99], a[48:51]
    ds_read_b64_tr_b16 v[44:45], v10 offset:17056
    v_mfma_f32_16x16x32_bf16 a[48:51], v[60:63], v[112:115], a[48:51]
    v_accvgpr_read_b32 v136, a32
    v_accvgpr_read_b32 v137, a33
    v_accvgpr_read_b32 v138, a34
    v_accvgpr_read_b32 v139, a35
    v_mfma_f32_16x16x32_bf16 a[52:55], v[56:59], v[100:103], a[52:55]
    ds_read_b64_tr_b16 v[46:47], v10 offset:17568
    v_mul_f32 v136, v136, v12
    v_mul_f32 v137, v137, v12
    v_mul_f32 v138, v138, v12
    v_mfma_f32_16x16x32_bf16 a[52:55], v[60:63], v[116:119], a[52:55]
    ds_write_b64 v6, v[132:133] offset:32
    v_mul_f32 v139, v139, v12
    v_mfma_f32_16x16x32_bf16 a[56:59], v[56:59], v[104:107], a[56:59]
    ds_read_b64_tr_b16 v[48:49], v10 offset:192
    v_cvt_pk_bf16_f32 v136, v136, v137
    v_cvt_pk_bf16_f32 v137, v138, v139
    v_mfma_f32_16x16x32_bf16 a[56:59], v[60:63], v[120:123], a[56:59]
    v_mfma_f32_16x16x32_bf16 a[60:63], v[56:59], v[108:111], a[60:63]
    ds_read_b64_tr_b16 v[50:51], v10 offset:704
    v_mfma_f32_16x16x32_bf16 a[60:63], v[60:63], v[124:127], a[60:63]
    s_waitcnt lgkmcnt(8)
    v_mfma_f32_16x16x32_bf16 a[64:67], v[32:35], v[96:99], a[64:67]
    ds_read_b64_tr_b16 v[52:53], v10 offset:17088
    v_mfma_f32_16x16x32_bf16 a[64:67], v[36:39], v[112:115], a[64:67]
    v_accvgpr_read_b32 v140, a48
    v_accvgpr_read_b32 v141, a49
    v_accvgpr_read_b32 v142, a50
    v_accvgpr_read_b32 v143, a51
    v_mfma_f32_16x16x32_bf16 a[68:71], v[32:35], v[100:103], a[68:71]
    ds_read_b64_tr_b16 v[54:55], v10 offset:17600
    v_mul_f32 v140, v140, v12
    v_mul_f32 v141, v141, v12
    v_mul_f32 v142, v142, v12
    v_mfma_f32_16x16x32_bf16 a[68:71], v[36:39], v[116:119], a[68:71]
    ds_write_b64 v6, v[136:137] offset:64
    v_mul_f32 v143, v143, v12
    v_mfma_f32_16x16x32_bf16 a[72:75], v[32:35], v[104:107], a[72:75]
    ds_read_b64_tr_b16 v[56:57], v10 offset:224
    v_cvt_pk_bf16_f32 v140, v140, v141
    v_cvt_pk_bf16_f32 v141, v142, v143
    v_accvgpr_read_b32 v144, a4
    v_mfma_f32_16x16x32_bf16 a[72:75], v[36:39], v[120:123], a[72:75]
    v_accvgpr_read_b32 v145, a5
    v_accvgpr_read_b32 v146, a6
    v_accvgpr_read_b32 v147, a7
    v_mul_f32 v144, v144, v13
    v_mfma_f32_16x16x32_bf16 a[76:79], v[32:35], v[108:111], a[76:79]
    ds_read_b64_tr_b16 v[58:59], v10 offset:736
    v_mul_f32 v145, v145, v13
    v_mul_f32 v146, v146, v13
    v_mul_f32 v147, v147, v13
    v_mfma_f32_16x16x32_bf16 a[76:79], v[36:39], v[124:127], a[76:79]
    s_waitcnt lgkmcnt(8)
    ds_write_b64 v6, v[140:141] offset:96
    v_cvt_pk_bf16_f32 v144, v144, v145
    v_mfma_f32_16x16x32_bf16 a[80:83], v[40:43], v[96:99], a[80:83]
    ds_read_b64_tr_b16 v[60:61], v10 offset:17120
    v_cvt_pk_bf16_f32 v145, v146, v147
    v_accvgpr_read_b32 v148, a20
    v_accvgpr_read_b32 v149, a21
    v_mfma_f32_16x16x32_bf16 a[80:83], v[44:47], v[112:115], a[80:83]
    ds_read_b128 v[192:195], v7 offset:0
    v_accvgpr_read_b32 v150, a22
    v_accvgpr_read_b32 v151, a23
    v_mul_f32 v148, v148, v13
    v_mfma_f32_16x16x32_bf16 a[84:87], v[40:43], v[100:103], a[84:87]
    ds_read_b64_tr_b16 v[62:63], v10 offset:17632
    v_mul_f32 v149, v149, v13
    v_mul_f32 v150, v150, v13
    v_mul_f32 v151, v151, v13
    v_mfma_f32_16x16x32_bf16 a[84:87], v[44:47], v[116:119], a[84:87]
    ds_read_b128 v[196:199], v7 offset:1152
    v_cvt_pk_bf16_f32 v148, v148, v149
    v_cvt_pk_bf16_f32 v149, v150, v151
    v_accvgpr_read_b32 v152, a36
    v_mfma_f32_16x16x32_bf16 a[88:91], v[40:43], v[104:107], a[88:91]
    ds_read_b64_tr_b16 v[32:33], v3 offset:128
    v_accvgpr_read_b32 v153, a37
    v_accvgpr_read_b32 v154, a38
    v_accvgpr_read_b32 v155, a39
    v_mfma_f32_16x16x32_bf16 a[88:91], v[44:47], v[120:123], a[88:91]
    ds_write_b64 v6, v[144:145] offset:2304
    v_mul_f32 v152, v152, v13
    v_mfma_f32_16x16x32_bf16 a[92:95], v[40:43], v[108:111], a[92:95]
    s_waitcnt lgkmcnt(8)
    ds_read_b64_tr_b16 v[34:35], v3 offset:640
    v_mul_f32 v153, v153, v13
    v_mul_f32 v154, v154, v13
    v_mul_f32 v155, v155, v13
    v_mfma_f32_16x16x32_bf16 a[92:95], v[44:47], v[124:127], a[92:95]
    s_waitcnt lgkmcnt(11)
    ds_write_b64 v6, v[148:149] offset:2336
    v_cvt_pk_bf16_f32 v152, v152, v153
    v_mfma_f32_16x16x32_bf16 a[96:99], v[48:51], v[96:99], a[96:99]
    s_waitcnt lgkmcnt(6)
    ds_read_b64_tr_b16 v[36:37], v3 offset:17024
    v_cvt_pk_bf16_f32 v153, v154, v155
    v_accvgpr_read_b32 v156, a52
    v_accvgpr_read_b32 v157, a53
    v_mfma_f32_16x16x32_bf16 a[96:99], v[52:55], v[112:115], a[96:99]
    buffer_store_dwordx4 v[192:195], v8, s[16:19], s88 offen offset:0 sc1
    v_mfma_f32_16x16x32_bf16 a[100:103], v[48:51], v[100:103], a[100:103]
    s_waitcnt lgkmcnt(5)
    ds_read_b64_tr_b16 v[38:39], v3 offset:17536
    v_accvgpr_read_b32 v158, a54
    v_accvgpr_read_b32 v159, a55
    v_mul_f32 v156, v156, v13
    v_mfma_f32_16x16x32_bf16 a[100:103], v[52:55], v[116:119], a[100:103]
    buffer_store_dwordx4 v[196:199], v8, s[16:19], s89 offen offset:0 sc1
    v_mfma_f32_16x16x32_bf16 a[104:107], v[48:51], v[104:107], a[104:107]
    ds_read_b64_tr_b16 v[40:41], v3 offset:160
    v_mul_f32 v157, v157, v13
    v_mul_f32 v158, v158, v13
    v_mul_f32 v159, v159, v13
    v_mfma_f32_16x16x32_bf16 a[104:107], v[52:55], v[120:123], a[104:107]
    ds_write_b64 v6, v[152:153] offset:2368
    v_cvt_pk_bf16_f32 v156, v156, v157
    v_mfma_f32_16x16x32_bf16 a[108:111], v[48:51], v[108:111], a[108:111]
    ds_read_b64_tr_b16 v[42:43], v3 offset:672
    v_cvt_pk_bf16_f32 v157, v158, v159
    v_accvgpr_read_b32 v160, a8
    v_accvgpr_read_b32 v161, a9
    v_mfma_f32_16x16x32_bf16 a[108:111], v[52:55], v[124:127], a[108:111]
    s_waitcnt lgkmcnt(9)
    v_accvgpr_read_b32 v162, a10
    v_accvgpr_read_b32 v163, a11
    v_mul_f32 v160, v160, v14
    v_mul_f32 v161, v161, v14
    v_mfma_f32_16x16x32_bf16 a[112:115], v[56:59], v[96:99], a[112:115]
    ds_read_b64_tr_b16 v[44:45], v3 offset:17056
    v_mul_f32 v162, v162, v14
    v_mul_f32 v163, v163, v14
    v_cvt_pk_bf16_f32 v160, v160, v161
    v_mfma_f32_16x16x32_bf16 a[112:115], v[60:63], v[112:115], a[112:115]
    ds_write_b64 v6, v[156:157] offset:2400
    v_cvt_pk_bf16_f32 v161, v162, v163
    v_mfma_f32_16x16x32_bf16 a[116:119], v[56:59], v[100:103], a[116:119]
    ds_read_b64_tr_b16 v[46:47], v3 offset:17568
    v_accvgpr_read_b32 v164, a24
    v_accvgpr_read_b32 v165, a25
    v_accvgpr_read_b32 v166, a26
    v_mfma_f32_16x16x32_bf16 a[116:119], v[60:63], v[116:119], a[116:119]
    ds_read_b128 v[200:203], v7 offset:2304
    v_accvgpr_read_b32 v167, a27
    v_mul_f32 v164, v164, v14
    v_mul_f32 v165, v165, v14
    v_mfma_f32_16x16x32_bf16 a[120:123], v[56:59], v[104:107], a[120:123]
    ds_read_b64_tr_b16 v[48:49], v3 offset:192
    v_mul_f32 v166, v166, v14
    v_mul_f32 v167, v167, v14
    v_cvt_pk_bf16_f32 v164, v164, v165
    v_mfma_f32_16x16x32_bf16 a[120:123], v[60:63], v[120:123], a[120:123]
    ds_read_b128 v[204:207], v7 offset:3456
    v_cvt_pk_bf16_f32 v165, v166, v167
    v_accvgpr_read_b32 v168, a40
    v_accvgpr_read_b32 v169, a41
    v_mfma_f32_16x16x32_bf16 a[124:127], v[56:59], v[108:111], a[124:127]
    s_waitcnt lgkmcnt(8)
    ds_read_b64_tr_b16 v[50:51], v3 offset:704
    v_accvgpr_read_b32 v170, a42
    v_accvgpr_read_b32 v171, a43
    v_mul_f32 v168, v168, v14
    v_mfma_f32_16x16x32_bf16 a[124:127], v[60:63], v[124:127], a[124:127]
    s_waitcnt lgkmcnt(10)
    ds_write_b64 v6, v[160:161] offset:4608
    v_mul_f32 v169, v169, v14
    v_mfma_f32_16x16x32_bf16 a[64:67], v[32:35], v[224:227], a[64:67]
    ds_read_b64_tr_b16 v[52:53], v3 offset:17088
    v_mul_f32 v170, v170, v14
    v_mul_f32 v171, v171, v14
    v_cvt_pk_bf16_f32 v168, v168, v169
    v_mfma_f32_16x16x32_bf16 a[64:67], v[36:39], v[240:243], a[64:67]
    ds_write_b64 v6, v[164:165] offset:4640
    v_cvt_pk_bf16_f32 v169, v170, v171
    v_mfma_f32_16x16x32_bf16 a[68:71], v[32:35], v[228:231], a[68:71]
    s_waitcnt lgkmcnt(6)
    ds_read_b64_tr_b16 v[54:55], v3 offset:17600
    v_accvgpr_read_b32 v172, a56
    v_accvgpr_read_b32 v173, a57
    v_accvgpr_read_b32 v174, a58
    v_mfma_f32_16x16x32_bf16 a[68:71], v[36:39], v[244:247], a[68:71]
    buffer_store_dwordx4 v[200:203], v8, s[16:19], s90 offen offset:0 sc1
    v_mfma_f32_16x16x32_bf16 a[72:75], v[32:35], v[232:235], a[72:75]
    s_waitcnt lgkmcnt(5)
    ds_read_b64_tr_b16 v[56:57], v3 offset:224
    v_accvgpr_read_b32 v175, a59
    v_mul_f32 v172, v172, v14
    v_mul_f32 v173, v173, v14
    v_mfma_f32_16x16x32_bf16 a[72:75], v[36:39], v[248:251], a[72:75]
    buffer_store_dwordx4 v[204:207], v8, s[16:19], s91 offen offset:0 sc1
    v_mfma_f32_16x16x32_bf16 a[76:79], v[32:35], v[236:239], a[76:79]
    ds_read_b64_tr_b16 v[58:59], v3 offset:736
    v_mul_f32 v174, v174, v14
    v_mul_f32 v175, v175, v14
    v_cvt_pk_bf16_f32 v172, v172, v173
    v_mfma_f32_16x16x32_bf16 a[76:79], v[36:39], v[252:255], a[76:79]
    s_waitcnt lgkmcnt(7)
    ds_write_b64 v6, v[168:169] offset:4672
    v_cvt_pk_bf16_f32 v173, v174, v175
    v_mfma_f32_16x16x32_bf16 a[80:83], v[40:43], v[224:227], a[80:83]
    ds_read_b64_tr_b16 v[60:61], v3 offset:17120
    v_accvgpr_read_b32 v176, a12
    v_accvgpr_read_b32 v177, a13
    v_accvgpr_read_b32 v178, a14
    v_mfma_f32_16x16x32_bf16 a[80:83], v[44:47], v[240:243], a[80:83]
    v_accvgpr_read_b32 v179, a15
    v_mul_f32 v176, v176, v15
    v_mul_f32 v177, v177, v15
    v_mul_f32 v178, v178, v15
    v_mfma_f32_16x16x32_bf16 a[84:87], v[40:43], v[228:231], a[84:87]
    ds_read_b64_tr_b16 v[62:63], v3 offset:17632
    v_mul_f32 v179, v179, v15
    v_cvt_pk_bf16_f32 v176, v176, v177
    v_cvt_pk_bf16_f32 v177, v178, v179
    v_mfma_f32_16x16x32_bf16 a[84:87], v[44:47], v[244:247], a[84:87]
    ds_write_b64 v6, v[172:173] offset:4704
    v_accvgpr_read_b32 v180, a28
    v_mfma_f32_16x16x32_bf16 a[88:91], v[40:43], v[232:235], a[88:91]
    ds_read_b64_tr_b16 v[32:33], v3 offset:256
    v_accvgpr_read_b32 v181, a29
    v_accvgpr_read_b32 v182, a30
    v_accvgpr_read_b32 v183, a31
    v_mfma_f32_16x16x32_bf16 a[88:91], v[44:47], v[248:251], a[88:91]
    ds_read_b128 v[208:211], v7 offset:4608
    v_mul_f32 v180, v180, v15
    v_mul_f32 v181, v181, v15
    v_mul_f32 v182, v182, v15
    v_mfma_f32_16x16x32_bf16 a[92:95], v[40:43], v[236:239], a[92:95]
    ds_read_b64_tr_b16 v[34:35], v3 offset:768
    v_mul_f32 v183, v183, v15
    v_cvt_pk_bf16_f32 v180, v180, v181
    v_cvt_pk_bf16_f32 v181, v182, v183
    v_mfma_f32_16x16x32_bf16 a[92:95], v[44:47], v[252:255], a[92:95]
    s_waitcnt lgkmcnt(9)
    ds_read_b128 v[212:215], v7 offset:5760
    v_accvgpr_read_b32 v184, a44
    v_accvgpr_read_b32 v185, a45
    v_accvgpr_read_b32 v186, a46
    v_mfma_f32_16x16x32_bf16 a[96:99], v[48:51], v[224:227], a[96:99]
    ds_read_b64_tr_b16 v[36:37], v3 offset:17152
    v_accvgpr_read_b32 v187, a47
    v_mul_f32 v184, v184, v15
    v_mul_f32 v185, v185, v15
    v_mfma_f32_16x16x32_bf16 a[96:99], v[52:55], v[240:243], a[96:99]
    ds_write_b64 v6, v[176:177] offset:0
    v_mul_f32 v186, v186, v15
    v_mfma_f32_16x16x32_bf16 a[100:103], v[48:51], v[228:231], a[100:103]
    ds_read_b64_tr_b16 v[38:39], v3 offset:17664
    v_mul_f32 v187, v187, v15
    v_cvt_pk_bf16_f32 v184, v184, v185
    v_cvt_pk_bf16_f32 v185, v186, v187
    v_mfma_f32_16x16x32_bf16 a[100:103], v[52:55], v[244:247], a[100:103]
    ds_write_b64 v6, v[180:181] offset:32
    v_accvgpr_read_b32 v188, a60
    v_mfma_f32_16x16x32_bf16 a[104:107], v[48:51], v[232:235], a[104:107]
    s_waitcnt lgkmcnt(6)
    ds_read_b64_tr_b16 v[40:41], v3 offset:34048
    v_accvgpr_read_b32 v189, a61
    v_accvgpr_read_b32 v190, a62
    v_accvgpr_read_b32 v191, a63
    v_mfma_f32_16x16x32_bf16 a[104:107], v[52:55], v[248:251], a[104:107]
    buffer_store_dwordx4 v[208:211], v8, s[16:19], s92 offen offset:0 sc1
    v_mfma_f32_16x16x32_bf16 a[108:111], v[48:51], v[236:239], a[108:111]
    ds_read_b64_tr_b16 v[42:43], v3 offset:34560
    v_mul_f32 v188, v188, v15
    v_mul_f32 v189, v189, v15
    v_mul_f32 v190, v190, v15
    v_mfma_f32_16x16x32_bf16 a[108:111], v[52:55], v[252:255], a[108:111]
    s_waitcnt lgkmcnt(8)
    v_mul_f32 v191, v191, v15
    v_cvt_pk_bf16_f32 v188, v188, v189
    v_cvt_pk_bf16_f32 v189, v190, v191
    v_accvgpr_read_b32 v128, a64
    v_mfma_f32_16x16x32_bf16 a[112:115], v[56:59], v[224:227], a[112:115]
    s_waitcnt lgkmcnt(6)
    ds_read_b64_tr_b16 v[44:45], v3 offset:50944
    v_accvgpr_read_b32 v129, a65
    v_accvgpr_read_b32 v130, a66
    v_accvgpr_read_b32 v131, a67
    v_mfma_f32_16x16x32_bf16 a[112:115], v[60:63], v[240:243], a[112:115]
    buffer_store_dwordx4 v[212:215], v8, s[16:19], s93 offen offset:0 sc1
    v_mfma_f32_16x16x32_bf16 a[116:119], v[56:59], v[228:231], a[116:119]
    ds_read_b64_tr_b16 v[46:47], v3 offset:51456
    v_mul_f32 v128, v128, v12
    v_mul_f32 v129, v129, v12
    v_mul_f32 v130, v130, v12
    v_mfma_f32_16x16x32_bf16 a[116:119], v[60:63], v[244:247], a[116:119]
    ds_write_b64 v6, v[184:185] offset:64
    v_mul_f32 v131, v131, v12
    v_mfma_f32_16x16x32_bf16 a[120:123], v[56:59], v[232:235], a[120:123]
    ds_read_b64_tr_b16 v[48:49], v10 offset:256
    v_cvt_pk_bf16_f32 v128, v128, v129
    v_cvt_pk_bf16_f32 v129, v130, v131
    v_accvgpr_read_b32 v132, a80
    v_mfma_f32_16x16x32_bf16 a[120:123], v[60:63], v[248:251], a[120:123]
    ds_write_b64 v6, v[188:189] offset:96
    v_accvgpr_read_b32 v133, a81
    v_mfma_f32_16x16x32_bf16 a[124:127], v[56:59], v[236:239], a[124:127]
    ds_read_b64_tr_b16 v[50:51], v10 offset:768
    v_accvgpr_read_b32 v134, a82
    v_accvgpr_read_b32 v135, a83
    v_mul_f32 v132, v132, v12
    v_mfma_f32_16x16x32_bf16 a[124:127], v[60:63], v[252:255], a[124:127]
    s_waitcnt lgkmcnt(9)
    ds_read_b128 v[192:195], v7 offset:0
    v_mul_f32 v133, v133, v12
    v_mul_f32 v134, v134, v12
    v_mul_f32 v135, v135, v12
    v_mfma_f32_16x16x32_bf16 a[128:131], v[32:35], v[224:227], a[128:131]
    ds_read_b64_tr_b16 v[52:53], v10 offset:17152
    v_cvt_pk_bf16_f32 v132, v132, v133
    v_cvt_pk_bf16_f32 v133, v134, v135
    v_accvgpr_read_b32 v136, a96
    v_mfma_f32_16x16x32_bf16 a[128:131], v[36:39], v[240:243], a[128:131]
    ds_read_b128 v[196:199], v7 offset:1152
    v_accvgpr_read_b32 v137, a97
    v_accvgpr_read_b32 v138, a98
    v_accvgpr_read_b32 v139, a99
    v_mfma_f32_16x16x32_bf16 a[132:135], v[32:35], v[228:231], a[132:135]
    ds_read_b64_tr_b16 v[54:55], v10 offset:17664
    v_mul_f32 v136, v136, v12
    v_mul_f32 v137, v137, v12
    v_mul_f32 v138, v138, v12
    v_mfma_f32_16x16x32_bf16 a[132:135], v[36:39], v[244:247], a[132:135]
    v_mul_f32 v139, v139, v12
    v_cvt_pk_bf16_f32 v136, v136, v137
    v_cvt_pk_bf16_f32 v137, v138, v139
    v_accvgpr_read_b32 v140, a112
    v_mfma_f32_16x16x32_bf16 a[136:139], v[32:35], v[232:235], a[136:139]
    ds_read_b64_tr_b16 v[56:57], v3 offset:288
    v_accvgpr_read_b32 v141, a113
    v_accvgpr_read_b32 v142, a114
    v_accvgpr_read_b32 v143, a115
    v_mfma_f32_16x16x32_bf16 a[136:139], v[36:39], v[248:251], a[136:139]
    v_mul_f32 v140, v140, v12
    v_mul_f32 v141, v141, v12
    v_mul_f32 v142, v142, v12
    v_mul_f32 v143, v143, v12
    v_mfma_f32_16x16x32_bf16 a[140:143], v[32:35], v[236:239], a[140:143]
    ds_read_b64_tr_b16 v[58:59], v3 offset:800
    v_mfma_f32_16x16x32_bf16 a[140:143], v[36:39], v[252:255], a[140:143]
    s_waitcnt lgkmcnt(10)
    v_mfma_f32_16x16x32_bf16 a[128:131], v[40:43], v[64:67], a[128:131]
    ds_read_b64_tr_b16 v[60:61], v3 offset:17184
    v_mfma_f32_16x16x32_bf16 a[128:131], v[44:47], v[80:83], a[128:131]
    v_mfma_f32_16x16x32_bf16 a[132:135], v[40:43], v[68:71], a[132:135]
    s_waitcnt lgkmcnt(6)
    ds_read_b64_tr_b16 v[62:63], v3 offset:17696
    v_mfma_f32_16x16x32_bf16 a[132:135], v[44:47], v[84:87], a[132:135]
    buffer_store_dwordx4 v[192:195], v8, s[16:19], s94 offen offset:0 sc1
    v_mfma_f32_16x16x32_bf16 a[136:139], v[40:43], v[72:75], a[136:139]
    s_waitcnt lgkmcnt(5)
    ds_read_b64_tr_b16 v[32:33], v3 offset:34080
    v_cvt_pk_bf16_f32 v140, v140, v141
    v_mfma_f32_16x16x32_bf16 a[136:139], v[44:47], v[88:91], a[136:139]
    buffer_store_dwordx4 v[196:199], v8, s[16:19], s95 offen offset:0 sc1
    v_mfma_f32_16x16x32_bf16 a[140:143], v[40:43], v[76:79], a[140:143]
    ds_read_b64_tr_b16 v[34:35], v3 offset:34592
    v_cvt_pk_bf16_f32 v141, v142, v143
    v_accvgpr_read_b32 v144, a68
    v_accvgpr_read_b32 v145, a69
    v_mfma_f32_16x16x32_bf16 a[140:143], v[44:47], v[92:95], a[140:143]
    s_waitcnt lgkmcnt(6)
    ds_write_b64 v6, v[128:129] offset:2304
    v_accvgpr_read_b32 v146, a70
    v_mfma_f32_16x16x32_bf16 a[128:131], v[48:51], v[96:99], a[128:131]
    ds_read_b64_tr_b16 v[36:37], v3 offset:50976
    v_accvgpr_read_b32 v147, a71
    v_mul_f32 v144, v144, v13
    v_mul_f32 v145, v145, v13
    v_mfma_f32_16x16x32_bf16 a[128:131], v[52:55], v[112:115], a[128:131]
    ds_write_b64 v6, v[132:133] offset:2336
    v_mul_f32 v146, v146, v13
    v_mfma_f32_16x16x32_bf16 a[132:135], v[48:51], v[100:103], a[132:135]
    ds_read_b64_tr_b16 v[38:39], v3 offset:51488
    v_mul_f32 v147, v147, v13
    v_cvt_pk_bf16_f32 v144, v144, v145
    v_cvt_pk_bf16_f32 v145, v146, v147
    v_mfma_f32_16x16x32_bf16 a[132:135], v[52:55], v[116:119], a[132:135]
    ds_write_b64 v6, v[136:137] offset:2368
    v_accvgpr_read_b32 v148, a84
    v_mfma_f32_16x16x32_bf16 a[136:139], v[48:51], v[104:107], a[136:139]
    ds_read_b64_tr_b16 v[40:41], v10 offset:288
    v_accvgpr_read_b32 v149, a85
    v_accvgpr_read_b32 v150, a86
    v_accvgpr_read_b32 v151, a87
    v_mfma_f32_16x16x32_bf16 a[136:139], v[52:55], v[120:123], a[136:139]
    ds_write_b64 v6, v[140:141] offset:2400
    v_mul_f32 v148, v148, v13
    v_mfma_f32_16x16x32_bf16 a[140:143], v[48:51], v[108:111], a[140:143]
    ds_read_b64_tr_b16 v[42:43], v10 offset:800
    v_mul_f32 v149, v149, v13
    v_mul_f32 v150, v150, v13
    v_mul_f32 v151, v151, v13
    v_mfma_f32_16x16x32_bf16 a[140:143], v[52:55], v[124:127], a[140:143]
    s_waitcnt lgkmcnt(10)
    ds_read_b128 v[200:203], v7 offset:2304
    v_cvt_pk_bf16_f32 v148, v148, v149
    v_cvt_pk_bf16_f32 v149, v150, v151
    v_accvgpr_read_b32 v152, a100
    v_mfma_f32_16x16x32_bf16 a[144:147], v[56:59], v[224:227], a[144:147]
    ds_read_b64_tr_b16 v[44:45], v10 offset:17184
    v_accvgpr_read_b32 v153, a101
    v_accvgpr_read_b32 v154, a102
    v_accvgpr_read_b32 v155, a103
    v_mfma_f32_16x16x32_bf16 a[144:147], v[60:63], v[240:243], a[144:147]
    ds_read_b128 v[204:207], v7 offset:3456
    v_mul_f32 v152, v152, v13
    v_mul_f32 v153, v153, v13
    v_mul_f32 v154, v154, v13
    v_mfma_f32_16x16x32_bf16 a[148:151], v[56:59], v[228:231], a[148:151]
    ds_read_b64_tr_b16 v[46:47], v10 offset:17696
    v_mul_f32 v155, v155, v13
    v_cvt_pk_bf16_f32 v152, v152, v153
    v_cvt_pk_bf16_f32 v153, v154, v155
    v_mfma_f32_16x16x32_bf16 a[148:151], v[60:63], v[244:247], a[148:151]
    ds_write_b64 v6, v[144:145] offset:4608
    v_accvgpr_read_b32 v156, a116
    v_mfma_f32_16x16x32_bf16 a[152:155], v[56:59], v[232:235], a[152:155]
    s_waitcnt lgkmcnt(8)
    ds_read_b64_tr_b16 v[48:49], v3 offset:320
    v_accvgpr_read_b32 v157, a117
    v_accvgpr_read_b32 v158, a118
    v_accvgpr_read_b32 v159, a119
    v_mfma_f32_16x16x32_bf16 a[152:155], v[60:63], v[248:251], a[152:155]
    ds_write_b64 v6, v[148:149] offset:4640
    v_mul_f32 v156, v156, v13
    v_mfma_f32_16x16x32_bf16 a[156:159], v[56:59], v[236:239], a[156:159]
    ds_read_b64_tr_b16 v[50:51], v3 offset:832
    v_mul_f32 v157, v157, v13
    v_mul_f32 v158, v158, v13
    v_mul_f32 v159, v159, v13
    v_mfma_f32_16x16x32_bf16 a[156:159], v[60:63], v[252:255], a[156:159]
    s_waitcnt lgkmcnt(12)
    v_cvt_pk_bf16_f32 v156, v156, v157
    v_cvt_pk_bf16_f32 v157, v158, v159
    v_accvgpr_read_b32 v160, a72
    v_accvgpr_read_b32 v161, a73
    v_mfma_f32_16x16x32_bf16 a[144:147], v[32:35], v[64:67], a[144:147]
    s_waitcnt lgkmcnt(7)
    ds_read_b64_tr_b16 v[52:53], v3 offset:17216
    v_accvgpr_read_b32 v162, a74
    v_accvgpr_read_b32 v163, a75
    v_mul_f32 v160, v160, v14
    v_mfma_f32_16x16x32_bf16 a[144:147], v[36:39], v[80:83], a[144:147]
    buffer_store_dwordx4 v[200:203], v8, s[16:19], s88 offen offset:128 sc1
    v_mfma_f32_16x16x32_bf16 a[148:151], v[32:35], v[68:71], a[148:151]
    s_waitcnt lgkmcnt(6)
    ds_read_b64_tr_b16 v[54:55], v3 offset:17728
    v_mul_f32 v161, v161, v14
    v_mul_f32 v162, v162, v14
    v_mul_f32 v163, v163, v14
    v_mfma_f32_16x16x32_bf16 a[148:151], v[36:39], v[84:87], a[148:151]
    buffer_store_dwordx4 v[204:207], v8, s[16:19], s89 offen offset:128 sc1
    v_mfma_f32_16x16x32_bf16 a[152:155], v[32:35], v[72:75], a[152:155]
    ds_read_b64_tr_b16 v[56:57], v3 offset:34112
    v_cvt_pk_bf16_f32 v160, v160, v161
    v_cvt_pk_bf16_f32 v161, v162, v163
    v_accvgpr_read_b32 v164, a88
    v_mfma_f32_16x16x32_bf16 a[152:155], v[36:39], v[88:91], a[152:155]
    ds_write_b64 v6, v[152:153] offset:4672
    v_accvgpr_read_b32 v165, a89
    v_mfma_f32_16x16x32_bf16 a[156:159], v[32:35], v[76:79], a[156:159]
    ds_read_b64_tr_b16 v[58:59], v3 offset:34624
    v_accvgpr_read_b32 v166, a90
    v_accvgpr_read_b32 v167, a91
    v_mul_f32 v164, v164, v14
    v_mfma_f32_16x16x32_bf16 a[156:159], v[36:39], v[92:95], a[156:159]
    s_waitcnt lgkmcnt(9)
    ds_write_b64 v6, v[156:157] offset:4704
    v_mul_f32 v165, v165, v14
    v_mfma_f32_16x16x32_bf16 a[144:147], v[40:43], v[96:99], a[144:147]
    ds_read_b64_tr_b16 v[60:61], v3 offset:51008
    v_mul_f32 v166, v166, v14
    v_mul_f32 v167, v167, v14
    v_cvt_pk_bf16_f32 v164, v164, v165
    v_mfma_f32_16x16x32_bf16 a[144:147], v[44:47], v[112:115], a[144:147]
    ds_read_b128 v[208:211], v7 offset:4608
    v_cvt_pk_bf16_f32 v165, v166, v167
    v_accvgpr_read_b32 v168, a104
    v_accvgpr_read_b32 v169, a105
    v_mfma_f32_16x16x32_bf16 a[148:151], v[40:43], v[100:103], a[148:151]
    ds_read_b64_tr_b16 v[62:63], v3 offset:51520
    v_accvgpr_read_b32 v170, a106
    v_accvgpr_read_b32 v171, a107
    v_mul_f32 v168, v168, v14
    v_mfma_f32_16x16x32_bf16 a[148:151], v[44:47], v[116:119], a[148:151]
    ds_read_b128 v[212:215], v7 offset:5760
    v_mul_f32 v169, v169, v14
    v_mul_f32 v170, v170, v14
    v_mul_f32 v171, v171, v14
    v_mfma_f32_16x16x32_bf16 a[152:155], v[40:43], v[104:107], a[152:155]
    ds_read_b64_tr_b16 v[32:33], v10 offset:320
    v_cvt_pk_bf16_f32 v168, v168, v169
    v_cvt_pk_bf16_f32 v169, v170, v171
    v_accvgpr_read_b32 v172, a120
    v_mfma_f32_16x16x32_bf16 a[152:155], v[44:47], v[120:123], a[152:155]
    s_waitcnt lgkmcnt(8)
    ds_write_b64 v6, v[160:161] offset:0
    v_accvgpr_read_b32 v173, a121
    v_mfma_f32_16x16x32_bf16 a[156:159], v[40:43], v[108:111], a[156:159]
    ds_read_b64_tr_b16 v[34:35], v10 offset:832
    v_accvgpr_read_b32 v174, a122
    v_accvgpr_read_b32 v175, a123
    v_mul_f32 v172, v172, v14
    v_mfma_f32_16x16x32_bf16 a[156:159], v[44:47], v[124:127], a[156:159]
    s_waitcnt lgkmcnt(11)
    ds_write_b64 v6, v[164:165] offset:32
    v_mul_f32 v173, v173, v14
    v_mfma_f32_16x16x32_bf16 a[160:163], v[48:51], v[224:227], a[160:163]
    s_waitcnt lgkmcnt(6)
    ds_read_b64_tr_b16 v[36:37], v10 offset:17216
    v_mul_f32 v174, v174, v14
    v_mul_f32 v175, v175, v14
    v_cvt_pk_bf16_f32 v172, v172, v173
    v_mfma_f32_16x16x32_bf16 a[160:163], v[52:55], v[240:243], a[160:163]
    buffer_store_dwordx4 v[208:211], v8, s[16:19], s90 offen offset:128 sc1
    v_mfma_f32_16x16x32_bf16 a[164:167], v[48:51], v[228:231], a[164:167]
    s_waitcnt lgkmcnt(5)
    ds_read_b64_tr_b16 v[38:39], v10 offset:17728
    v_cvt_pk_bf16_f32 v173, v174, v175
    v_accvgpr_read_b32 v176, a76
    v_accvgpr_read_b32 v177, a77
    v_mfma_f32_16x16x32_bf16 a[164:167], v[52:55], v[244:247], a[164:167]
    buffer_store_dwordx4 v[212:215], v8, s[16:19], s91 offen offset:128 sc1
    v_mfma_f32_16x16x32_bf16 a[168:171], v[48:51], v[232:235], a[168:171]
    ds_read_b64_tr_b16 v[40:41], v3 offset:352
    v_accvgpr_read_b32 v178, a78
    v_accvgpr_read_b32 v179, a79
    v_mul_f32 v176, v176, v15
    v_mfma_f32_16x16x32_bf16 a[168:171], v[52:55], v[248:251], a[168:171]
    ds_write_b64 v6, v[168:169] offset:64
    v_mul_f32 v177, v177, v15
    v_mfma_f32_16x16x32_bf16 a[172:175], v[48:51], v[236:239], a[172:175]
    ds_read_b64_tr_b16 v[42:43], v3 offset:864
    v_mul_f32 v178, v178, v15
    v_mul_f32 v179, v179, v15
    v_cvt_pk_bf16_f32 v176, v176, v177
    v_mfma_f32_16x16x32_bf16 a[172:175], v[52:55], v[252:255], a[172:175]
    s_waitcnt lgkmcnt(9)
    ds_write_b64 v6, v[172:173] offset:96
    v_cvt_pk_bf16_f32 v177, v178, v179
    v_mfma_f32_16x16x32_bf16 a[160:163], v[56:59], v[64:67], a[160:163]
    ds_read_b64_tr_b16 v[44:45], v3 offset:17248
    v_accvgpr_read_b32 v180, a92
    v_accvgpr_read_b32 v181, a93
    v_accvgpr_read_b32 v182, a94
    v_mfma_f32_16x16x32_bf16 a[160:163], v[60:63], v[80:83], a[160:163]
    ds_read_b128 v[192:195], v7 offset:0
    v_accvgpr_read_b32 v183, a95
    v_mul_f32 v180, v180, v15
    v_mul_f32 v181, v181, v15
    v_mfma_f32_16x16x32_bf16 a[164:167], v[56:59], v[68:71], a[164:167]
    ds_read_b64_tr_b16 v[46:47], v3 offset:17760
    v_mul_f32 v182, v182, v15
    v_mul_f32 v183, v183, v15
    v_cvt_pk_bf16_f32 v180, v180, v181
    v_mfma_f32_16x16x32_bf16 a[164:167], v[60:63], v[84:87], a[164:167]
    ds_read_b128 v[196:199], v7 offset:1152
    v_cvt_pk_bf16_f32 v181, v182, v183
    v_accvgpr_read_b32 v184, a108
    v_accvgpr_read_b32 v185, a109
    v_mfma_f32_16x16x32_bf16 a[168:171], v[56:59], v[72:75], a[168:171]
    ds_read_b64_tr_b16 v[48:49], v3 offset:34144
    v_accvgpr_read_b32 v186, a110
    v_accvgpr_read_b32 v187, a111
    v_mul_f32 v184, v184, v15
    v_mfma_f32_16x16x32_bf16 a[168:171], v[60:63], v[88:91], a[168:171]
    s_waitcnt lgkmcnt(8)
    ds_write_b64 v6, v[176:177] offset:2304
    v_mul_f32 v185, v185, v15
    v_mfma_f32_16x16x32_bf16 a[172:175], v[56:59], v[76:79], a[172:175]
    ds_read_b64_tr_b16 v[50:51], v3 offset:34656
    v_mul_f32 v186, v186, v15
    v_mul_f32 v187, v187, v15
    v_cvt_pk_bf16_f32 v184, v184, v185
    v_mfma_f32_16x16x32_bf16 a[172:175], v[60:63], v[92:95], a[172:175]
    s_waitcnt lgkmcnt(11)
    ds_write_b64 v6, v[180:181] offset:2336
    v_cvt_pk_bf16_f32 v185, v186, v187
    v_mfma_f32_16x16x32_bf16 a[160:163], v[32:35], v[96:99], a[160:163]
    s_waitcnt lgkmcnt(6)
    ds_read_b64_tr_b16 v[52:53], v3 offset:51040
    v_accvgpr_read_b32 v188, a124
    v_accvgpr_read_b32 v189, a125
    v_accvgpr_read_b32 v190, a126
    v_mfma_f32_16x16x32_bf16 a[160:163], v[36:39], v[112:115], a[160:163]
    buffer_store_dwordx4 v[192:195], v8, s[16:19], s92 offen offset:128 sc1
    v_mfma_f32_16x16x32_bf16 a[164:167], v[32:35], v[100:103], a[164:167]
    s_waitcnt lgkmcnt(5)
    ds_read_b64_tr_b16 v[54:55], v3 offset:51552
    v_accvgpr_read_b32 v191, a127
    v_mul_f32 v188, v188, v15
    v_mul_f32 v189, v189, v15
    v_mfma_f32_16x16x32_bf16 a[164:167], v[36:39], v[116:119], a[164:167]
    buffer_store_dwordx4 v[196:199], v8, s[16:19], s93 offen offset:128 sc1
    v_mfma_f32_16x16x32_bf16 a[168:171], v[32:35], v[104:107], a[168:171]
    ds_read_b64_tr_b16 v[56:57], v10 offset:352
    v_mul_f32 v190, v190, v15
    v_mul_f32 v191, v191, v15
    v_cvt_pk_bf16_f32 v188, v188, v189
    v_mfma_f32_16x16x32_bf16 a[168:171], v[36:39], v[120:123], a[168:171]
    ds_write_b64 v6, v[184:185] offset:2368
    v_cvt_pk_bf16_f32 v189, v190, v191
    v_mfma_f32_16x16x32_bf16 a[172:175], v[32:35], v[108:111], a[172:175]
    ds_read_b64_tr_b16 v[58:59], v10 offset:864
    v_accvgpr_read_b32 v128, a128
    v_accvgpr_read_b32 v129, a129
    v_accvgpr_read_b32 v130, a130
    v_mfma_f32_16x16x32_bf16 a[172:175], v[36:39], v[124:127], a[172:175]
    s_waitcnt lgkmcnt(9)
    ds_write_b64 v6, v[188:189] offset:2400
    v_accvgpr_read_b32 v131, a131
    v_mfma_f32_16x16x32_bf16 a[176:179], v[40:43], v[224:227], a[176:179]
    ds_read_b64_tr_b16 v[60:61], v10 offset:17248
    v_mul_f32 v128, v128, v12
    v_mul_f32 v129, v129, v12
    v_mul_f32 v130, v130, v12
    v_mfma_f32_16x16x32_bf16 a[176:179], v[44:47], v[240:243], a[176:179]
    ds_read_b128 v[200:203], v7 offset:2304
    v_mul_f32 v131, v131, v12
    v_cvt_pk_bf16_f32 v128, v128, v129
    v_cvt_pk_bf16_f32 v129, v130, v131
    v_mfma_f32_16x16x32_bf16 a[180:183], v[40:43], v[228:231], a[180:183]
    ds_read_b64_tr_b16 v[62:63], v10 offset:17760
    v_accvgpr_read_b32 v132, a144
    v_accvgpr_read_b32 v133, a145
    v_accvgpr_read_b32 v134, a146
    v_mfma_f32_16x16x32_bf16 a[180:183], v[44:47], v[244:247], a[180:183]
    ds_read_b128 v[204:207], v7 offset:3456
    v_accvgpr_read_b32 v135, a147
    v_mul_f32 v132, v132, v12
    v_mul_f32 v133, v133, v12
    v_mfma_f32_16x16x32_bf16 a[184:187], v[40:43], v[232:235], a[184:187]
    ds_read_b64_tr_b16 v[32:33], v3 offset:384
    v_mul_f32 v134, v134, v12
    v_mul_f32 v135, v135, v12
    v_cvt_pk_bf16_f32 v132, v132, v133
    v_mfma_f32_16x16x32_bf16 a[184:187], v[44:47], v[248:251], a[184:187]
    v_cvt_pk_bf16_f32 v133, v134, v135
    v_accvgpr_read_b32 v136, a160
    v_accvgpr_read_b32 v137, a161
    v_accvgpr_read_b32 v138, a162
    v_mfma_f32_16x16x32_bf16 a[188:191], v[40:43], v[236:239], a[188:191]
    s_waitcnt lgkmcnt(8)
    ds_read_b64_tr_b16 v[34:35], v3 offset:896
    v_accvgpr_read_b32 v139, a163
    v_mul_f32 v136, v136, v12
    v_mul_f32 v137, v137, v12
    v_mfma_f32_16x16x32_bf16 a[188:191], v[44:47], v[252:255], a[188:191]
    s_waitcnt lgkmcnt(10)
    v_mul_f32 v138, v138, v12
    v_mul_f32 v139, v139, v12
    v_cvt_pk_bf16_f32 v136, v136, v137
    v_cvt_pk_bf16_f32 v137, v138, v139
    v_mfma_f32_16x16x32_bf16 a[176:179], v[48:51], v[64:67], a[176:179]
    ds_read_b64_tr_b16 v[36:37], v3 offset:17280
    v_mfma_f32_16x16x32_bf16 a[176:179], v[52:55], v[80:83], a[176:179]
    v_mfma_f32_16x16x32_bf16 a[180:183], v[48:51], v[68:71], a[180:183]
    ds_read_b64_tr_b16 v[38:39], v3 offset:17792
    v_mfma_f32_16x16x32_bf16 a[180:183], v[52:55], v[84:87], a[180:183]
    v_mfma_f32_16x16x32_bf16 a[184:187], v[48:51], v[72:75], a[184:187]
    s_waitcnt lgkmcnt(6)
    ds_read_b64_tr_b16 v[40:41], v3 offset:34176
    v_mfma_f32_16x16x32_bf16 a[184:187], v[52:55], v[88:91], a[184:187]
    buffer_store_dwordx4 v[200:203], v8, s[16:19], s94 offen offset:128 sc1
    v_mfma_f32_16x16x32_bf16 a[188:191], v[48:51], v[76:79], a[188:191]
    ds_read_b64_tr_b16 v[42:43], v3 offset:34688
    v_mfma_f32_16x16x32_bf16 a[188:191], v[52:55], v[92:95], a[188:191]
    s_waitcnt lgkmcnt(7)
    v_mfma_f32_16x16x32_bf16 a[176:179], v[56:59], v[96:99], a[176:179]
    s_waitcnt lgkmcnt(6)
    ds_read_b64_tr_b16 v[44:45], v3 offset:51072
    v_mfma_f32_16x16x32_bf16 a[176:179], v[60:63], v[112:115], a[176:179]
    buffer_store_dwordx4 v[204:207], v8, s[16:19], s95 offen offset:128 sc1
    v_mfma_f32_16x16x32_bf16 a[180:183], v[56:59], v[100:103], a[180:183]
    ds_read_b64_tr_b16 v[46:47], v3 offset:51584
    v_mfma_f32_16x16x32_bf16 a[180:183], v[60:63], v[116:119], a[180:183]
    ds_write_b64 v6, v[128:129] offset:4608
    v_mfma_f32_16x16x32_bf16 a[184:187], v[56:59], v[104:107], a[184:187]
    ds_read_b64_tr_b16 v[48:49], v10 offset:384
    v_mfma_f32_16x16x32_bf16 a[184:187], v[60:63], v[120:123], a[184:187]
    ds_write_b64 v6, v[132:133] offset:4640
    v_mfma_f32_16x16x32_bf16 a[188:191], v[56:59], v[108:111], a[188:191]
    ds_read_b64_tr_b16 v[50:51], v10 offset:896
    v_mfma_f32_16x16x32_bf16 a[188:191], v[60:63], v[124:127], a[188:191]
    s_waitcnt lgkmcnt(8)
    v_mfma_f32_16x16x32_bf16 a[192:195], v[32:35], v[224:227], a[192:195]
    ds_read_b64_tr_b16 v[52:53], v10 offset:17280
    v_mfma_f32_16x16x32_bf16 a[192:195], v[36:39], v[240:243], a[192:195]
    v_accvgpr_read_b32 v140, a176
    v_accvgpr_read_b32 v141, a177
    v_accvgpr_read_b32 v142, a178
    v_accvgpr_read_b32 v143, a179
    v_mfma_f32_16x16x32_bf16 a[196:199], v[32:35], v[228:231], a[196:199]
    ds_read_b64_tr_b16 v[54:55], v10 offset:17792
    v_mul_f32 v140, v140, v12
    v_mul_f32 v141, v141, v12
    v_mul_f32 v142, v142, v12
    v_mfma_f32_16x16x32_bf16 a[196:199], v[36:39], v[244:247], a[196:199]
    ds_write_b64 v6, v[136:137] offset:4672
    v_mul_f32 v143, v143, v12
    v_mfma_f32_16x16x32_bf16 a[200:203], v[32:35], v[232:235], a[200:203]
    ds_read_b64_tr_b16 v[56:57], v3 offset:416
    v_cvt_pk_bf16_f32 v140, v140, v141
    v_cvt_pk_bf16_f32 v141, v142, v143
    v_accvgpr_read_b32 v144, a132
    v_mfma_f32_16x16x32_bf16 a[200:203], v[36:39], v[248:251], a[200:203]
    v_accvgpr_read_b32 v145, a133
    v_accvgpr_read_b32 v146, a134
    v_accvgpr_read_b32 v147, a135
    v_mul_f32 v144, v144, v13
    v_mfma_f32_16x16x32_bf16 a[204:207], v[32:35], v[236:239], a[204:207]
    ds_read_b64_tr_b16 v[58:59], v3 offset:928
    v_mul_f32 v145, v145, v13
    v_mul_f32 v146, v146, v13
    v_mul_f32 v147, v147, v13
    v_mfma_f32_16x16x32_bf16 a[204:207], v[36:39], v[252:255], a[204:207]
    s_waitcnt lgkmcnt(9)
    ds_write_b64 v6, v[140:141] offset:4704
    v_cvt_pk_bf16_f32 v144, v144, v145
    v_mfma_f32_16x16x32_bf16 a[192:195], v[40:43], v[64:67], a[192:195]
    ds_read_b64_tr_b16 v[60:61], v3 offset:17312
    v_cvt_pk_bf16_f32 v145, v146, v147
    v_accvgpr_read_b32 v148, a148
    v_accvgpr_read_b32 v149, a149
    v_mfma_f32_16x16x32_bf16 a[192:195], v[44:47], v[80:83], a[192:195]
    ds_read_b128 v[208:211], v7 offset:4608
    v_accvgpr_read_b32 v150, a150
    v_accvgpr_read_b32 v151, a151
    v_mul_f32 v148, v148, v13
    v_mfma_f32_16x16x32_bf16 a[196:199], v[40:43], v[68:71], a[196:199]
    ds_read_b64_tr_b16 v[62:63], v3 offset:17824
    v_mul_f32 v149, v149, v13
    v_mul_f32 v150, v150, v13
    v_mul_f32 v151, v151, v13
    v_mfma_f32_16x16x32_bf16 a[196:199], v[44:47], v[84:87], a[196:199]
    ds_read_b128 v[212:215], v7 offset:5760
    v_cvt_pk_bf16_f32 v148, v148, v149
    v_cvt_pk_bf16_f32 v149, v150, v151
    v_accvgpr_read_b32 v152, a164
    v_mfma_f32_16x16x32_bf16 a[200:203], v[40:43], v[72:75], a[200:203]
    ds_read_b64_tr_b16 v[32:33], v3 offset:34208
    v_accvgpr_read_b32 v153, a165
    v_accvgpr_read_b32 v154, a166
    v_accvgpr_read_b32 v155, a167
    v_mfma_f32_16x16x32_bf16 a[200:203], v[44:47], v[88:91], a[200:203]
    s_waitcnt lgkmcnt(8)
    ds_write_b64 v6, v[144:145] offset:0
    v_mul_f32 v152, v152, v13
    v_mfma_f32_16x16x32_bf16 a[204:207], v[40:43], v[76:79], a[204:207]
    ds_read_b64_tr_b16 v[34:35], v3 offset:34720
    v_mul_f32 v153, v153, v13
    v_mul_f32 v154, v154, v13
    v_mul_f32 v155, v155, v13
    v_mfma_f32_16x16x32_bf16 a[204:207], v[44:47], v[92:95], a[204:207]
    s_waitcnt lgkmcnt(11)
    ds_write_b64 v6, v[148:149] offset:32
    v_cvt_pk_bf16_f32 v152, v152, v153
    v_mfma_f32_16x16x32_bf16 a[192:195], v[48:51], v[96:99], a[192:195]
    s_waitcnt lgkmcnt(6)
    ds_read_b64_tr_b16 v[36:37], v3 offset:51104
    v_cvt_pk_bf16_f32 v153, v154, v155
    v_accvgpr_read_b32 v156, a180
    v_accvgpr_read_b32 v157, a181
    v_mfma_f32_16x16x32_bf16 a[192:195], v[52:55], v[112:115], a[192:195]
    buffer_store_dwordx4 v[208:211], v8, s[16:19], s88 offen offset:256 sc1
    v_mfma_f32_16x16x32_bf16 a[196:199], v[48:51], v[100:103], a[196:199]
    s_waitcnt lgkmcnt(5)
    ds_read_b64_tr_b16 v[38:39], v3 offset:51616
    v_accvgpr_read_b32 v158, a182
    v_accvgpr_read_b32 v159, a183
    v_mul_f32 v156, v156, v13
    v_mfma_f32_16x16x32_bf16 a[196:199], v[52:55], v[116:119], a[196:199]
    buffer_store_dwordx4 v[212:215], v8, s[16:19], s89 offen offset:256 sc1
    v_mfma_f32_16x16x32_bf16 a[200:203], v[48:51], v[104:107], a[200:203]
    ds_read_b64_tr_b16 v[40:41], v10 offset:416
    v_mul_f32 v157, v157, v13
    v_mul_f32 v158, v158, v13
    v_mul_f32 v159, v159, v13
    v_mfma_f32_16x16x32_bf16 a[200:203], v[52:55], v[120:123], a[200:203]
    ds_write_b64 v6, v[152:153] offset:64
    v_cvt_pk_bf16_f32 v156, v156, v157
    v_mfma_f32_16x16x32_bf16 a[204:207], v[48:51], v[108:111], a[204:207]
    ds_read_b64_tr_b16 v[42:43], v10 offset:928
    v_cvt_pk_bf16_f32 v157, v158, v159
    v_accvgpr_read_b32 v160, a136
    v_accvgpr_read_b32 v161, a137
    v_mfma_f32_16x16x32_bf16 a[204:207], v[52:55], v[124:127], a[204:207]
    s_waitcnt lgkmcnt(9)
    v_accvgpr_read_b32 v162, a138
    v_accvgpr_read_b32 v163, a139
    v_mul_f32 v160, v160, v14
    v_mul_f32 v161, v161, v14
    v_mfma_f32_16x16x32_bf16 a[208:211], v[56:59], v[224:227], a[208:211]
    ds_read_b64_tr_b16 v[44:45], v10 offset:17312
    v_mul_f32 v162, v162, v14
    v_mul_f32 v163, v163, v14
    v_cvt_pk_bf16_f32 v160, v160, v161
    v_mfma_f32_16x16x32_bf16 a[208:211], v[60:63], v[240:243], a[208:211]
    ds_write_b64 v6, v[156:157] offset:96
    v_cvt_pk_bf16_f32 v161, v162, v163
    v_mfma_f32_16x16x32_bf16 a[212:215], v[56:59], v[228:231], a[212:215]
    ds_read_b64_tr_b16 v[46:47], v10 offset:17824
    v_accvgpr_read_b32 v164, a152
    v_accvgpr_read_b32 v165, a153
    v_accvgpr_read_b32 v166, a154
    v_mfma_f32_16x16x32_bf16 a[212:215], v[60:63], v[244:247], a[212:215]
    ds_read_b128 v[192:195], v7 offset:0
    v_accvgpr_read_b32 v167, a155
    v_mul_f32 v164, v164, v14
    v_mul_f32 v165, v165, v14
    v_mfma_f32_16x16x32_bf16 a[216:219], v[56:59], v[232:235], a[216:219]
    ds_read_b64_tr_b16 v[48:49], v3 offset:448
    v_mul_f32 v166, v166, v14
    v_mul_f32 v167, v167, v14
    v_cvt_pk_bf16_f32 v164, v164, v165
    v_mfma_f32_16x16x32_bf16 a[216:219], v[60:63], v[248:251], a[216:219]
    ds_read_b128 v[196:199], v7 offset:1152
    v_cvt_pk_bf16_f32 v165, v166, v167
    v_accvgpr_read_b32 v168, a168
    v_accvgpr_read_b32 v169, a169
    v_mfma_f32_16x16x32_bf16 a[220:223], v[56:59], v[236:239], a[220:223]
    s_waitcnt lgkmcnt(8)
    ds_read_b64_tr_b16 v[50:51], v3 offset:960
    v_accvgpr_read_b32 v170, a170
    v_accvgpr_read_b32 v171, a171
    v_mul_f32 v168, v168, v14
    v_mfma_f32_16x16x32_bf16 a[220:223], v[60:63], v[252:255], a[220:223]
    s_waitcnt lgkmcnt(10)
    ds_write_b64 v6, v[160:161] offset:2304
    v_mul_f32 v169, v169, v14
    v_mfma_f32_16x16x32_bf16 a[208:211], v[32:35], v[64:67], a[208:211]
    ds_read_b64_tr_b16 v[52:53], v3 offset:17344
    v_mul_f32 v170, v170, v14
    v_mul_f32 v171, v171, v14
    v_cvt_pk_bf16_f32 v168, v168, v169
    v_mfma_f32_16x16x32_bf16 a[208:211], v[36:39], v[80:83], a[208:211]
    ds_write_b64 v6, v[164:165] offset:2336
    v_cvt_pk_bf16_f32 v169, v170, v171
    v_mfma_f32_16x16x32_bf16 a[212:215], v[32:35], v[68:71], a[212:215]
    s_waitcnt lgkmcnt(6)
    ds_read_b64_tr_b16 v[54:55], v3 offset:17856
    v_accvgpr_read_b32 v172, a184
    v_accvgpr_read_b32 v173, a185
    v_accvgpr_read_b32 v174, a186
    v_mfma_f32_16x16x32_bf16 a[212:215], v[36:39], v[84:87], a[212:215]
    buffer_store_dwordx4 v[192:195], v8, s[16:19], s90 offen offset:256 sc1
    v_mfma_f32_16x16x32_bf16 a[216:219], v[32:35], v[72:75], a[216:219]
    s_waitcnt lgkmcnt(5)
    ds_read_b64_tr_b16 v[56:57], v3 offset:34240
    v_accvgpr_read_b32 v175, a187
    v_mul_f32 v172, v172, v14
    v_mul_f32 v173, v173, v14
    v_mfma_f32_16x16x32_bf16 a[216:219], v[36:39], v[88:91], a[216:219]
    buffer_store_dwordx4 v[196:199], v8, s[16:19], s91 offen offset:256 sc1
    v_mfma_f32_16x16x32_bf16 a[220:223], v[32:35], v[76:79], a[220:223]
    ds_read_b64_tr_b16 v[58:59], v3 offset:34752
    v_mul_f32 v174, v174, v14
    v_mul_f32 v175, v175, v14
    v_cvt_pk_bf16_f32 v172, v172, v173
    v_mfma_f32_16x16x32_bf16 a[220:223], v[36:39], v[92:95], a[220:223]
    s_waitcnt lgkmcnt(7)
    ds_write_b64 v6, v[168:169] offset:2368
    v_cvt_pk_bf16_f32 v173, v174, v175
    v_mfma_f32_16x16x32_bf16 a[208:211], v[40:43], v[96:99], a[208:211]
    ds_read_b64_tr_b16 v[60:61], v3 offset:51136
    v_accvgpr_read_b32 v176, a140
    v_accvgpr_read_b32 v177, a141
    v_accvgpr_read_b32 v178, a142
    v_mfma_f32_16x16x32_bf16 a[208:211], v[44:47], v[112:115], a[208:211]
    v_accvgpr_read_b32 v179, a143
    v_mul_f32 v176, v176, v15
    v_mul_f32 v177, v177, v15
    v_mul_f32 v178, v178, v15
    v_mfma_f32_16x16x32_bf16 a[212:215], v[40:43], v[100:103], a[212:215]
    ds_read_b64_tr_b16 v[62:63], v3 offset:51648
    v_mul_f32 v179, v179, v15
    v_cvt_pk_bf16_f32 v176, v176, v177
    v_cvt_pk_bf16_f32 v177, v178, v179
    v_mfma_f32_16x16x32_bf16 a[212:215], v[44:47], v[116:119], a[212:215]
    ds_write_b64 v6, v[172:173] offset:2400
    v_accvgpr_read_b32 v180, a156
    v_mfma_f32_16x16x32_bf16 a[216:219], v[40:43], v[104:107], a[216:219]
    ds_read_b64_tr_b16 v[32:33], v10 offset:448
    v_accvgpr_read_b32 v181, a157
    v_accvgpr_read_b32 v182, a158
    v_accvgpr_read_b32 v183, a159
    v_mfma_f32_16x16x32_bf16 a[216:219], v[44:47], v[120:123], a[216:219]
    ds_read_b128 v[200:203], v7 offset:2304
    v_mul_f32 v180, v180, v15
    v_mul_f32 v181, v181, v15
    v_mul_f32 v182, v182, v15
    v_mfma_f32_16x16x32_bf16 a[220:223], v[40:43], v[108:111], a[220:223]
    ds_read_b64_tr_b16 v[34:35], v10 offset:960
    v_mul_f32 v183, v183, v15
    v_cvt_pk_bf16_f32 v180, v180, v181
    v_cvt_pk_bf16_f32 v181, v182, v183
    v_mfma_f32_16x16x32_bf16 a[220:223], v[44:47], v[124:127], a[220:223]
    s_waitcnt lgkmcnt(9)
    ds_read_b128 v[204:207], v7 offset:3456
    v_accvgpr_read_b32 v184, a172
    v_accvgpr_read_b32 v185, a173
    v_accvgpr_read_b32 v186, a174
    v_mfma_f32_16x16x32_bf16 a[224:227], v[48:51], v[224:227], a[224:227]
    ds_read_b64_tr_b16 v[36:37], v10 offset:17344
    v_accvgpr_read_b32 v187, a175
    v_mul_f32 v184, v184, v15
    v_mul_f32 v185, v185, v15
    v_mfma_f32_16x16x32_bf16 a[224:227], v[52:55], v[240:243], a[224:227]
    ds_write_b64 v6, v[176:177] offset:4608
    v_mul_f32 v186, v186, v15
    v_mfma_f32_16x16x32_bf16 a[228:231], v[48:51], v[228:231], a[228:231]
    ds_read_b64_tr_b16 v[38:39], v10 offset:17856
    v_mul_f32 v187, v187, v15
    v_cvt_pk_bf16_f32 v184, v184, v185
    v_cvt_pk_bf16_f32 v185, v186, v187
    v_mfma_f32_16x16x32_bf16 a[228:231], v[52:55], v[244:247], a[228:231]
    ds_write_b64 v6, v[180:181] offset:4640
    v_accvgpr_read_b32 v188, a188
    v_mfma_f32_16x16x32_bf16 a[232:235], v[48:51], v[232:235], a[232:235]
    s_waitcnt lgkmcnt(6)
    ds_read_b64_tr_b16 v[40:41], v3 offset:480
    v_accvgpr_read_b32 v189, a189
    v_accvgpr_read_b32 v190, a190
    v_accvgpr_read_b32 v191, a191
    v_mfma_f32_16x16x32_bf16 a[232:235], v[52:55], v[248:251], a[232:235]
    buffer_store_dwordx4 v[200:203], v8, s[16:19], s92 offen offset:256 sc1
    v_mfma_f32_16x16x32_bf16 a[236:239], v[48:51], v[236:239], a[236:239]
    ds_read_b64_tr_b16 v[42:43], v3 offset:992
    v_mul_f32 v188, v188, v15
    v_mul_f32 v189, v189, v15
    v_mul_f32 v190, v190, v15
    v_mfma_f32_16x16x32_bf16 a[236:239], v[52:55], v[252:255], a[236:239]
    s_waitcnt lgkmcnt(8)
    v_mul_f32 v191, v191, v15
    v_cvt_pk_bf16_f32 v188, v188, v189
    v_cvt_pk_bf16_f32 v189, v190, v191
    v_accvgpr_read_b32 v128, a192
    v_mfma_f32_16x16x32_bf16 a[224:227], v[56:59], v[64:67], a[224:227]
    s_waitcnt lgkmcnt(6)
    ds_read_b64_tr_b16 v[44:45], v3 offset:17376
    v_accvgpr_read_b32 v129, a193
    v_accvgpr_read_b32 v130, a194
    v_accvgpr_read_b32 v131, a195
    v_mfma_f32_16x16x32_bf16 a[224:227], v[60:63], v[80:83], a[224:227]
    buffer_store_dwordx4 v[204:207], v8, s[16:19], s93 offen offset:256 sc1
    v_mfma_f32_16x16x32_bf16 a[228:231], v[56:59], v[68:71], a[228:231]
    ds_read_b64_tr_b16 v[46:47], v3 offset:17888
    v_mul_f32 v128, v128, v12
    v_mul_f32 v129, v129, v12
    v_mul_f32 v130, v130, v12
    v_mfma_f32_16x16x32_bf16 a[228:231], v[60:63], v[84:87], a[228:231]
    ds_write_b64 v6, v[184:185] offset:4672
    v_mul_f32 v131, v131, v12
    v_mfma_f32_16x16x32_bf16 a[232:235], v[56:59], v[72:75], a[232:235]
    ds_read_b64_tr_b16 v[48:49], v3 offset:34272
    v_cvt_pk_bf16_f32 v128, v128, v129
    v_cvt_pk_bf16_f32 v129, v130, v131
    v_accvgpr_read_b32 v132, a208
    v_mfma_f32_16x16x32_bf16 a[232:235], v[60:63], v[88:91], a[232:235]
    ds_write_b64 v6, v[188:189] offset:4704
    v_accvgpr_read_b32 v133, a209
    v_mfma_f32_16x16x32_bf16 a[236:239], v[56:59], v[76:79], a[236:239]
    ds_read_b64_tr_b16 v[50:51], v3 offset:34784
    v_accvgpr_read_b32 v134, a210
    v_accvgpr_read_b32 v135, a211
    v_mul_f32 v132, v132, v12
    v_mfma_f32_16x16x32_bf16 a[236:239], v[60:63], v[92:95], a[236:239]
    s_waitcnt lgkmcnt(9)
    ds_read_b128 v[208:211], v7 offset:4608
    v_mul_f32 v133, v133, v12
    v_mul_f32 v134, v134, v12
    v_mul_f32 v135, v135, v12
    v_mfma_f32_16x16x32_bf16 a[224:227], v[32:35], v[96:99], a[224:227]
    ds_read_b64_tr_b16 v[52:53], v3 offset:51168
    v_cvt_pk_bf16_f32 v132, v132, v133
    v_cvt_pk_bf16_f32 v133, v134, v135
    v_mfma_f32_16x16x32_bf16 a[224:227], v[36:39], v[112:115], a[224:227]
    ds_read_b128 v[212:215], v7 offset:5760
    v_mfma_f32_16x16x32_bf16 a[228:231], v[32:35], v[100:103], a[228:231]
    ds_read_b64_tr_b16 v[54:55], v3 offset:51680
    v_mfma_f32_16x16x32_bf16 a[228:231], v[36:39], v[116:119], a[228:231]
    v_mfma_f32_16x16x32_bf16 a[232:235], v[32:35], v[104:107], a[232:235]
    ds_read_b64_tr_b16 v[56:57], v10 offset:480
    v_mfma_f32_16x16x32_bf16 a[232:235], v[36:39], v[120:123], a[232:235]
    v_mfma_f32_16x16x32_bf16 a[236:239], v[32:35], v[108:111], a[236:239]
    ds_read_b64_tr_b16 v[58:59], v10 offset:992
    v_mfma_f32_16x16x32_bf16 a[236:239], v[36:39], v[124:127], a[236:239]
    s_waitcnt lgkmcnt(10)
    v_mfma_f32_16x16x32_bf16 a[240:243], v[40:43], v[224:227], a[240:243]
    ds_read_b64_tr_b16 v[60:61], v10 offset:17376
    v_mfma_f32_16x16x32_bf16 a[240:243], v[44:47], v[240:243], a[240:243]
    v_accvgpr_read_b32 v136, a224
    v_accvgpr_read_b32 v137, a225
    v_accvgpr_read_b32 v138, a226
    v_accvgpr_read_b32 v139, a227
    v_mfma_f32_16x16x32_bf16 a[244:247], v[40:43], v[228:231], a[244:247]
    s_waitcnt lgkmcnt(6)
    ds_read_b64_tr_b16 v[62:63], v10 offset:17888
    v_mul_f32 v136, v136, v12
    v_mul_f32 v137, v137, v12
    v_mul_f32 v138, v138, v12
    v_mfma_f32_16x16x32_bf16 a[244:247], v[44:47], v[244:247], a[244:247]
    buffer_store_dwordx4 v[208:211], v8, s[16:19], s94 offen offset:256 sc1
    v_mfma_f32_16x16x32_bf16 a[248:251], v[40:43], v[232:235], a[248:251]
    s_waitcnt lgkmcnt(5)
    v_mul_f32 v139, v139, v12
    v_cvt_pk_bf16_f32 v136, v136, v137
    v_cvt_pk_bf16_f32 v137, v138, v139
    v_mfma_f32_16x16x32_bf16 a[248:251], v[44:47], v[248:251], a[248:251]
    buffer_store_dwordx4 v[212:215], v8, s[16:19], s95 offen offset:256 sc1
    v_mfma_f32_16x16x32_bf16 a[252:255], v[40:43], v[236:239], a[252:255]
    ds_write_b64 v6, v[128:129] offset:0
    v_mfma_f32_16x16x32_bf16 a[252:255], v[44:47], v[252:255], a[252:255]
    s_waitcnt lgkmcnt(5)
    ds_write_b64 v6, v[132:133] offset:32
    v_mfma_f32_16x16x32_bf16 a[240:243], v[48:51], v[64:67], a[240:243]
    v_mfma_f32_16x16x32_bf16 a[240:243], v[52:55], v[80:83], a[240:243]
    v_mfma_f32_16x16x32_bf16 a[244:247], v[48:51], v[68:71], a[244:247]
    v_mfma_f32_16x16x32_bf16 a[244:247], v[52:55], v[84:87], a[244:247]
    v_mfma_f32_16x16x32_bf16 a[248:251], v[48:51], v[72:75], a[248:251]
    v_mfma_f32_16x16x32_bf16 a[248:251], v[52:55], v[88:91], a[248:251]
    v_mfma_f32_16x16x32_bf16 a[252:255], v[48:51], v[76:79], a[252:255]
    v_mfma_f32_16x16x32_bf16 a[252:255], v[52:55], v[92:95], a[252:255]
    s_waitcnt lgkmcnt(2)
    v_mfma_f32_16x16x32_bf16 a[240:243], v[56:59], v[96:99], a[240:243]
    v_mfma_f32_16x16x32_bf16 a[240:243], v[60:63], v[112:115], a[240:243]
    v_mfma_f32_16x16x32_bf16 a[244:247], v[56:59], v[100:103], a[244:247]
    v_mfma_f32_16x16x32_bf16 a[244:247], v[60:63], v[116:119], a[244:247]
    v_mfma_f32_16x16x32_bf16 a[248:251], v[56:59], v[104:107], a[248:251]
    v_mfma_f32_16x16x32_bf16 a[248:251], v[60:63], v[120:123], a[248:251]
    v_mfma_f32_16x16x32_bf16 a[252:255], v[56:59], v[108:111], a[252:255]
    v_mfma_f32_16x16x32_bf16 a[252:255], v[60:63], v[124:127], a[252:255]
    s_nop 7
    v_accvgpr_read_b32 v140, a240
    v_accvgpr_read_b32 v141, a241
    v_accvgpr_read_b32 v142, a242
    v_accvgpr_read_b32 v143, a243
    ds_write_b64 v6, v[136:137] offset:64
    v_mul_f32 v140, v140, v12
    v_mul_f32 v141, v141, v12
    v_mul_f32 v142, v142, v12
    v_mul_f32 v143, v143, v12
    v_cvt_pk_bf16_f32 v140, v140, v141
    v_cvt_pk_bf16_f32 v141, v142, v143
    v_accvgpr_read_b32 v144, a196
    v_accvgpr_read_b32 v145, a197
    v_accvgpr_read_b32 v146, a198
    v_accvgpr_read_b32 v147, a199
    ds_write_b64 v6, v[140:141] offset:96
    ds_read_b128 v[192:195], v7 offset:0
    ds_read_b128 v[196:199], v7 offset:1152
    v_mul_f32 v144, v144, v13
    v_mul_f32 v145, v145, v13
    v_mul_f32 v146, v146, v13
    v_mul_f32 v147, v147, v13
    v_cvt_pk_bf16_f32 v144, v144, v145
    v_cvt_pk_bf16_f32 v145, v146, v147
    v_accvgpr_read_b32 v148, a212
    v_accvgpr_read_b32 v149, a213
    v_accvgpr_read_b32 v150, a214
    v_accvgpr_read_b32 v151, a215
    ds_write_b64 v6, v[144:145] offset:2304
    v_mul_f32 v148, v148, v13
    v_mul_f32 v149, v149, v13
    v_mul_f32 v150, v150, v13
    v_mul_f32 v151, v151, v13
    v_cvt_pk_bf16_f32 v148, v148, v149
    v_cvt_pk_bf16_f32 v149, v150, v151
    v_accvgpr_read_b32 v152, a228
    v_accvgpr_read_b32 v153, a229
    v_accvgpr_read_b32 v154, a230
    v_accvgpr_read_b32 v155, a231
    ds_write_b64 v6, v[148:149] offset:2336
    v_mul_f32 v152, v152, v13
    v_mul_f32 v153, v153, v13
    v_mul_f32 v154, v154, v13
    v_mul_f32 v155, v155, v13
    v_cvt_pk_bf16_f32 v152, v152, v153
    v_cvt_pk_bf16_f32 v153, v154, v155
    s_waitcnt lgkmcnt(3)
    buffer_store_dwordx4 v[192:195], v8, s[16:19], s88 offen offset:384 sc1
    s_waitcnt lgkmcnt(2)
    buffer_store_dwordx4 v[196:199], v8, s[16:19], s89 offen offset:384 sc1
    v_accvgpr_read_b32 v156, a244
    v_accvgpr_read_b32 v157, a245
    v_accvgpr_read_b32 v158, a246
    v_accvgpr_read_b32 v159, a247
    ds_write_b64 v6, v[152:153] offset:2368
    v_mul_f32 v156, v156, v13
    v_mul_f32 v157, v157, v13
    v_mul_f32 v158, v158, v13
    v_mul_f32 v159, v159, v13
    v_cvt_pk_bf16_f32 v156, v156, v157
    v_cvt_pk_bf16_f32 v157, v158, v159
    v_accvgpr_read_b32 v160, a200
    v_accvgpr_read_b32 v161, a201
    v_accvgpr_read_b32 v162, a202
    v_accvgpr_read_b32 v163, a203
    ds_write_b64 v6, v[156:157] offset:2400
    ds_read_b128 v[200:203], v7 offset:2304
    ds_read_b128 v[204:207], v7 offset:3456
    v_mul_f32 v160, v160, v14
    v_mul_f32 v161, v161, v14
    v_mul_f32 v162, v162, v14
    v_mul_f32 v163, v163, v14
    v_cvt_pk_bf16_f32 v160, v160, v161
    v_cvt_pk_bf16_f32 v161, v162, v163
    v_accvgpr_read_b32 v164, a216
    v_accvgpr_read_b32 v165, a217
    v_accvgpr_read_b32 v166, a218
    v_accvgpr_read_b32 v167, a219
    ds_write_b64 v6, v[160:161] offset:4608
    v_mul_f32 v164, v164, v14
    v_mul_f32 v165, v165, v14
    v_mul_f32 v166, v166, v14
    v_mul_f32 v167, v167, v14
    v_cvt_pk_bf16_f32 v164, v164, v165
    v_cvt_pk_bf16_f32 v165, v166, v167
    v_accvgpr_read_b32 v168, a232
    v_accvgpr_read_b32 v169, a233
    v_accvgpr_read_b32 v170, a234
    v_accvgpr_read_b32 v171, a235
    ds_write_b64 v6, v[164:165] offset:4640
    v_mul_f32 v168, v168, v14
    v_mul_f32 v169, v169, v14
    v_mul_f32 v170, v170, v14
    v_mul_f32 v171, v171, v14
    v_cvt_pk_bf16_f32 v168, v168, v169
    v_cvt_pk_bf16_f32 v169, v170, v171
    s_waitcnt lgkmcnt(3)
    buffer_store_dwordx4 v[200:203], v8, s[16:19], s90 offen offset:384 sc1
    s_waitcnt lgkmcnt(2)
    buffer_store_dwordx4 v[204:207], v8, s[16:19], s91 offen offset:384 sc1
    v_accvgpr_read_b32 v172, a248
    v_accvgpr_read_b32 v173, a249
    v_accvgpr_read_b32 v174, a250
    v_accvgpr_read_b32 v175, a251
    ds_write_b64 v6, v[168:169] offset:4672
    v_mul_f32 v172, v172, v14
    v_mul_f32 v173, v173, v14
    v_mul_f32 v174, v174, v14
    v_mul_f32 v175, v175, v14
    v_cvt_pk_bf16_f32 v172, v172, v173
    v_cvt_pk_bf16_f32 v173, v174, v175
    v_accvgpr_read_b32 v176, a204
    v_accvgpr_read_b32 v177, a205
    v_accvgpr_read_b32 v178, a206
    v_accvgpr_read_b32 v179, a207
    s_waitcnt lgkmcnt(8)
    ds_write_b64 v6, v[172:173] offset:4704
    ds_read_b128 v[208:211], v7 offset:4608
    ds_read_b128 v[212:215], v7 offset:5760
    v_mul_f32 v176, v176, v15
    v_mul_f32 v177, v177, v15
    v_mul_f32 v178, v178, v15
    v_mul_f32 v179, v179, v15
    v_cvt_pk_bf16_f32 v176, v176, v177
    v_cvt_pk_bf16_f32 v177, v178, v179
    v_accvgpr_read_b32 v180, a220
    v_accvgpr_read_b32 v181, a221
    v_accvgpr_read_b32 v182, a222
    v_accvgpr_read_b32 v183, a223
    ds_write_b64 v6, v[176:177] offset:0
    v_mul_f32 v180, v180, v15
    v_mul_f32 v181, v181, v15
    v_mul_f32 v182, v182, v15
    v_mul_f32 v183, v183, v15
    v_cvt_pk_bf16_f32 v180, v180, v181
    v_cvt_pk_bf16_f32 v181, v182, v183
    v_accvgpr_read_b32 v184, a236
    v_accvgpr_read_b32 v185, a237
    v_accvgpr_read_b32 v186, a238
    v_accvgpr_read_b32 v187, a239
    ds_write_b64 v6, v[180:181] offset:32
    v_mul_f32 v184, v184, v15
    v_mul_f32 v185, v185, v15
    v_mul_f32 v186, v186, v15
    v_mul_f32 v187, v187, v15
    v_cvt_pk_bf16_f32 v184, v184, v185
    v_cvt_pk_bf16_f32 v185, v186, v187
    s_waitcnt lgkmcnt(3)
    buffer_store_dwordx4 v[208:211], v8, s[16:19], s92 offen offset:384 sc1
    s_waitcnt lgkmcnt(2)
    buffer_store_dwordx4 v[212:215], v8, s[16:19], s93 offen offset:384 sc1
    v_accvgpr_read_b32 v188, a252
    v_accvgpr_read_b32 v189, a253
    v_accvgpr_read_b32 v190, a254
    v_accvgpr_read_b32 v191, a255
    ds_write_b64 v6, v[184:185] offset:64
    v_mul_f32 v188, v188, v15
    v_mul_f32 v189, v189, v15
    v_mul_f32 v190, v190, v15
    v_mul_f32 v191, v191, v15
    v_cvt_pk_bf16_f32 v188, v188, v189
    v_cvt_pk_bf16_f32 v189, v190, v191
    ds_write_b64 v6, v[188:189] offset:96
    s_waitcnt lgkmcnt(8)
    ds_read_b128 v[192:195], v7 offset:0
    ds_read_b128 v[196:199], v7 offset:1152
    s_waitcnt lgkmcnt(1)
    buffer_store_dwordx4 v[192:195], v8, s[16:19], s94 offen offset:384 sc1
    s_waitcnt lgkmcnt(0)
    buffer_store_dwordx4 v[196:199], v8, s[16:19], s95 offen offset:384 sc1
    s_lshl_b32 s33, s29, 2
    s_add_u32 s33, s33, 152064
    v_mov_b32 v132, s33
    v_mov_b32 v133, s21
    v_mov_b32 v134, 152064
    ds_write_b32 v132, v133
    s_waitcnt lgkmcnt(0)
    s_barrier
    ds_read_b128 v[128:131], v134
    s_waitcnt lgkmcnt(0)
    v_or3_b32 v132, v128, v129, v130
    v_or_b32 v132, v132, v131
    s_nop 0
    v_readfirstlane_b32 s21, v132
    s_nop 3
    s_cmp_lg_u32 s21, 0
    s_cbranch_scc1 L_redo
L_end:
    s_endpgm
L_redo:
    s_waitcnt vmcnt(0)
    s_barrier
L_safe:
    s_load_dwordx8 s[40:47], s[0:1], 0
    v_lshrrev_b32 v16, 6, v0
    v_and_b32 v17, 63, v0
    v_readfirstlane_b32 s29, v16
    v_lshrrev_b32 v18, 5, v17
    v_and_b32 v19, 31, v17
    v_lshlrev_b32 v19, 4, v19
    s_lshr_b32 s33, s2, 4
    s_lshl_b32 s33, s33, 3
    s_and_b32 s34, s2, 7
    s_add_u32 s33, s33, s34
    s_lshr_b32 s34, s2, 3
    s_and_b32 s34, s34, 1
    s_mul_i32 s35, s33, 253952
    s_lshl_b32 s36, s33, 19
    s_mul_i32 s30, s29, 4224
    s_lshl_b32 s34, s34, 2
    s_add_u32 s34, s34, s29
    s_lshl_b32 s96, s34, 15
    v_lshlrev_b32 v20, 11, v16
    v_lshl_add_u32 v20, v18, 13, v20
    v_add_u32 v5, v20, v19
    v_lshl_add_u32 v6, v18, 12, v19
    v_add_u32 v6, s96, v6
    s_mul_i32 s39, s29, 16896
    s_add_u32 s39, s39, 50688
    s_waitcnt lgkmcnt(0)
    s_add_u32 s8, s42, s36
    s_addc_u32 s9, s43, 0
    s_and_b32 s9, s9, 0xffff
    s_mov_b32 s10, 524288
    s_mov_b32 s11, 0x00020000
    s_add_u32 s4, s40, s35
    s_addc_u32 s5, s41, 0
    s_and_b32 s5, s5, 0xffff
    s_mov_b32 s6, 253952
    s_mov_b32 s7, 0x00020000
    s_add_u32 s24, s30, 0
    s_mov_b32 s22, 0
    s_add_u32 m0, s24, 0
    s_nop 0
    buffer_load_dwordx4 v5, s[8:11], s22 offen offset:0 nt lds
    s_add_u32 m0, s24, 544
    s_nop 0
    buffer_load_dwordx4 v5, s[8:11], s22 offen offset:512 nt lds
    s_add_u32 m0, s24, 1088
    s_nop 0
    buffer_load_dwordx4 v5, s[8:11], s22 offen offset:1024 nt lds
    s_add_u32 m0, s24, 1632
    s_nop 0
    buffer_load_dwordx4 v5, s[8:11], s22 offen offset:1536 nt lds
    s_mov_b32 s38, 0
    s_add_u32 m0, s39, 0
    s_nop 0
    buffer_load_dwordx4 v6, s[4:7], s38 offen offset:0 nt lds
    s_add_u32 m0, s39, 544
    s_nop 0
    buffer_load_dwordx4 v6, s[4:7], s38 offen offset:512 nt lds
    s_add_u32 m0, s39, 1088
    s_nop 0
    buffer_load_dwordx4 v6, s[4:7], s38 offen offset:1024 nt lds
    s_add_u32 m0, s39, 1632
    s_nop 0
    buffer_load_dwordx4 v6, s[4:7], s38 offen offset:1536 nt lds
    s_add_u32 m0, s39, 2176
    s_nop 0
    buffer_load_dwordx4 v6, s[4:7], s38 offen offset:2048 nt lds
    s_add_u32 m0, s39, 2720
    s_nop 0
    buffer_load_dwordx4 v6, s[4:7], s38 offen offset:2560 nt lds
    s_add_u32 m0, s39, 3264
    s_nop 0
    buffer_load_dwordx4 v6, s[4:7], s38 offen offset:3072 nt lds
    s_add_u32 m0, s39, 3808
    s_nop 0
    buffer_load_dwordx4 v6, s[4:7], s38 offen offset:3584 nt lds
    s_mov_b32 s38, 8192
    s_add_u32 m0, s39, 8448
    s_nop 0
    buffer_load_dwordx4 v6, s[4:7], s38 offen offset:0 nt lds
    s_add_u32 m0, s39, 8992
    s_nop 0
    buffer_load_dwordx4 v6, s[4:7], s38 offen offset:512 nt lds
    s_add_u32 m0, s39, 9536
    s_nop 0
    buffer_load_dwordx4 v6, s[4:7], s38 offen offset:1024 nt lds
    s_add_u32 m0, s39, 10080
    s_nop 0
    buffer_load_dwordx4 v6, s[4:7], s38 offen offset:1536 nt lds
    s_add_u32 m0, s39, 10624
    s_nop 0
    buffer_load_dwordx4 v6, s[4:7], s38 offen offset:2048 nt lds
    s_add_u32 m0, s39, 11168
    s_nop 0
    buffer_load_dwordx4 v6, s[4:7], s38 offen offset:2560 nt lds
    s_add_u32 m0, s39, 11712
    s_nop 0
    buffer_load_dwordx4 v6, s[4:7], s38 offen offset:3072 nt lds
    s_add_u32 m0, s39, 12256
    s_nop 0
    buffer_load_dwordx4 v6, s[4:7], s38 offen offset:3584 nt lds
    s_add_u32 s12, s44, s36
    s_addc_u32 s13, s45, 0
    s_and_b32 s13, s13, 0xffff
    s_mov_b32 s14, 524288
    s_mov_b32 s15, 0x00020000
    s_add_u32 s16, s46, s35
    s_addc_u32 s17, s47, 0
    s_and_b32 s17, s17, 0xffff
    s_mov_b32 s18, 253952
    s_mov_b32 s19, 0x00020000
    v_and_b32 v20, 15, v17
    v_lshrrev_b32 v21, 4, v17
    v_mul_u32_u24 v22, 1056, v20
    v_lshl_add_u32 v2, v21, 4, v22
    v_lshrrev_b32 v22, 2, v17
    v_mul_u32_u24 v22, 1056, v22
    v_and_b32 v23, 3, v17
    v_lshl_add_u32 v4, v23, 3, v22
    v_and_b32 v22, 7, v17
    v_mul_u32_u24 v22, 1056, v22
    v_bfe_u32 v23, v17, 3, 1
    v_lshl_add_u32 v22, v23, 9, v22
    v_lshl_add_u32 v22, v21, 4, v22
    v_add_u32 v7, s39, v22
    s_mov_b32 s26, 0
    v_mov_b32 v1, v2
    s_mov_b32 s27, 101376
    s_mov_b32 s20, 0x3db8aa3b
    s_add_u32 s31, s30, 67584
    s_add_u32 s32, s30, 152064
    s_add_u32 s37, s30, 101376
    s_mov_b32 s28, 0
    s_mov_b32 s97, 0x3f803f80
    v_mov_b32 v12, 0
    v_mov_b32 v13, 0
    v_mov_b32 v14, 0
    v_mov_b32 v15, 0
    s_nop 1
    v_mfma_f32_32x32x16_bf16 a[0:15], v[12:15], v[12:15], 0
    v_mfma_f32_32x32x16_bf16 a[16:31], v[12:15], v[12:15], 0
    v_mfma_f32_32x32x16_bf16 a[32:47], v[12:15], v[12:15], 0
    v_mfma_f32_32x32x16_bf16 a[48:63], v[12:15], v[12:15], 0
    v_mfma_f32_32x32x16_bf16 a[64:79], v[12:15], v[12:15], 0
    v_mfma_f32_32x32x16_bf16 a[80:95], v[12:15], v[12:15], 0
    v_mfma_f32_32x32x16_bf16 a[96:111], v[12:15], v[12:15], 0
    v_mfma_f32_32x32x16_bf16 a[112:127], v[12:15], v[12:15], 0
    v_mfma_f32_32x32x16_bf16 a[128:143], v[12:15], v[12:15], 0
    v_mfma_f32_32x32x16_bf16 a[144:159], v[12:15], v[12:15], 0
    v_mfma_f32_32x32x16_bf16 a[160:175], v[12:15], v[12:15], 0
    v_mfma_f32_32x32x16_bf16 a[176:191], v[12:15], v[12:15], 0
    v_mfma_f32_32x32x16_bf16 a[192:207], v[12:15], v[12:15], 0
    v_mfma_f32_32x32x16_bf16 a[208:223], v[12:15], v[12:15], 0
    v_mfma_f32_32x32x16_bf16 a[224:239], v[12:15], v[12:15], 0
    v_mfma_f32_32x32x16_bf16 a[240:255], v[12:15], v[12:15], 0
    s_waitcnt vmcnt(8)
    s_barrier
    ds_read_b128 v[128:131], v7 offset:0
    ds_read_b128 v[132:135], v7 offset:64
    ds_read_b128 v[136:139], v7 offset:128
    ds_read_b128 v[140:143], v7 offset:192
    ds_read_b128 v[144:147], v7 offset:256
    ds_read_b128 v[148:151], v7 offset:320
    ds_read_b128 v[152:155], v7 offset:384
    ds_read_b128 v[156:159], v7 offset:448
    s_waitcnt lgkmcnt(0)
    s_mov_b32 s38, 16384
    s_add_u32 m0, s39, 0
    s_nop 0
    buffer_load_dwordx4 v6, s[4:7], s38 offen offset:0 nt lds
    s_add_u32 m0, s39, 544
    s_nop 0
    buffer_load_dwordx4 v6, s[4:7], s38 offen offset:512 nt lds
    s_add_u32 m0, s39, 1088
    s_nop 0
    buffer_load_dwordx4 v6, s[4:7], s38 offen offset:1024 nt lds
    s_add_u32 m0, s39, 1632
    s_nop 0
    buffer_load_dwordx4 v6, s[4:7], s38 offen offset:1536 nt lds
    s_add_u32 m0, s39, 2176
    s_nop 0
    buffer_load_dwordx4 v6, s[4:7], s38 offen offset:2048 nt lds
    s_add_u32 m0, s39, 2720
    s_nop 0
    buffer_load_dwordx4 v6, s[4:7], s38 offen offset:2560 nt lds
    s_add_u32 m0, s39, 3264
    s_nop 0
    buffer_load_dwordx4 v6, s[4:7], s38 offen offset:3072 nt lds
    s_add_u32 m0, s39, 3808
    s_nop 0
    buffer_load_dwordx4 v6, s[4:7], s38 offen offset:3584 nt lds
    ds_read_b128 v[32:35], v1 offset:0
    ds_read_b128 v[36:39], v1 offset:64
    ds_read_b128 v[40:43], v1 offset:128
    ds_read_b128 v[44:47], v1 offset:192
    ds_read_b128 v[48:51], v1 offset:256
    ds_read_b128 v[52:55], v1 offset:320
    ds_read_b128 v[56:59], v1 offset:384
    ds_read_b128 v[60:63], v1 offset:448
    s_waitcnt lgkmcnt(0)
    ds_read_b128 v[96:99], v1 offset:512
    ds_read_b128 v[100:103], v1 offset:576
    ds_read_b128 v[104:107], v1 offset:640
    ds_read_b128 v[108:111], v1 offset:704
    ds_read_b128 v[112:115], v1 offset:768
    ds_read_b128 v[116:119], v1 offset:832
    ds_read_b128 v[120:123], v1 offset:896
    ds_read_b128 v[124:127], v1 offset:960
    s_waitcnt lgkmcnt(0)
    v_mfma_f32_16x16x32_bf16 v[64:67], v[32:35], v[128:131], 0
    v_mfma_f32_16x16x32_bf16 v[64:67], v[36:39], v[132:135], v[64:67]
    v_mfma_f32_16x16x32_bf16 v[64:67], v[40:43], v[136:139], v[64:67]
    v_mfma_f32_16x16x32_bf16 v[64:67], v[44:47], v[140:143], v[64:67]
    v_mfma_f32_16x16x32_bf16 v[64:67], v[48:51], v[144:147], v[64:67]
    v_mfma_f32_16x16x32_bf16 v[64:67], v[52:55], v[148:151], v[64:67]
    v_mfma_f32_16x16x32_bf16 v[64:67], v[56:59], v[152:155], v[64:67]
    v_mfma_f32_16x16x32_bf16 v[64:67], v[60:63], v[156:159], v[64:67]
    v_mfma_f32_16x16x32_bf16 v[68:71], v[96:99], v[128:131], 0
    v_mfma_f32_16x16x32_bf16 v[68:71], v[100:103], v[132:135], v[68:71]
    v_mfma_f32_16x16x32_bf16 v[68:71], v[104:107], v[136:139], v[68:71]
    v_mfma_f32_16x16x32_bf16 v[68:71], v[108:111], v[140:143], v[68:71]
    v_mfma_f32_16x16x32_bf16 v[68:71], v[112:115], v[144:147], v[68:71]
    v_mfma_f32_16x16x32_bf16 v[68:71], v[116:119], v[148:151], v[68:71]
    v_mfma_f32_16x16x32_bf16 v[68:71], v[120:123], v[152:155], v[68:71]
    v_mfma_f32_16x16x32_bf16 v[68:71], v[124:127], v[156:159], v[68:71]
    s_waitcnt vmcnt(8)
    ds_read_b128 v[160:163], v7 offset:8448
    ds_read_b128 v[164:167], v7 offset:8512
    ds_read_b128 v[168:171], v7 offset:8576
    ds_read_b128 v[172:175], v7 offset:8640
    ds_read_b128 v[176:179], v7 offset:8704
    ds_read_b128 v[180:183], v7 offset:8768
    ds_read_b128 v[184:187], v7 offset:8832
    ds_read_b128 v[188:191], v7 offset:8896
    s_waitcnt lgkmcnt(0)
    s_mov_b32 s38, 24576
    s_add_u32 m0, s39, 8448
    s_nop 0
    buffer_load_dwordx4 v6, s[4:7], s38 offen offset:0 nt lds
    s_add_u32 m0, s39, 8992
    s_nop 0
    buffer_load_dwordx4 v6, s[4:7], s38 offen offset:512 nt lds
    s_add_u32 m0, s39, 9536
    s_nop 0
    buffer_load_dwordx4 v6, s[4:7], s38 offen offset:1024 nt lds
    s_add_u32 m0, s39, 10080
    s_nop 0
    buffer_load_dwordx4 v6, s[4:7], s38 offen offset:1536 nt lds
    s_add_u32 m0, s39, 10624
    s_nop 0
    buffer_load_dwordx4 v6, s[4:7], s38 offen offset:2048 nt lds
    s_add_u32 m0, s39, 11168
    s_nop 0
    buffer_load_dwordx4 v6, s[4:7], s38 offen offset:2560 nt lds
    s_add_u32 m0, s39, 11712
    s_nop 0
    buffer_load_dwordx4 v6, s[4:7], s38 offen offset:3072 nt lds
    s_add_u32 m0, s39, 12256
    s_nop 0
    buffer_load_dwordx4 v6, s[4:7], s38 offen offset:3584 nt lds
    v_mfma_f32_16x16x32_bf16 v[72:75], v[32:35], v[160:163], 0
    v_mfma_f32_16x16x32_bf16 v[72:75], v[36:39], v[164:167], v[72:75]
    v_mfma_f32_16x16x32_bf16 v[72:75], v[40:43], v[168:171], v[72:75]
    v_mfma_f32_16x16x32_bf16 v[72:75], v[44:47], v[172:175], v[72:75]
    v_mfma_f32_16x16x32_bf16 v[72:75], v[48:51], v[176:179], v[72:75]
    v_mfma_f32_16x16x32_bf16 v[72:75], v[52:55], v[180:183], v[72:75]
    v_mfma_f32_16x16x32_bf16 v[72:75], v[56:59], v[184:187], v[72:75]
    v_mfma_f32_16x16x32_bf16 v[72:75], v[60:63], v[188:191], v[72:75]
    v_mfma_f32_16x16x32_bf16 v[76:79], v[96:99], v[160:163], 0
    v_mfma_f32_16x16x32_bf16 v[76:79], v[100:103], v[164:167], v[76:79]
    v_mfma_f32_16x16x32_bf16 v[76:79], v[104:107], v[168:171], v[76:79]
    v_mfma_f32_16x16x32_bf16 v[76:79], v[108:111], v[172:175], v[76:79]
    v_mfma_f32_16x16x32_bf16 v[76:79], v[112:115], v[176:179], v[76:79]
    v_mfma_f32_16x16x32_bf16 v[76:79], v[116:119], v[180:183], v[76:79]
    v_mfma_f32_16x16x32_bf16 v[76:79], v[120:123], v[184:187], v[76:79]
    v_mfma_f32_16x16x32_bf16 v[76:79], v[124:127], v[188:191], v[76:79]
    v_mul_f32 v64, s20, v64
    v_mul_f32 v65, s20, v65
    v_mul_f32 v66, s20, v66
    v_mul_f32 v67, s20, v67
    v_mul_f32 v68, s20, v68
    v_mul_f32 v69, s20, v69
    v_mul_f32 v70, s20, v70
    v_mul_f32 v71, s20, v71
    v_max3_f32 v16, v64, v65, v66
    v_max3_f32 v16, v16, v67, v68
    v_max3_f32 v16, v16, v69, v70
    v_max_f32 v16, v16, v71
    v_mov_b32 v9, v16
    s_nop 1
    v_permlane16_swap_b32 v16, v9
    v_max_f32 v16, v16, v9
    v_mov_b32 v9, v16
    s_nop 1
    v_permlane32_swap_b32 v16, v9
    v_max_f32 v16, v16, v9
    v_sub_f32 v64, v64, v16
    v_sub_f32 v65, v65, v16
    v_sub_f32 v66, v66, v16
    v_sub_f32 v67, v67, v16
    v_sub_f32 v68, v68, v16
    v_sub_f32 v69, v69, v16
    v_sub_f32 v70, v70, v16
    v_sub_f32 v71, v71, v16
    v_exp_f32 v64, v64
    s_nop 0
    v_add_f32 v12, v12, v64
    v_exp_f32 v65, v65
    s_nop 0
    v_add_f32 v12, v12, v65
    v_exp_f32 v66, v66
    s_nop 0
    v_cvt_pk_bf16_f32 v64, v64, v65
    v_exp_f32 v67, v67
    s_nop 0
    v_add_f32 v12, v12, v66
    v_exp_f32 v68, v68
    s_nop 0
    v_add_f32 v12, v12, v67
    v_cvt_pk_bf16_f32 v65, v66, v67
    v_exp_f32 v69, v69
    s_nop 0
    v_add_f32 v12, v12, v68
    v_exp_f32 v70, v70
    s_nop 0
    v_add_f32 v12, v12, v69
    v_exp_f32 v71, v71
    s_nop 0
    v_cvt_pk_bf16_f32 v66, v68, v69
    v_add_f32 v12, v12, v70
    v_add_f32 v12, v12, v71
    v_cvt_pk_bf16_f32 v67, v70, v71
    s_add_u32 s24, s30, 16896
    s_mov_b32 s22, 16384
    s_add_u32 m0, s24, 0
    s_nop 0
    buffer_load_dwordx4 v5, s[8:11], s22 offen offset:0 nt lds
    s_add_u32 m0, s24, 544
    s_nop 0
    buffer_load_dwordx4 v5, s[8:11], s22 offen offset:512 nt lds
    s_add_u32 m0, s24, 1088
    s_nop 0
    buffer_load_dwordx4 v5, s[8:11], s22 offen offset:1024 nt lds
    s_add_u32 m0, s24, 1632
    s_nop 0
    buffer_load_dwordx4 v5, s[8:11], s22 offen offset:1536 nt lds
    s_waitcnt vmcnt(12)
    ds_read_b128 v[192:195], v7 offset:0
    ds_read_b128 v[196:199], v7 offset:64
    ds_read_b128 v[200:203], v7 offset:128
    ds_read_b128 v[204:207], v7 offset:192
    ds_read_b128 v[208:211], v7 offset:256
    ds_read_b128 v[212:215], v7 offset:320
    ds_read_b128 v[216:219], v7 offset:384
    ds_read_b128 v[220:223], v7 offset:448
    s_add_u32 s25, s30, 118272
    s_mov_b32 s23, 0
    s_add_u32 m0, s25, 0
    s_nop 0
    buffer_load_dwordx4 v5, s[12:15], s23 offen offset:0 nt lds
    s_add_u32 m0, s25, 544
    s_nop 0
    buffer_load_dwordx4 v5, s[12:15], s23 offen offset:512 nt lds
    s_add_u32 m0, s25, 1088
    s_nop 0
    buffer_load_dwordx4 v5, s[12:15], s23 offen offset:1024 nt lds
    s_add_u32 m0, s25, 1632
    s_nop 0
    buffer_load_dwordx4 v5, s[12:15], s23 offen offset:1536 nt lds
    s_waitcnt lgkmcnt(0)
    v_mfma_f32_16x16x32_bf16 v[80:83], v[32:35], v[192:195], 0
    v_mfma_f32_16x16x32_bf16 v[80:83], v[36:39], v[196:199], v[80:83]
    v_mfma_f32_16x16x32_bf16 v[80:83], v[40:43], v[200:203], v[80:83]
    v_mfma_f32_16x16x32_bf16 v[80:83], v[44:47], v[204:207], v[80:83]
    v_mfma_f32_16x16x32_bf16 v[80:83], v[48:51], v[208:211], v[80:83]
    v_mfma_f32_16x16x32_bf16 v[80:83], v[52:55], v[212:215], v[80:83]
    v_mfma_f32_16x16x32_bf16 v[80:83], v[56:59], v[216:219], v[80:83]
    v_mfma_f32_16x16x32_bf16 v[80:83], v[60:63], v[220:223], v[80:83]
    v_mfma_f32_16x16x32_bf16 v[84:87], v[96:99], v[192:195], 0
    v_mfma_f32_16x16x32_bf16 v[84:87], v[100:103], v[196:199], v[84:87]
    v_mfma_f32_16x16x32_bf16 v[84:87], v[104:107], v[200:203], v[84:87]
    v_mfma_f32_16x16x32_bf16 v[84:87], v[108:111], v[204:207], v[84:87]
    v_mfma_f32_16x16x32_bf16 v[84:87], v[112:115], v[208:211], v[84:87]
    v_mfma_f32_16x16x32_bf16 v[84:87], v[116:119], v[212:215], v[84:87]
    v_mfma_f32_16x16x32_bf16 v[84:87], v[120:123], v[216:219], v[84:87]
    v_mfma_f32_16x16x32_bf16 v[84:87], v[124:127], v[220:223], v[84:87]
    v_mul_f32 v72, s20, v72
    v_mul_f32 v73, s20, v73
    v_mul_f32 v74, s20, v74
    v_mul_f32 v75, s20, v75
    v_mul_f32 v76, s20, v76
    v_mul_f32 v77, s20, v77
    v_mul_f32 v78, s20, v78
    v_mul_f32 v79, s20, v79
    v_max3_f32 v17, v72, v73, v74
    v_max3_f32 v17, v17, v75, v76
    v_max3_f32 v17, v17, v77, v78
    v_max_f32 v17, v17, v79
    v_mov_b32 v9, v17
    s_nop 1
    v_permlane16_swap_b32 v17, v9
    v_max_f32 v17, v17, v9
    v_mov_b32 v9, v17
    s_nop 1
    v_permlane32_swap_b32 v17, v9
    v_max_f32 v17, v17, v9
    v_sub_f32 v72, v72, v17
    v_sub_f32 v73, v73, v17
    v_sub_f32 v74, v74, v17
    v_sub_f32 v75, v75, v17
    v_sub_f32 v76, v76, v17
    v_sub_f32 v77, v77, v17
    v_sub_f32 v78, v78, v17
    v_sub_f32 v79, v79, v17
    v_exp_f32 v72, v72
    v_exp_f32 v73, v73
    v_exp_f32 v74, v74
    v_exp_f32 v75, v75
    s_nop 0
    v_add_f32 v13, v13, v72
    v_exp_f32 v76, v76
    v_exp_f32 v77, v77
    s_nop 0
    v_add_f32 v13, v13, v73
    v_exp_f32 v78, v78
    s_nop 0
    v_cvt_pk_bf16_f32 v72, v72, v73
    v_add_f32 v13, v13, v74
    v_exp_f32 v79, v79
    s_nop 0
    v_add_f32 v13, v13, v75
    v_cvt_pk_bf16_f32 v73, v74, v75
    v_add_f32 v13, v13, v76
    v_add_f32 v13, v13, v77
    s_add_u32 s24, s30, 33792
    s_mov_b32 s22, 32768
    s_add_u32 m0, s24, 0
    s_nop 0
    buffer_load_dwordx4 v5, s[8:11], s22 offen offset:0 nt lds
    s_add_u32 m0, s24, 544
    s_nop 0
    buffer_load_dwordx4 v5, s[8:11], s22 offen offset:512 nt lds
    s_add_u32 m0, s24, 1088
    s_nop 0
    buffer_load_dwordx4 v5, s[8:11], s22 offen offset:1024 nt lds
    s_add_u32 m0, s24, 1632
    s_nop 0
    buffer_load_dwordx4 v5, s[8:11], s22 offen offset:1536 nt lds
    v_mul_f32 v80, s20, v80
    v_mul_f32 v81, s20, v81
    v_mul_f32 v82, s20, v82
    v_mul_f32 v83, s20, v83
    v_mul_f32 v84, s20, v84
    v_mul_f32 v85, s20, v85
    v_mul_f32 v86, s20, v86
    v_mul_f32 v87, s20, v87
    v_max3_f32 v18, v80, v81, v82
    v_max3_f32 v18, v18, v83, v84
    v_max3_f32 v18, v18, v85, v86
    v_max_f32 v18, v18, v87
    v_mov_b32 v9, v18
    s_nop 1
    v_permlane16_swap_b32 v18, v9
    v_max_f32 v18, v18, v9
    v_mov_b32 v9, v18
    s_nop 1
    v_permlane32_swap_b32 v18, v9
    v_max_f32 v18, v18, v9
    v_sub_f32 v80, v80, v18
    v_sub_f32 v81, v81, v18
    v_sub_f32 v82, v82, v18
    v_sub_f32 v83, v83, v18
    v_sub_f32 v84, v84, v18
    v_sub_f32 v85, v85, v18
    v_sub_f32 v86, v86, v18
    v_sub_f32 v87, v87, v18
    v_exp_f32 v80, v80
    v_exp_f32 v81, v81
    s_nop 0
    s_waitcnt vmcnt(12)
    ds_read_b128 v[224:227], v7 offset:8448
    ds_read_b128 v[228:231], v7 offset:8512
    ds_read_b128 v[232:235], v7 offset:8576
    ds_read_b128 v[236:239], v7 offset:8640
    ds_read_b128 v[240:243], v7 offset:8704
    ds_read_b128 v[244:247], v7 offset:8768
    ds_read_b128 v[248:251], v7 offset:8832
    ds_read_b128 v[252:255], v7 offset:8896
    s_waitcnt lgkmcnt(0)
    v_mfma_f32_16x16x32_bf16 v[88:91], v[32:35], v[224:227], 0
    v_mfma_f32_16x16x32_bf16 v[88:91], v[36:39], v[228:231], v[88:91]
    v_mfma_f32_16x16x32_bf16 v[88:91], v[40:43], v[232:235], v[88:91]
    v_mfma_f32_16x16x32_bf16 v[88:91], v[44:47], v[236:239], v[88:91]
    v_mfma_f32_16x16x32_bf16 v[88:91], v[48:51], v[240:243], v[88:91]
    v_mfma_f32_16x16x32_bf16 v[88:91], v[52:55], v[244:247], v[88:91]
    v_mfma_f32_16x16x32_bf16 v[88:91], v[56:59], v[248:251], v[88:91]
    v_mfma_f32_16x16x32_bf16 v[88:91], v[60:63], v[252:255], v[88:91]
    v_mfma_f32_16x16x32_bf16 v[92:95], v[96:99], v[224:227], 0
    v_mfma_f32_16x16x32_bf16 v[92:95], v[100:103], v[228:231], v[92:95]
    v_mfma_f32_16x16x32_bf16 v[92:95], v[104:107], v[232:235], v[92:95]
    v_mfma_f32_16x16x32_bf16 v[92:95], v[108:111], v[236:239], v[92:95]
    v_mfma_f32_16x16x32_bf16 v[92:95], v[112:115], v[240:243], v[92:95]
    v_mfma_f32_16x16x32_bf16 v[92:95], v[116:119], v[244:247], v[92:95]
    v_mfma_f32_16x16x32_bf16 v[92:95], v[120:123], v[248:251], v[92:95]
    v_mfma_f32_16x16x32_bf16 v[92:95], v[124:127], v[252:255], v[92:95]
    s_waitcnt vmcnt(8)
    s_barrier
    s_add_u32 s26, s26, 16896
    s_cmp_eq_u32 s26, 67584
    s_cmov_b32 s26, 0
    v_add_u32 v1, s26, v2
    ds_read_b128 v[32:35], v1 offset:0
    ds_read_b128 v[36:39], v1 offset:64
    ds_read_b128 v[40:43], v1 offset:128
    ds_read_b128 v[44:47], v1 offset:192
    ds_read_b128 v[48:51], v1 offset:256
    s_add_u32 s24, s30, 50688
    s_mov_b32 s22, 49152
    s_add_u32 m0, s24, 0
    s_nop 0
    buffer_load_dwordx4 v5, s[8:11], s22 offen offset:0 nt lds
    s_add_u32 m0, s24, 544
    s_nop 0
    buffer_load_dwordx4 v5, s[8:11], s22 offen offset:512 nt lds
    s_add_u32 m0, s24, 1088
    s_nop 0
    buffer_load_dwordx4 v5, s[8:11], s22 offen offset:1024 nt lds
    s_add_u32 m0, s24, 1632
    s_nop 0
    buffer_load_dwordx4 v5, s[8:11], s22 offen offset:1536 nt lds
    s_add_u32 s25, s30, 135168
    s_mov_b32 s23, 16384
    s_add_u32 m0, s25, 0
    s_nop 0
    buffer_load_dwordx4 v5, s[12:15], s23 offen offset:0 nt lds
    s_add_u32 m0, s25, 544
    s_nop 0
    buffer_load_dwordx4 v5, s[12:15], s23 offen offset:512 nt lds
    s_add_u32 m0, s25, 1088
    s_nop 0
    buffer_load_dwordx4 v5, s[12:15], s23 offen offset:1024 nt lds
    s_add_u32 m0, s25, 1632
    s_nop 0
    buffer_load_dwordx4 v5, s[12:15], s23 offen offset:1536 nt lds
    v_mul_f32 v88, s20, v88
    v_mul_f32 v89, s20, v89
    v_mul_f32 v90, s20, v90
    v_mul_f32 v91, s20, v91
    v_mul_f32 v92, s20, v92
    v_mul_f32 v93, s20, v93
    v_mul_f32 v94, s20, v94
    v_mul_f32 v95, s20, v95
    v_max3_f32 v19, v88, v89, v90
    v_max3_f32 v19, v19, v91, v92
    v_max3_f32 v19, v19, v93, v94
    v_max_f32 v19, v19, v95
    v_mov_b32 v9, v19
    s_nop 1
    v_permlane16_swap_b32 v19, v9
    v_max_f32 v19, v19, v9
    v_mov_b32 v9, v19
    s_nop 1
    v_permlane32_swap_b32 v19, v9
    v_max_f32 v19, v19, v9
    v_sub_f32 v88, v88, v19
    v_sub_f32 v89, v89, v19
    v_sub_f32 v90, v90, v19
    v_sub_f32 v91, v91, v19
    v_sub_f32 v92, v92, v19
    v_sub_f32 v93, v93, v19
    v_sub_f32 v94, v94, v19
    v_sub_f32 v95, v95, v19
    s_waitcnt lgkmcnt(3)
L_loopS:
    v_mfma_f32_16x16x32_bf16 v[96:99], v[32:35], v[128:131], 0
    s_add_u32 s24, s24, 16896
    v_exp_f32 v82, v82
    v_mfma_f32_16x16x32_bf16 v[96:99], v[36:39], v[132:135], v[96:99]
    s_cmp_eq_u32 s24, s31
    v_cvt_pk_bf16_f32 v74, v76, v77
    v_add_f32 v13, v13, v78
    v_mfma_f32_16x16x32_bf16 v[104:107], v[32:35], v[160:163], 0
    s_cmov_b32 s24, s30
    ds_read_b128 v[52:55], v1 offset:320
    v_add_f32 v13, v13, v79
    v_mfma_f32_16x16x32_bf16 v[104:107], v[36:39], v[164:167], v[104:107]
    s_add_u32 s25, s25, 16896
    v_exp_f32 v83, v83
    v_mfma_f32_16x16x32_bf16 v[112:115], v[32:35], v[192:195], 0
    s_cmp_eq_u32 s25, s32
    v_exp_f32 v84, v84
    v_mfma_f32_16x16x32_bf16 v[112:115], v[36:39], v[196:199], v[112:115]
    s_cmov_b32 s25, s37
    v_cvt_pk_bf16_f32 v75, v78, v79
    v_add_f32 v14, v14, v80
    v_mfma_f32_16x16x32_bf16 v[120:123], v[32:35], v[224:227], 0
    s_add_u32 s22, s22, 16384
    ds_read_b128 v[56:59], v1 offset:384
    v_add_f32 v14, v14, v81
    v_mfma_f32_16x16x32_bf16 v[120:123], v[36:39], v[228:231], v[120:123]
    s_waitcnt lgkmcnt(3)
    v_exp_f32 v85, v85
    v_mfma_f32_16x16x32_bf16 v[96:99], v[40:43], v[136:139], v[96:99]
    s_add_u32 s23, s23, 16384
    v_exp_f32 v86, v86
    v_mfma_f32_16x16x32_bf16 v[96:99], v[44:47], v[140:143], v[96:99]
    s_add_u32 s27, s27, 16896
    v_cvt_pk_bf16_f32 v80, v80, v81
    v_add_f32 v14, v14, v82
    v_mfma_f32_16x16x32_bf16 v[104:107], v[40:43], v[168:171], v[104:107]
    s_cmp_eq_u32 s27, 152064
    ds_read_b128 v[60:63], v1 offset:448
    v_add_f32 v14, v14, v83
    v_mfma_f32_16x16x32_bf16 v[104:107], v[44:47], v[172:175], v[104:107]
    s_cmov_b32 s27, 101376
    v_exp_f32 v87, v87
    v_mfma_f32_16x16x32_bf16 v[112:115], v[40:43], v[200:203], v[112:115]
    v_exp_f32 v88, v88
    v_mfma_f32_16x16x32_bf16 v[112:115], v[44:47], v[204:207], v[112:115]
    v_cvt_pk_bf16_f32 v81, v82, v83
    v_add_f32 v14, v14, v84
    v_mfma_f32_16x16x32_bf16 v[120:123], v[40:43], v[232:235], v[120:123]
    ds_read_b128 v[32:35], v1 offset:512
    v_add_u32 v3, s27, v4
    v_mfma_f32_16x16x32_bf16 v[120:123], v[44:47], v[236:239], v[120:123]
    s_waitcnt lgkmcnt(3)
    v_exp_f32 v89, v89
    v_mfma_f32_16x16x32_bf16 v[96:99], v[48:51], v[144:147], v[96:99]
    s_add_u32 s26, s26, 16896
    v_add_f32 v14, v14, v85
    v_cvt_pk_bf16_f32 v82, v84, v85
    v_mfma_f32_16x16x32_bf16 v[96:99], v[52:55], v[148:151], v[96:99]
    s_cmp_eq_u32 s26, 67584
    v_exp_f32 v90, v90
    v_mfma_f32_16x16x32_bf16 v[104:107], v[48:51], v[176:179], v[104:107]
    s_cmov_b32 s26, 0
    ds_read_b128 v[36:39], v1 offset:576
    v_add_f32 v14, v14, v86
    v_mfma_f32_16x16x32_bf16 v[104:107], v[52:55], v[180:183], v[104:107]
    s_add_u32 s28, s28, 1
    v_exp_f32 v91, v91
    v_mfma_f32_16x16x32_bf16 v[112:115], v[48:51], v[208:211], v[112:115]
    v_add_f32 v14, v14, v87
    v_cvt_pk_bf16_f32 v83, v86, v87
    v_mfma_f32_16x16x32_bf16 v[112:115], v[52:55], v[212:215], v[112:115]
    v_exp_f32 v92, v92
    v_mfma_f32_16x16x32_bf16 v[120:123], v[48:51], v[240:243], v[120:123]
    ds_read_b128 v[40:43], v1 offset:640
    v_add_f32 v15, v15, v88
    v_mfma_f32_16x16x32_bf16 v[120:123], v[52:55], v[244:247], v[120:123]
    s_waitcnt lgkmcnt(3)
    v_exp_f32 v93, v93
    v_mfma_f32_16x16x32_bf16 v[96:99], v[56:59], v[152:155], v[96:99]
    v_add_f32 v15, v15, v89
    v_cvt_pk_bf16_f32 v88, v88, v89
    v_mfma_f32_16x16x32_bf16 v[96:99], v[60:63], v[156:159], v[96:99]
    v_exp_f32 v94, v94
    v_mfma_f32_16x16x32_bf16 v[104:107], v[56:59], v[184:187], v[104:107]
    ds_read_b128 v[44:47], v1 offset:704
    v_add_f32 v15, v15, v90
    v_mfma_f32_16x16x32_bf16 v[104:107], v[60:63], v[188:191], v[104:107]
    v_exp_f32 v95, v95
    v_mfma_f32_16x16x32_bf16 v[112:115], v[56:59], v[216:219], v[112:115]
    v_add_f32 v15, v15, v91
    v_cvt_pk_bf16_f32 v89, v90, v91
    v_mfma_f32_16x16x32_bf16 v[112:115], v[60:63], v[220:223], v[112:115]
    v_add_f32 v15, v15, v92
    v_add_f32 v15, v15, v93
    v_mfma_f32_16x16x32_bf16 v[120:123], v[56:59], v[248:251], v[120:123]
    ds_read_b128 v[48:51], v1 offset:768
    v_cvt_pk_bf16_f32 v90, v92, v93
    v_mfma_f32_16x16x32_bf16 v[120:123], v[60:63], v[252:255], v[120:123]
    s_waitcnt lgkmcnt(3)
    v_add_f32 v15, v15, v94
    v_add_f32 v15, v15, v95
    v_mfma_f32_16x16x32_bf16 v[100:103], v[32:35], v[128:131], 0
    v_fma_f32 v96, v96, s20, -v16
    v_fma_f32 v97, v97, s20, -v16
    v_mfma_f32_16x16x32_bf16 v[100:103], v[36:39], v[132:135], v[100:103]
    v_fma_f32 v98, v98, s20, -v16
    v_max3_f32 v20, v96, v97, v98
    v_mfma_f32_16x16x32_bf16 v[108:111], v[32:35], v[160:163], 0
    ds_read_b128 v[52:55], v1 offset:832
    v_fma_f32 v99, v99, s20, -v16
    v_mfma_f32_16x16x32_bf16 v[108:111], v[36:39], v[164:167], v[108:111]
    v_fma_f32 v104, v104, s20, -v17
    v_max3_f32 v20, v20, v99, v104
    v_mfma_f32_16x16x32_bf16 v[116:119], v[32:35], v[192:195], 0
    v_fma_f32 v105, v105, s20, -v17
    v_fma_f32 v106, v106, s20, -v17
    v_mfma_f32_16x16x32_bf16 v[116:119], v[36:39], v[196:199], v[116:119]
    v_max3_f32 v20, v20, v105, v106
    v_fma_f32 v107, v107, s20, -v17
    v_mfma_f32_16x16x32_bf16 v[124:127], v[32:35], v[224:227], 0
    ds_read_b128 v[56:59], v1 offset:896
    v_fma_f32 v112, v112, s20, -v18
    v_mfma_f32_16x16x32_bf16 v[124:127], v[36:39], v[228:231], v[124:127]
    s_waitcnt lgkmcnt(3)
    v_max3_f32 v20, v20, v107, v112
    v_fma_f32 v113, v113, s20, -v18
    v_mfma_f32_16x16x32_bf16 v[100:103], v[40:43], v[136:139], v[100:103]
    s_waitcnt vmcnt(8)
    v_fma_f32 v114, v114, s20, -v18
    v_max3_f32 v20, v20, v113, v114
    v_mfma_f32_16x16x32_bf16 v[100:103], v[44:47], v[140:143], v[100:103]
    s_barrier
    v_mfma_f32_16x16x32_bf16 v[108:111], v[40:43], v[168:171], v[108:111]
    ds_read_b128 v[60:63], v1 offset:960
    v_fma_f32 v115, v115, s20, -v18
    v_mfma_f32_16x16x32_bf16 v[108:111], v[44:47], v[172:175], v[108:111]
    v_fma_f32 v120, v120, s20, -v19
    v_max3_f32 v20, v20, v115, v120
    v_mfma_f32_16x16x32_bf16 v[116:119], v[40:43], v[200:203], v[116:119]
    s_add_u32 m0, s24, 0
    ds_read_b64_tr_b16 v[32:33], v3 offset:0
    v_add_u32 v1, s26, v2
    v_mfma_f32_16x16x32_bf16 v[116:119], v[44:47], v[204:207], v[116:119]
    buffer_load_dwordx4 v5, s[8:11], s22 offen offset:0 nt lds
    v_mfma_f32_16x16x32_bf16 v[124:127], v[40:43], v[232:235], v[124:127]
    ds_read_b64_tr_b16 v[34:35], v3 offset:512
    v_fma_f32 v121, v121, s20, -v19
    v_mfma_f32_16x16x32_bf16 v[124:127], v[44:47], v[236:239], v[124:127]
    s_waitcnt lgkmcnt(4)
    v_fma_f32 v122, v122, s20, -v19
    v_max3_f32 v20, v20, v121, v122
    v_mfma_f32_16x16x32_bf16 v[100:103], v[48:51], v[144:147], v[100:103]
    ds_read_b64_tr_b16 v[36:37], v3 offset:32
    v_fma_f32 v123, v123, s20, -v19
    v_mfma_f32_16x16x32_bf16 v[100:103], v[52:55], v[148:151], v[100:103]
    v_cvt_pk_bf16_f32 v91, v94, v95
    v_mfma_f32_16x16x32_bf16 v[108:111], v[48:51], v[176:179], v[108:111]
    ds_read_b64_tr_b16 v[38:39], v3 offset:544
    v_mfma_f32_16x16x32_bf16 v[108:111], v[52:55], v[180:183], v[108:111]
    v_mfma_f32_16x16x32_bf16 v[116:119], v[48:51], v[208:211], v[116:119]
    ds_read_b64_tr_b16 v[40:41], v3 offset:64
    v_mfma_f32_16x16x32_bf16 v[116:119], v[52:55], v[212:215], v[116:119]
    v_mfma_f32_16x16x32_bf16 v[124:127], v[48:51], v[240:243], v[124:127]
    ds_read_b64_tr_b16 v[42:43], v3 offset:576
    v_mfma_f32_16x16x32_bf16 v[124:127], v[52:55], v[244:247], v[124:127]
    s_waitcnt lgkmcnt(6)
    v_mfma_f32_16x16x32_bf16 v[100:103], v[56:59], v[152:155], v[100:103]
    s_add_u32 m0, s25, 0
    ds_read_b64_tr_b16 v[44:45], v3 offset:96
    v_mfma_f32_16x16x32_bf16 v[100:103], v[60:63], v[156:159], v[100:103]
    buffer_load_dwordx4 v5, s[12:15], s23 offen offset:0 nt lds
    v_mfma_f32_16x16x32_bf16 v[108:111], v[56:59], v[184:187], v[108:111]
    ds_read_b64_tr_b16 v[46:47], v3 offset:608
    v_mfma_f32_16x16x32_bf16 v[108:111], v[60:63], v[188:191], v[108:111]
    v_mfma_f32_16x16x32_bf16 v[116:119], v[56:59], v[216:219], v[116:119]
    ds_read_b64_tr_b16 v[48:49], v3 offset:128
    v_mfma_f32_16x16x32_bf16 v[116:119], v[60:63], v[220:223], v[116:119]
    v_mfma_f32_16x16x32_bf16 v[124:127], v[56:59], v[248:251], v[124:127]
    ds_read_b64_tr_b16 v[50:51], v3 offset:640
    v_mfma_f32_16x16x32_bf16 v[124:127], v[60:63], v[252:255], v[124:127]
    s_waitcnt lgkmcnt(6)
    v_mfma_f32_16x16x32_bf16 a[0:3], v[32:35], v[64:67], a[0:3]
    ds_read_b64_tr_b16 v[52:53], v3 offset:160
    v_fma_f32 v100, v100, s20, -v16
    v_mfma_f32_16x16x32_bf16 a[16:19], v[36:39], v[64:67], a[16:19]
    v_max3_f32 v20, v20, v123, v100
    v_fma_f32 v101, v101, s20, -v16
    v_mfma_f32_16x16x32_bf16 a[4:7], v[32:35], v[72:75], a[4:7]
    s_add_u32 m0, s24, 544
    ds_read_b64_tr_b16 v[54:55], v3 offset:672
    v_fma_f32 v102, v102, s20, -v16
    v_mfma_f32_16x16x32_bf16 a[20:23], v[36:39], v[72:75], a[20:23]
    buffer_load_dwordx4 v5, s[8:11], s22 offen offset:512 nt lds
    v_mfma_f32_16x16x32_bf16 a[8:11], v[32:35], v[80:83], a[8:11]
    ds_read_b64_tr_b16 v[56:57], v3 offset:192
    v_max3_f32 v20, v20, v101, v102
    v_mfma_f32_16x16x32_bf16 a[24:27], v[36:39], v[80:83], a[24:27]
    v_fma_f32 v103, v103, s20, -v16
    v_fma_f32 v108, v108, s20, -v17
    v_mfma_f32_16x16x32_bf16 a[12:15], v[32:35], v[88:91], a[12:15]
    ds_read_b64_tr_b16 v[58:59], v3 offset:704
    v_max3_f32 v20, v20, v103, v108
    v_mfma_f32_16x16x32_bf16 a[28:31], v[36:39], v[88:91], a[28:31]
    s_waitcnt lgkmcnt(6)
    v_fma_f32 v109, v109, s20, -v17
    v_fma_f32 v110, v110, s20, -v17
    v_mfma_f32_16x16x32_bf16 a[32:35], v[40:43], v[64:67], a[32:35]
    ds_read_b64_tr_b16 v[60:61], v3 offset:224
    v_max3_f32 v20, v20, v109, v110
    v_mfma_f32_16x16x32_bf16 a[48:51], v[44:47], v[64:67], a[48:51]
    v_fma_f32 v111, v111, s20, -v17
    v_fma_f32 v116, v116, s20, -v18
    v_mfma_f32_16x16x32_bf16 a[36:39], v[40:43], v[72:75], a[36:39]
    ds_read_b64_tr_b16 v[62:63], v3 offset:736
    v_max3_f32 v20, v20, v111, v116
    v_mfma_f32_16x16x32_bf16 a[52:55], v[44:47], v[72:75], a[52:55]
    v_fma_f32 v117, v117, s20, -v18
    v_fma_f32 v118, v118, s20, -v18
    v_mfma_f32_16x16x32_bf16 a[40:43], v[40:43], v[80:83], a[40:43]
    s_add_u32 m0, s25, 544
    ds_read_b64_tr_b16 v[32:33], v3 offset:256
    v_max3_f32 v20, v20, v117, v118
    v_mfma_f32_16x16x32_bf16 a[56:59], v[44:47], v[80:83], a[56:59]
    buffer_load_dwordx4 v5, s[12:15], s23 offen offset:512 nt lds
    v_mfma_f32_16x16x32_bf16 a[44:47], v[40:43], v[88:91], a[44:47]
    ds_read_b64_tr_b16 v[34:35], v3 offset:768
    v_fma_f32 v119, v119, s20, -v18
    v_mfma_f32_16x16x32_bf16 a[60:63], v[44:47], v[88:91], a[60:63]
    s_waitcnt lgkmcnt(6)
    v_fma_f32 v124, v124, s20, -v19
    v_max3_f32 v20, v20, v119, v124
    v_mfma_f32_16x16x32_bf16 a[64:67], v[48:51], v[64:67], a[64:67]
    ds_read_b64_tr_b16 v[36:37], v3 offset:288
    v_fma_f32 v125, v125, s20, -v19
    v_mfma_f32_16x16x32_bf16 a[80:83], v[52:55], v[64:67], a[80:83]
    v_fma_f32 v126, v126, s20, -v19
    v_max3_f32 v20, v20, v125, v126
    v_mfma_f32_16x16x32_bf16 a[68:71], v[48:51], v[72:75], a[68:71]
    ds_read_b64_tr_b16 v[38:39], v3 offset:800
    v_fma_f32 v127, v127, s20, -v19
    v_mfma_f32_16x16x32_bf16 a[84:87], v[52:55], v[72:75], a[84:87]
    v_max_f32 v20, v20, v127
    v_cmp_lt_f32 vcc, 0x41000000, v20
    v_mfma_f32_16x16x32_bf16 a[72:75], v[48:51], v[80:83], a[72:75]
    ds_read_b64_tr_b16 v[40:41], v3 offset:320
    v_mfma_f32_16x16x32_bf16 a[88:91], v[52:55], v[80:83], a[88:91]
    s_cbranch_vccnz L_slow0
L_back0:
    v_mfma_f32_16x16x32_bf16 a[76:79], v[48:51], v[88:91], a[76:79]
    ds_read_b64_tr_b16 v[42:43], v3 offset:832
    v_mfma_f32_16x16x32_bf16 a[92:95], v[52:55], v[88:91], a[92:95]
    s_waitcnt lgkmcnt(6)
    v_exp_f32 v96, v96
    v_mfma_f32_16x16x32_bf16 a[96:99], v[56:59], v[64:67], a[96:99]
    s_add_u32 m0, s24, 1088
    ds_read_b64_tr_b16 v[44:45], v3 offset:352
    v_add_f32 v12, v12, v96
    v_mfma_f32_16x16x32_bf16 a[112:115], v[60:63], v[64:67], a[112:115]
    buffer_load_dwordx4 v5, s[8:11], s22 offen offset:1024 nt lds
    v_mfma_f32_16x16x32_bf16 a[100:103], v[56:59], v[72:75], a[100:103]
    ds_read_b64_tr_b16 v[46:47], v3 offset:864
    v_mfma_f32_16x16x32_bf16 a[116:119], v[60:63], v[72:75], a[116:119]
    v_exp_f32 v97, v97
    v_mfma_f32_16x16x32_bf16 a[104:107], v[56:59], v[80:83], a[104:107]
    ds_read_b64_tr_b16 v[48:49], v3 offset:384
    v_add_f32 v12, v12, v97
    v_mfma_f32_16x16x32_bf16 a[120:123], v[60:63], v[80:83], a[120:123]
    v_exp_f32 v98, v98
    v_mfma_f32_16x16x32_bf16 a[108:111], v[56:59], v[88:91], a[108:111]
    ds_read_b64_tr_b16 v[50:51], v3 offset:896
    v_cvt_pk_bf16_f32 v96, v96, v97
    v_mfma_f32_16x16x32_bf16 a[124:127], v[60:63], v[88:91], a[124:127]
    s_waitcnt lgkmcnt(6)
    v_exp_f32 v99, v99
    v_mfma_f32_16x16x32_bf16 a[128:131], v[32:35], v[64:67], a[128:131]
    ds_read_b64_tr_b16 v[52:53], v3 offset:416
    v_add_f32 v12, v12, v98
    v_mfma_f32_16x16x32_bf16 a[144:147], v[36:39], v[64:67], a[144:147]
    v_exp_f32 v100, v100
    v_mfma_f32_16x16x32_bf16 a[132:135], v[32:35], v[72:75], a[132:135]
    s_add_u32 m0, s25, 1088
    ds_read_b64_tr_b16 v[54:55], v3 offset:928
    v_add_f32 v12, v12, v99
    v_mfma_f32_16x16x32_bf16 a[148:151], v[36:39], v[72:75], a[148:151]
    buffer_load_dwordx4 v5, s[12:15], s23 offen offset:1024 nt lds
    v_mfma_f32_16x16x32_bf16 a[136:139], v[32:35], v[80:83], a[136:139]
    ds_read_b64_tr_b16 v[56:57], v3 offset:448
    v_cvt_pk_bf16_f32 v97, v98, v99
    v_mfma_f32_16x16x32_bf16 a[152:155], v[36:39], v[80:83], a[152:155]
    v_exp_f32 v101, v101
    v_mfma_f32_16x16x32_bf16 a[140:143], v[32:35], v[88:91], a[140:143]
    ds_read_b64_tr_b16 v[58:59], v3 offset:960
    v_add_f32 v12, v12, v100
    v_mfma_f32_16x16x32_bf16 a[156:159], v[36:39], v[88:91], a[156:159]
    s_waitcnt lgkmcnt(6)
    v_exp_f32 v102, v102
    v_mfma_f32_16x16x32_bf16 a[160:163], v[40:43], v[64:67], a[160:163]
    ds_read_b64_tr_b16 v[60:61], v3 offset:480
    v_add_f32 v12, v12, v101
    v_mfma_f32_16x16x32_bf16 a[176:179], v[44:47], v[64:67], a[176:179]
    v_exp_f32 v103, v103
    v_mfma_f32_16x16x32_bf16 a[164:167], v[40:43], v[72:75], a[164:167]
    ds_read_b64_tr_b16 v[62:63], v3 offset:992
    v_cvt_pk_bf16_f32 v98, v100, v101
    v_mfma_f32_16x16x32_bf16 a[180:183], v[44:47], v[72:75], a[180:183]
    s_add_u32 m0, s24, 1632
    v_exp_f32 v104, v104
    v_mfma_f32_16x16x32_bf16 a[168:171], v[40:43], v[80:83], a[168:171]
    buffer_load_dwordx4 v5, s[8:11], s22 offen offset:1536 nt lds
    v_mfma_f32_16x16x32_bf16 a[184:187], v[44:47], v[80:83], a[184:187]
    v_exp_f32 v105, v105
    v_mfma_f32_16x16x32_bf16 a[172:175], v[40:43], v[88:91], a[172:175]
    ds_read_b128 v[32:35], v1 offset:0
    v_add_f32 v12, v12, v102
    v_mfma_f32_16x16x32_bf16 a[188:191], v[44:47], v[88:91], a[188:191]
    s_waitcnt lgkmcnt(5)
    v_exp_f32 v106, v106
    v_mfma_f32_16x16x32_bf16 a[192:195], v[48:51], v[64:67], a[192:195]
    v_exp_f32 v107, v107
    v_mfma_f32_16x16x32_bf16 a[208:211], v[52:55], v[64:67], a[208:211]
    v_add_f32 v12, v12, v103
    v_cvt_pk_bf16_f32 v99, v102, v103
    v_mfma_f32_16x16x32_bf16 a[196:199], v[48:51], v[72:75], a[196:199]
    ds_read_b128 v[36:39], v1 offset:64
    v_add_f32 v13, v13, v104
    v_mfma_f32_16x16x32_bf16 a[212:215], v[52:55], v[72:75], a[212:215]
    v_exp_f32 v108, v108
    v_mfma_f32_16x16x32_bf16 a[200:203], v[48:51], v[80:83], a[200:203]
    s_add_u32 m0, s25, 1632
    v_exp_f32 v109, v109
    v_mfma_f32_16x16x32_bf16 a[216:219], v[52:55], v[80:83], a[216:219]
    buffer_load_dwordx4 v5, s[12:15], s23 offen offset:1536 nt lds
    v_mfma_f32_16x16x32_bf16 a[204:207], v[48:51], v[88:91], a[204:207]
    s_cmp_eq_u32 s28, 31
    ds_read_b128 v[40:43], v1 offset:128
    v_add_f32 v13, v13, v105
    v_mfma_f32_16x16x32_bf16 a[220:223], v[52:55], v[88:91], a[220:223]
    s_waitcnt lgkmcnt(3)
    v_exp_f32 v110, v110
    v_mfma_f32_16x16x32_bf16 a[224:227], v[56:59], v[64:67], a[224:227]
    v_cvt_pk_bf16_f32 v104, v104, v105
    v_add_f32 v13, v13, v106
    v_mfma_f32_16x16x32_bf16 a[240:243], v[60:63], v[64:67], a[240:243]
    v_exp_f32 v111, v111
    v_mfma_f32_16x16x32_bf16 a[228:231], v[56:59], v[72:75], a[228:231]
    ds_read_b128 v[44:47], v1 offset:192
    v_add_f32 v13, v13, v107
    v_mfma_f32_16x16x32_bf16 a[244:247], v[60:63], v[72:75], a[244:247]
    v_exp_f32 v112, v112
    v_mfma_f32_16x16x32_bf16 a[232:235], v[56:59], v[80:83], a[232:235]
    v_cvt_pk_bf16_f32 v105, v106, v107
    v_add_f32 v13, v13, v108
    v_mfma_f32_16x16x32_bf16 a[248:251], v[60:63], v[80:83], a[248:251]
    v_exp_f32 v113, v113
    v_mfma_f32_16x16x32_bf16 a[236:239], v[56:59], v[88:91], a[236:239]
    s_waitcnt lgkmcnt(2)
    ds_read_b128 v[48:51], v1 offset:256
    v_add_f32 v13, v13, v109
    v_mfma_f32_16x16x32_bf16 a[252:255], v[60:63], v[88:91], a[252:255]
    s_cbranch_scc1 L_tailS
    v_mfma_f32_16x16x32_bf16 v[64:67], v[32:35], v[128:131], 0
    s_add_u32 s24, s24, 16896
    v_exp_f32 v114, v114
    v_mfma_f32_16x16x32_bf16 v[64:67], v[36:39], v[132:135], v[64:67]
    s_cmp_eq_u32 s24, s31
    v_cvt_pk_bf16_f32 v106, v108, v109
    v_add_f32 v13, v13, v110
    v_mfma_f32_16x16x32_bf16 v[72:75], v[32:35], v[160:163], 0
    s_cmov_b32 s24, s30
    ds_read_b128 v[52:55], v1 offset:320
    v_add_f32 v13, v13, v111
    v_mfma_f32_16x16x32_bf16 v[72:75], v[36:39], v[164:167], v[72:75]
    s_add_u32 s25, s25, 16896
    v_exp_f32 v115, v115
    v_mfma_f32_16x16x32_bf16 v[80:83], v[32:35], v[192:195], 0
    s_cmp_eq_u32 s25, s32
    v_exp_f32 v116, v116
    v_mfma_f32_16x16x32_bf16 v[80:83], v[36:39], v[196:199], v[80:83]
    s_cmov_b32 s25, s37
    v_cvt_pk_bf16_f32 v107, v110, v111
    v_add_f32 v14, v14, v112
    v_mfma_f32_16x16x32_bf16 v[88:91], v[32:35], v[224:227], 0
    s_add_u32 s22, s22, 16384
    ds_read_b128 v[56:59], v1 offset:384
    v_add_f32 v14, v14, v113
    v_mfma_f32_16x16x32_bf16 v[88:91], v[36:39], v[228:231], v[88:91]
    s_waitcnt lgkmcnt(3)
    v_exp_f32 v117, v117
    v_mfma_f32_16x16x32_bf16 v[64:67], v[40:43], v[136:139], v[64:67]
    s_add_u32 s23, s23, 16384
    v_exp_f32 v118, v118
    v_mfma_f32_16x16x32_bf16 v[64:67], v[44:47], v[140:143], v[64:67]
    s_add_u32 s27, s27, 16896
    v_cvt_pk_bf16_f32 v112, v112, v113
    v_add_f32 v14, v14, v114
    v_mfma_f32_16x16x32_bf16 v[72:75], v[40:43], v[168:171], v[72:75]
    s_cmp_eq_u32 s27, 152064
    ds_read_b128 v[60:63], v1 offset:448
    v_add_f32 v14, v14, v115
    v_mfma_f32_16x16x32_bf16 v[72:75], v[44:47], v[172:175], v[72:75]
    s_cmov_b32 s27, 101376
    v_exp_f32 v119, v119
    v_mfma_f32_16x16x32_bf16 v[80:83], v[40:43], v[200:203], v[80:83]
    v_exp_f32 v120, v120
    v_mfma_f32_16x16x32_bf16 v[80:83], v[44:47], v[204:207], v[80:83]
    v_cvt_pk_bf16_f32 v113, v114, v115
    v_add_f32 v14, v14, v116
    v_mfma_f32_16x16x32_bf16 v[88:91], v[40:43], v[232:235], v[88:91]
    ds_read_b128 v[32:35], v1 offset:512
    v_add_u32 v3, s27, v4
    v_mfma_f32_16x16x32_bf16 v[88:91], v[44:47], v[236:239], v[88:91]
    s_waitcnt lgkmcnt(3)
    v_exp_f32 v121, v121
    v_mfma_f32_16x16x32_bf16 v[64:67], v[48:51], v[144:147], v[64:67]
    s_add_u32 s26, s26, 16896
    v_add_f32 v14, v14, v117
    v_cvt_pk_bf16_f32 v114, v116, v117
    v_mfma_f32_16x16x32_bf16 v[64:67], v[52:55], v[148:151], v[64:67]
    s_cmp_eq_u32 s26, 67584
    v_exp_f32 v122, v122
    v_mfma_f32_16x16x32_bf16 v[72:75], v[48:51], v[176:179], v[72:75]
    s_cmov_b32 s26, 0
    ds_read_b128 v[36:39], v1 offset:576
    v_add_f32 v14, v14, v118
    v_mfma_f32_16x16x32_bf16 v[72:75], v[52:55], v[180:183], v[72:75]
    s_add_u32 s28, s28, 1
    v_exp_f32 v123, v123
    v_mfma_f32_16x16x32_bf16 v[80:83], v[48:51], v[208:211], v[80:83]
    v_add_f32 v14, v14, v119
    v_cvt_pk_bf16_f32 v115, v118, v119
    v_mfma_f32_16x16x32_bf16 v[80:83], v[52:55], v[212:215], v[80:83]
    v_exp_f32 v124, v124
    v_mfma_f32_16x16x32_bf16 v[88:91], v[48:51], v[240:243], v[88:91]
    ds_read_b128 v[40:43], v1 offset:640
    v_add_f32 v15, v15, v120
    v_mfma_f32_16x16x32_bf16 v[88:91], v[52:55], v[244:247], v[88:91]
    s_waitcnt lgkmcnt(3)
    v_exp_f32 v125, v125
    v_mfma_f32_16x16x32_bf16 v[64:67], v[56:59], v[152:155], v[64:67]
    v_add_f32 v15, v15, v121
    v_cvt_pk_bf16_f32 v120, v120, v121
    v_mfma_f32_16x16x32_bf16 v[64:67], v[60:63], v[156:159], v[64:67]
    v_exp_f32 v126, v126
    v_mfma_f32_16x16x32_bf16 v[72:75], v[56:59], v[184:187], v[72:75]
    ds_read_b128 v[44:47], v1 offset:704
    v_add_f32 v15, v15, v122
    v_mfma_f32_16x16x32_bf16 v[72:75], v[60:63], v[188:191], v[72:75]
    v_exp_f32 v127, v127
    v_mfma_f32_16x16x32_bf16 v[80:83], v[56:59], v[216:219], v[80:83]
    v_add_f32 v15, v15, v123
    v_cvt_pk_bf16_f32 v121, v122, v123
    v_mfma_f32_16x16x32_bf16 v[80:83], v[60:63], v[220:223], v[80:83]
    v_add_f32 v15, v15, v124
    v_add_f32 v15, v15, v125
    v_mfma_f32_16x16x32_bf16 v[88:91], v[56:59], v[248:251], v[88:91]
    ds_read_b128 v[48:51], v1 offset:768
    v_cvt_pk_bf16_f32 v122, v124, v125
    v_mfma_f32_16x16x32_bf16 v[88:91], v[60:63], v[252:255], v[88:91]
    s_waitcnt lgkmcnt(3)
    v_add_f32 v15, v15, v126
    v_add_f32 v15, v15, v127
    v_mfma_f32_16x16x32_bf16 v[68:71], v[32:35], v[128:131], 0
    v_fma_f32 v64, v64, s20, -v16
    v_fma_f32 v65, v65, s20, -v16
    v_mfma_f32_16x16x32_bf16 v[68:71], v[36:39], v[132:135], v[68:71]
    v_fma_f32 v66, v66, s20, -v16
    v_max3_f32 v20, v64, v65, v66
    v_mfma_f32_16x16x32_bf16 v[76:79], v[32:35], v[160:163], 0
    ds_read_b128 v[52:55], v1 offset:832
    v_fma_f32 v67, v67, s20, -v16
    v_mfma_f32_16x16x32_bf16 v[76:79], v[36:39], v[164:167], v[76:79]
    v_fma_f32 v72, v72, s20, -v17
    v_max3_f32 v20, v20, v67, v72
    v_mfma_f32_16x16x32_bf16 v[84:87], v[32:35], v[192:195], 0
    v_fma_f32 v73, v73, s20, -v17
    v_fma_f32 v74, v74, s20, -v17
    v_mfma_f32_16x16x32_bf16 v[84:87], v[36:39], v[196:199], v[84:87]
    v_max3_f32 v20, v20, v73, v74
    v_fma_f32 v75, v75, s20, -v17
    v_mfma_f32_16x16x32_bf16 v[92:95], v[32:35], v[224:227], 0
    ds_read_b128 v[56:59], v1 offset:896
    v_fma_f32 v80, v80, s20, -v18
    v_mfma_f32_16x16x32_bf16 v[92:95], v[36:39], v[228:231], v[92:95]
    s_waitcnt lgkmcnt(3)
    v_max3_f32 v20, v20, v75, v80
    v_fma_f32 v81, v81, s20, -v18
    v_mfma_f32_16x16x32_bf16 v[68:71], v[40:43], v[136:139], v[68:71]
    s_waitcnt vmcnt(8)
    v_fma_f32 v82, v82, s20, -v18
    v_max3_f32 v20, v20, v81, v82
    v_mfma_f32_16x16x32_bf16 v[68:71], v[44:47], v[140:143], v[68:71]
    s_barrier
    v_mfma_f32_16x16x32_bf16 v[76:79], v[40:43], v[168:171], v[76:79]
    ds_read_b128 v[60:63], v1 offset:960
    v_fma_f32 v83, v83, s20, -v18
    v_mfma_f32_16x16x32_bf16 v[76:79], v[44:47], v[172:175], v[76:79]
    v_fma_f32 v88, v88, s20, -v19
    v_max3_f32 v20, v20, v83, v88
    v_mfma_f32_16x16x32_bf16 v[84:87], v[40:43], v[200:203], v[84:87]
    s_add_u32 m0, s24, 0
    ds_read_b64_tr_b16 v[32:33], v3 offset:0
    v_add_u32 v1, s26, v2
    v_mfma_f32_16x16x32_bf16 v[84:87], v[44:47], v[204:207], v[84:87]
    buffer_load_dwordx4 v5, s[8:11], s22 offen offset:0 nt lds
    v_mfma_f32_16x16x32_bf16 v[92:95], v[40:43], v[232:235], v[92:95]
    ds_read_b64_tr_b16 v[34:35], v3 offset:512
    v_fma_f32 v89, v89, s20, -v19
    v_mfma_f32_16x16x32_bf16 v[92:95], v[44:47], v[236:239], v[92:95]
    s_waitcnt lgkmcnt(4)
    v_fma_f32 v90, v90, s20, -v19
    v_max3_f32 v20, v20, v89, v90
    v_mfma_f32_16x16x32_bf16 v[68:71], v[48:51], v[144:147], v[68:71]
    ds_read_b64_tr_b16 v[36:37], v3 offset:32
    v_fma_f32 v91, v91, s20, -v19
    v_mfma_f32_16x16x32_bf16 v[68:71], v[52:55], v[148:151], v[68:71]
    v_cvt_pk_bf16_f32 v123, v126, v127
    v_mfma_f32_16x16x32_bf16 v[76:79], v[48:51], v[176:179], v[76:79]
    ds_read_b64_tr_b16 v[38:39], v3 offset:544
    v_mfma_f32_16x16x32_bf16 v[76:79], v[52:55], v[180:183], v[76:79]
    v_mfma_f32_16x16x32_bf16 v[84:87], v[48:51], v[208:211], v[84:87]
    ds_read_b64_tr_b16 v[40:41], v3 offset:64
    v_mfma_f32_16x16x32_bf16 v[84:87], v[52:55], v[212:215], v[84:87]
    v_mfma_f32_16x16x32_bf16 v[92:95], v[48:51], v[240:243], v[92:95]
    ds_read_b64_tr_b16 v[42:43], v3 offset:576
    v_mfma_f32_16x16x32_bf16 v[92:95], v[52:55], v[244:247], v[92:95]
    s_waitcnt lgkmcnt(6)
    v_mfma_f32_16x16x32_bf16 v[68:71], v[56:59], v[152:155], v[68:71]
    s_add_u32 m0, s25, 0
    ds_read_b64_tr_b16 v[44:45], v3 offset:96
    v_mfma_f32_16x16x32_bf16 v[68:71], v[60:63], v[156:159], v[68:71]
    buffer_load_dwordx4 v5, s[12:15], s23 offen offset:0 nt lds
    v_mfma_f32_16x16x32_bf16 v[76:79], v[56:59], v[184:187], v[76:79]
    ds_read_b64_tr_b16 v[46:47], v3 offset:608
    v_mfma_f32_16x16x32_bf16 v[76:79], v[60:63], v[188:191], v[76:79]
    v_mfma_f32_16x16x32_bf16 v[84:87], v[56:59], v[216:219], v[84:87]
    ds_read_b64_tr_b16 v[48:49], v3 offset:128
    v_mfma_f32_16x16x32_bf16 v[84:87], v[60:63], v[220:223], v[84:87]
    v_mfma_f32_16x16x32_bf16 v[92:95], v[56:59], v[248:251], v[92:95]
    ds_read_b64_tr_b16 v[50:51], v3 offset:640
    v_mfma_f32_16x16x32_bf16 v[92:95], v[60:63], v[252:255], v[92:95]
    s_waitcnt lgkmcnt(6)
    v_mfma_f32_16x16x32_bf16 a[0:3], v[32:35], v[96:99], a[0:3]
    ds_read_b64_tr_b16 v[52:53], v3 offset:160
    v_fma_f32 v68, v68, s20, -v16
    v_mfma_f32_16x16x32_bf16 a[16:19], v[36:39], v[96:99], a[16:19]
    v_max3_f32 v20, v20, v91, v68
    v_fma_f32 v69, v69, s20, -v16
    v_mfma_f32_16x16x32_bf16 a[4:7], v[32:35], v[104:107], a[4:7]
    s_add_u32 m0, s24, 544
    ds_read_b64_tr_b16 v[54:55], v3 offset:672
    v_fma_f32 v70, v70, s20, -v16
    v_mfma_f32_16x16x32_bf16 a[20:23], v[36:39], v[104:107], a[20:23]
    buffer_load_dwordx4 v5, s[8:11], s22 offen offset:512 nt lds
    v_mfma_f32_16x16x32_bf16 a[8:11], v[32:35], v[112:115], a[8:11]
    ds_read_b64_tr_b16 v[56:57], v3 offset:192
    v_max3_f32 v20, v20, v69, v70
    v_mfma_f32_16x16x32_bf16 a[24:27], v[36:39], v[112:115], a[24:27]
    v_fma_f32 v71, v71, s20, -v16
    v_fma_f32 v76, v76, s20, -v17
    v_mfma_f32_16x16x32_bf16 a[12:15], v[32:35], v[120:123], a[12:15]
    ds_read_b64_tr_b16 v[58:59], v3 offset:704
    v_max3_f32 v20, v20, v71, v76
    v_mfma_f32_16x16x32_bf16 a[28:31], v[36:39], v[120:123], a[28:31]
    s_waitcnt lgkmcnt(6)
    v_fma_f32 v77, v77, s20, -v17
    v_fma_f32 v78, v78, s20, -v17
    v_mfma_f32_16x16x32_bf16 a[32:35], v[40:43], v[96:99], a[32:35]
    ds_read_b64_tr_b16 v[60:61], v3 offset:224
    v_max3_f32 v20, v20, v77, v78
    v_mfma_f32_16x16x32_bf16 a[48:51], v[44:47], v[96:99], a[48:51]
    v_fma_f32 v79, v79, s20, -v17
    v_fma_f32 v84, v84, s20, -v18
    v_mfma_f32_16x16x32_bf16 a[36:39], v[40:43], v[104:107], a[36:39]
    ds_read_b64_tr_b16 v[62:63], v3 offset:736
    v_max3_f32 v20, v20, v79, v84
    v_mfma_f32_16x16x32_bf16 a[52:55], v[44:47], v[104:107], a[52:55]
    v_fma_f32 v85, v85, s20, -v18
    v_fma_f32 v86, v86, s20, -v18
    v_mfma_f32_16x16x32_bf16 a[40:43], v[40:43], v[112:115], a[40:43]
    s_add_u32 m0, s25, 544
    ds_read_b64_tr_b16 v[32:33], v3 offset:256
    v_max3_f32 v20, v20, v85, v86
    v_mfma_f32_16x16x32_bf16 a[56:59], v[44:47], v[112:115], a[56:59]
    buffer_load_dwordx4 v5, s[12:15], s23 offen offset:512 nt lds
    v_mfma_f32_16x16x32_bf16 a[44:47], v[40:43], v[120:123], a[44:47]
    ds_read_b64_tr_b16 v[34:35], v3 offset:768
    v_fma_f32 v87, v87, s20, -v18
    v_mfma_f32_16x16x32_bf16 a[60:63], v[44:47], v[120:123], a[60:63]
    s_waitcnt lgkmcnt(6)
    v_fma_f32 v92, v92, s20, -v19
    v_max3_f32 v20, v20, v87, v92
    v_mfma_f32_16x16x32_bf16 a[64:67], v[48:51], v[96:99], a[64:67]
    ds_read_b64_tr_b16 v[36:37], v3 offset:288
    v_fma_f32 v93, v93, s20, -v19
    v_mfma_f32_16x16x32_bf16 a[80:83], v[52:55], v[96:99], a[80:83]
    v_fma_f32 v94, v94, s20, -v19
    v_max3_f32 v20, v20, v93, v94
    v_mfma_f32_16x16x32_bf16 a[68:71], v[48:51], v[104:107], a[68:71]
    ds_read_b64_tr_b16 v[38:39], v3 offset:800
    v_fma_f32 v95, v95, s20, -v19
    v_mfma_f32_16x16x32_bf16 a[84:87], v[52:55], v[104:107], a[84:87]
    v_max_f32 v20, v20, v95
    v_cmp_lt_f32 vcc, 0x41000000, v20
    v_mfma_f32_16x16x32_bf16 a[72:75], v[48:51], v[112:115], a[72:75]
    ds_read_b64_tr_b16 v[40:41], v3 offset:320
    v_mfma_f32_16x16x32_bf16 a[88:91], v[52:55], v[112:115], a[88:91]
    s_cbranch_vccnz L_slow1
L_back1:
    v_mfma_f32_16x16x32_bf16 a[76:79], v[48:51], v[120:123], a[76:79]
    ds_read_b64_tr_b16 v[42:43], v3 offset:832
    v_mfma_f32_16x16x32_bf16 a[92:95], v[52:55], v[120:123], a[92:95]
    s_waitcnt lgkmcnt(6)
    v_exp_f32 v64, v64
    v_mfma_f32_16x16x32_bf16 a[96:99], v[56:59], v[96:99], a[96:99]
    s_add_u32 m0, s24, 1088
    ds_read_b64_tr_b16 v[44:45], v3 offset:352
    v_add_f32 v12, v12, v64
    v_mfma_f32_16x16x32_bf16 a[112:115], v[60:63], v[96:99], a[112:115]
    buffer_load_dwordx4 v5, s[8:11], s22 offen offset:1024 nt lds
    v_mfma_f32_16x16x32_bf16 a[100:103], v[56:59], v[104:107], a[100:103]
    ds_read_b64_tr_b16 v[46:47], v3 offset:864
    v_mfma_f32_16x16x32_bf16 a[116:119], v[60:63], v[104:107], a[116:119]
    v_exp_f32 v65, v65
    v_mfma_f32_16x16x32_bf16 a[104:107], v[56:59], v[112:115], a[104:107]
    ds_read_b64_tr_b16 v[48:49], v3 offset:384
    v_add_f32 v12, v12, v65
    v_mfma_f32_16x16x32_bf16 a[120:123], v[60:63], v[112:115], a[120:123]
    v_exp_f32 v66, v66
    v_mfma_f32_16x16x32_bf16 a[108:111], v[56:59], v[120:123], a[108:111]
    ds_read_b64_tr_b16 v[50:51], v3 offset:896
    v_cvt_pk_bf16_f32 v64, v64, v65
    v_mfma_f32_16x16x32_bf16 a[124:127], v[60:63], v[120:123], a[124:127]
    s_waitcnt lgkmcnt(6)
    v_exp_f32 v67, v67
    v_mfma_f32_16x16x32_bf16 a[128:131], v[32:35], v[96:99], a[128:131]
    ds_read_b64_tr_b16 v[52:53], v3 offset:416
    v_add_f32 v12, v12, v66
    v_mfma_f32_16x16x32_bf16 a[144:147], v[36:39], v[96:99], a[144:147]
    v_exp_f32 v68, v68
    v_mfma_f32_16x16x32_bf16 a[132:135], v[32:35], v[104:107], a[132:135]
    s_add_u32 m0, s25, 1088
    ds_read_b64_tr_b16 v[54:55], v3 offset:928
    v_add_f32 v12, v12, v67
    v_mfma_f32_16x16x32_bf16 a[148:151], v[36:39], v[104:107], a[148:151]
    buffer_load_dwordx4 v5, s[12:15], s23 offen offset:1024 nt lds
    v_mfma_f32_16x16x32_bf16 a[136:139], v[32:35], v[112:115], a[136:139]
    ds_read_b64_tr_b16 v[56:57], v3 offset:448
    v_cvt_pk_bf16_f32 v65, v66, v67
    v_mfma_f32_16x16x32_bf16 a[152:155], v[36:39], v[112:115], a[152:155]
    v_exp_f32 v69, v69
    v_mfma_f32_16x16x32_bf16 a[140:143], v[32:35], v[120:123], a[140:143]
    ds_read_b64_tr_b16 v[58:59], v3 offset:960
    v_add_f32 v12, v12, v68
    v_mfma_f32_16x16x32_bf16 a[156:159], v[36:39], v[120:123], a[156:159]
    s_waitcnt lgkmcnt(6)
    v_exp_f32 v70, v70
    v_mfma_f32_16x16x32_bf16 a[160:163], v[40:43], v[96:99], a[160:163]
    ds_read_b64_tr_b16 v[60:61], v3 offset:480
    v_add_f32 v12, v12, v69
    v_mfma_f32_16x16x32_bf16 a[176:179], v[44:47], v[96:99], a[176:179]
    v_exp_f32 v71, v71
    v_mfma_f32_16x16x32_bf16 a[164:167], v[40:43], v[104:107], a[164:167]
    ds_read_b64_tr_b16 v[62:63], v3 offset:992
    v_cvt_pk_bf16_f32 v66, v68, v69
    v_mfma_f32_16x16x32_bf16 a[180:183], v[44:47], v[104:107], a[180:183]
    s_add_u32 m0, s24, 1632
    v_exp_f32 v72, v72
    v_mfma_f32_16x16x32_bf16 a[168:171], v[40:43], v[112:115], a[168:171]
    buffer_load_dwordx4 v5, s[8:11], s22 offen offset:1536 nt lds
    v_mfma_f32_16x16x32_bf16 a[184:187], v[44:47], v[112:115], a[184:187]
    v_exp_f32 v73, v73
    v_mfma_f32_16x16x32_bf16 a[172:175], v[40:43], v[120:123], a[172:175]
    ds_read_b128 v[32:35], v1 offset:0
    v_add_f32 v12, v12, v70
    v_mfma_f32_16x16x32_bf16 a[188:191], v[44:47], v[120:123], a[188:191]
    s_waitcnt lgkmcnt(5)
    v_exp_f32 v74, v74
    v_mfma_f32_16x16x32_bf16 a[192:195], v[48:51], v[96:99], a[192:195]
    v_exp_f32 v75, v75
    v_mfma_f32_16x16x32_bf16 a[208:211], v[52:55], v[96:99], a[208:211]
    v_add_f32 v12, v12, v71
    v_cvt_pk_bf16_f32 v67, v70, v71
    v_mfma_f32_16x16x32_bf16 a[196:199], v[48:51], v[104:107], a[196:199]
    ds_read_b128 v[36:39], v1 offset:64
    v_add_f32 v13, v13, v72
    v_mfma_f32_16x16x32_bf16 a[212:215], v[52:55], v[104:107], a[212:215]
    v_exp_f32 v76, v76
    v_mfma_f32_16x16x32_bf16 a[200:203], v[48:51], v[112:115], a[200:203]
    s_add_u32 m0, s25, 1632
    v_exp_f32 v77, v77
    v_mfma_f32_16x16x32_bf16 a[216:219], v[52:55], v[112:115], a[216:219]
    buffer_load_dwordx4 v5, s[12:15], s23 offen offset:1536 nt lds
    v_mfma_f32_16x16x32_bf16 a[204:207], v[48:51], v[120:123], a[204:207]
    s_cmp_eq_u32 s28, 31
    ds_read_b128 v[40:43], v1 offset:128
    v_add_f32 v13, v13, v73
    v_mfma_f32_16x16x32_bf16 a[220:223], v[52:55], v[120:123], a[220:223]
    s_waitcnt lgkmcnt(3)
    v_exp_f32 v78, v78
    v_mfma_f32_16x16x32_bf16 a[224:227], v[56:59], v[96:99], a[224:227]
    v_cvt_pk_bf16_f32 v72, v72, v73
    v_add_f32 v13, v13, v74
    v_mfma_f32_16x16x32_bf16 a[240:243], v[60:63], v[96:99], a[240:243]
    v_exp_f32 v79, v79
    v_mfma_f32_16x16x32_bf16 a[228:231], v[56:59], v[104:107], a[228:231]
    ds_read_b128 v[44:47], v1 offset:192
    v_add_f32 v13, v13, v75
    v_mfma_f32_16x16x32_bf16 a[244:247], v[60:63], v[104:107], a[244:247]
    v_exp_f32 v80, v80
    v_mfma_f32_16x16x32_bf16 a[232:235], v[56:59], v[112:115], a[232:235]
    v_cvt_pk_bf16_f32 v73, v74, v75
    v_add_f32 v13, v13, v76
    v_mfma_f32_16x16x32_bf16 a[248:251], v[60:63], v[112:115], a[248:251]
    v_exp_f32 v81, v81
    v_mfma_f32_16x16x32_bf16 a[236:239], v[56:59], v[120:123], a[236:239]
    s_waitcnt lgkmcnt(2)
    ds_read_b128 v[48:51], v1 offset:256
    v_add_f32 v13, v13, v77
    v_mfma_f32_16x16x32_bf16 a[252:255], v[60:63], v[120:123], a[252:255]
    s_branch L_loopS
L_tailS:
    s_add_u32 s27, s27, 16896
    s_cmp_eq_u32 s27, 152064
    s_cmov_b32 s27, 101376
    v_add_u32 v3, s27, v4
    s_waitcnt vmcnt(0)
    s_barrier
    ds_read_b64_tr_b16 v[32:33], v3 offset:0
    ds_read_b64_tr_b16 v[34:35], v3 offset:512
    ds_read_b64_tr_b16 v[36:37], v3 offset:32
    ds_read_b64_tr_b16 v[38:39], v3 offset:544
    s_waitcnt lgkmcnt(6)
    ds_read_b64_tr_b16 v[40:41], v3 offset:64
    ds_read_b64_tr_b16 v[42:43], v3 offset:576
    s_waitcnt lgkmcnt(7)
    ds_read_b64_tr_b16 v[44:45], v3 offset:96
    ds_read_b64_tr_b16 v[46:47], v3 offset:608
    s_waitcnt lgkmcnt(8)
    ds_read_b64_tr_b16 v[48:49], v3 offset:128
    ds_read_b64_tr_b16 v[50:51], v3 offset:640
    ds_read_b64_tr_b16 v[52:53], v3 offset:160
    ds_read_b64_tr_b16 v[54:55], v3 offset:672
    v_exp_f32 v114, v114
    s_nop 0
    v_cvt_pk_bf16_f32 v106, v108, v109
    v_add_f32 v13, v13, v110
    v_add_f32 v13, v13, v111
    v_exp_f32 v115, v115
    v_exp_f32 v116, v116
    s_nop 0
    v_cvt_pk_bf16_f32 v107, v110, v111
    v_add_f32 v14, v14, v112
    v_add_f32 v14, v14, v113
    v_exp_f32 v117, v117
    v_exp_f32 v118, v118
    s_nop 0
    v_cvt_pk_bf16_f32 v112, v112, v113
    v_add_f32 v14, v14, v114
    v_add_f32 v14, v14, v115
    v_exp_f32 v119, v119
    v_exp_f32 v120, v120
    s_nop 0
    v_cvt_pk_bf16_f32 v113, v114, v115
    v_add_f32 v14, v14, v116
    v_exp_f32 v121, v121
    s_nop 0
    v_add_f32 v14, v14, v117
    v_cvt_pk_bf16_f32 v114, v116, v117
    v_exp_f32 v122, v122
    s_nop 0
    v_add_f32 v14, v14, v118
    v_exp_f32 v123, v123
    s_nop 0
    v_add_f32 v14, v14, v119
    v_cvt_pk_bf16_f32 v115, v118, v119
    v_exp_f32 v124, v124
    s_nop 0
    v_add_f32 v15, v15, v120
    v_exp_f32 v125, v125
    s_nop 0
    v_add_f32 v15, v15, v121
    v_cvt_pk_bf16_f32 v120, v120, v121
    v_exp_f32 v126, v126
    s_nop 0
    v_add_f32 v15, v15, v122
    v_exp_f32 v127, v127
    s_nop 0
    v_add_f32 v15, v15, v123
    v_cvt_pk_bf16_f32 v121, v122, v123
    v_add_f32 v15, v15, v124
    v_add_f32 v15, v15, v125
    v_cvt_pk_bf16_f32 v122, v124, v125
    v_add_f32 v15, v15, v126
    v_add_f32 v15, v15, v127
    v_cvt_pk_bf16_f32 v123, v126, v127
    s_nop 1
    s_waitcnt lgkmcnt(10)
    v_mfma_f32_16x16x32_bf16 a[0:3], v[32:35], v[96:99], a[0:3]
    v_mov_b32 v9, v12
    s_nop 1
    v_permlane16_swap_b32 v12, v9
    v_add_f32 v12, v12, v9
    s_waitcnt lgkmcnt(8)
    v_mfma_f32_16x16x32_bf16 a[16:19], v[36:39], v[96:99], a[16:19]
    v_mov_b32 v9, v12
    s_nop 1
    v_permlane32_swap_b32 v12, v9
    v_add_f32 v12, v12, v9
    v_mfma_f32_16x16x32_bf16 a[4:7], v[32:35], v[104:107], a[4:7]
    v_mov_b32 v9, v13
    s_nop 1
    v_permlane16_swap_b32 v13, v9
    v_add_f32 v13, v13, v9
    v_mfma_f32_16x16x32_bf16 a[20:23], v[36:39], v[104:107], a[20:23]
    v_mov_b32 v9, v13
    s_nop 1
    v_permlane32_swap_b32 v13, v9
    v_add_f32 v13, v13, v9
    v_mfma_f32_16x16x32_bf16 a[8:11], v[32:35], v[112:115], a[8:11]
    v_mov_b32 v9, v14
    s_nop 1
    v_permlane16_swap_b32 v14, v9
    v_add_f32 v14, v14, v9
    v_mfma_f32_16x16x32_bf16 a[24:27], v[36:39], v[112:115], a[24:27]
    v_mov_b32 v9, v14
    s_nop 1
    v_permlane32_swap_b32 v14, v9
    v_add_f32 v14, v14, v9
    v_mfma_f32_16x16x32_bf16 a[12:15], v[32:35], v[120:123], a[12:15]
    v_mov_b32 v9, v15
    s_nop 1
    v_permlane16_swap_b32 v15, v9
    v_add_f32 v15, v15, v9
    v_mfma_f32_16x16x32_bf16 a[28:31], v[36:39], v[120:123], a[28:31]
    s_nop 0
    s_waitcnt lgkmcnt(8)
    ds_read_b64_tr_b16 v[56:57], v3 offset:192
    ds_read_b64_tr_b16 v[58:59], v3 offset:704
    s_nop 0
    ds_read_b64_tr_b16 v[60:61], v3 offset:224
    ds_read_b64_tr_b16 v[62:63], v3 offset:736
    v_mov_b32 v9, v15
    s_nop 1
    v_permlane32_swap_b32 v15, v9
    v_add_f32 v15, v15, v9
    s_waitcnt lgkmcnt(10)
    v_mfma_f32_16x16x32_bf16 a[32:35], v[40:43], v[96:99], a[32:35]
    v_rcp_f32 v12, v12
    v_rcp_f32 v13, v13
    v_rcp_f32 v14, v14
    v_rcp_f32 v15, v15
    s_waitcnt lgkmcnt(8)
    v_mfma_f32_16x16x32_bf16 a[48:51], v[44:47], v[96:99], a[48:51]
    v_and_b32 v252, 63, v0
    v_and_b32 v253, 15, v252
    v_lshrrev_b32 v254, 4, v252
    v_mul_u32_u24 v253, 528, v253
    v_mfma_f32_16x16x32_bf16 a[36:39], v[40:43], v[104:107], a[36:39]
    v_lshl_add_u32 v253, v254, 3, v253
    s_mul_i32 s33, s29, 33792
    v_add_u32 v6, s33, v253
    v_lshrrev_b32 v253, 3, v252
    v_mfma_f32_16x16x32_bf16 a[52:55], v[44:47], v[104:107], a[52:55]
    v_and_b32 v254, 7, v252
    v_lshlrev_b32 v254, 4, v254
    v_mul_u32_u24 v255, 528, v253
    v_add3_u32 v7, s33, v255, v254
    v_mfma_f32_16x16x32_bf16 a[40:43], v[40:43], v[112:115], a[40:43]
    v_lshl_add_u32 v8, v253, 9, v254
    s_add_u32 s88, s96, 0
    s_add_u32 s89, s96, 4096
    s_add_u32 s90, s96, 8192
    v_mfma_f32_16x16x32_bf16 a[56:59], v[44:47], v[112:115], a[56:59]
    s_add_u32 s91, s96, 12288
    s_add_u32 s92, s96, 16384
    s_add_u32 s93, s96, 20480
    s_add_u32 s94, s96, 24576
    v_mfma_f32_16x16x32_bf16 a[44:47], v[40:43], v[120:123], a[44:47]
    s_add_u32 s95, s96, 28672
    v_mfma_f32_16x16x32_bf16 a[60:63], v[44:47], v[120:123], a[60:63]
    s_nop 0
    ds_read_b64_tr_b16 v[32:33], v3 offset:256
    ds_read_b64_tr_b16 v[34:35], v3 offset:768
    s_nop 0
    ds_read_b64_tr_b16 v[36:37], v3 offset:288
    s_waitcnt lgkmcnt(8)
    ds_read_b64_tr_b16 v[38:39], v3 offset:800
    s_nop 3
    v_mfma_f32_16x16x32_bf16 a[64:67], v[48:51], v[96:99], a[64:67]
    v_accvgpr_read_b32 v128, a0
    v_accvgpr_read_b32 v129, a1
    v_accvgpr_read_b32 v130, a2
    v_accvgpr_read_b32 v131, a3
    v_mul_f32 v128, v128, v12
    v_mul_f32 v129, v129, v12
    v_mul_f32 v130, v130, v12
    v_mul_f32 v131, v131, v12
    v_cvt_pk_bf16_f32 v128, v128, v129
    v_cvt_pk_bf16_f32 v129, v130, v131
    ds_write_b64 v6, v[128:129] offset:0
    s_waitcnt lgkmcnt(9)
    v_mfma_f32_16x16x32_bf16 a[80:83], v[52:55], v[96:99], a[80:83]
    v_accvgpr_read_b32 v132, a16
    v_accvgpr_read_b32 v133, a17
    v_accvgpr_read_b32 v134, a18
    v_accvgpr_read_b32 v135, a19
    v_mul_f32 v132, v132, v12
    v_mul_f32 v133, v133, v12
    v_mul_f32 v134, v134, v12
    v_mul_f32 v135, v135, v12
    v_cvt_pk_bf16_f32 v132, v132, v133
    v_cvt_pk_bf16_f32 v133, v134, v135
    ds_write_b64 v6, v[132:133] offset:32
    v_mfma_f32_16x16x32_bf16 a[68:71], v[48:51], v[104:107], a[68:71]
    v_accvgpr_read_b32 v136, a32
    v_accvgpr_read_b32 v137, a33
    v_accvgpr_read_b32 v138, a34
    v_accvgpr_read_b32 v139, a35
    v_mul_f32 v136, v136, v12
    v_mul_f32 v137, v137, v12
    v_mul_f32 v138, v138, v12
    v_mul_f32 v139, v139, v12
    v_cvt_pk_bf16_f32 v136, v136, v137
    v_cvt_pk_bf16_f32 v137, v138, v139
    ds_write_b64 v6, v[136:137] offset:64
    v_mfma_f32_16x16x32_bf16 a[84:87], v[52:55], v[104:107], a[84:87]
    v_accvgpr_read_b32 v140, a48
    v_accvgpr_read_b32 v141, a49
    v_accvgpr_read_b32 v142, a50
    v_accvgpr_read_b32 v143, a51
    v_mul_f32 v140, v140, v12
    v_mul_f32 v141, v141, v12
    v_mul_f32 v142, v142, v12
    v_mul_f32 v143, v143, v12
    v_cvt_pk_bf16_f32 v140, v140, v141
    v_cvt_pk_bf16_f32 v141, v142, v143
    ds_write_b64 v6, v[140:141] offset:96
    ds_read_b128 v[192:195], v7 offset:0
    ds_read_b128 v[196:199], v7 offset:4224
    v_mfma_f32_16x16x32_bf16 a[72:75], v[48:51], v[112:115], a[72:75]
    v_accvgpr_read_b32 v144, a4
    v_accvgpr_read_b32 v145, a5
    v_accvgpr_read_b32 v146, a6
    v_accvgpr_read_b32 v147, a7
    v_mul_f32 v144, v144, v13
    v_mul_f32 v145, v145, v13
    v_mul_f32 v146, v146, v13
    v_mul_f32 v147, v147, v13
    v_cvt_pk_bf16_f32 v144, v144, v145
    v_cvt_pk_bf16_f32 v145, v146, v147
    s_waitcnt lgkmcnt(8)
    ds_write_b64 v6, v[144:145] offset:8448
    v_mfma_f32_16x16x32_bf16 a[88:91], v[52:55], v[112:115], a[88:91]
    v_accvgpr_read_b32 v148, a20
    v_accvgpr_read_b32 v149, a21
    v_accvgpr_read_b32 v150, a22
    v_accvgpr_read_b32 v151, a23
    v_mul_f32 v148, v148, v13
    v_mul_f32 v149, v149, v13
    v_mul_f32 v150, v150, v13
    v_mul_f32 v151, v151, v13
    v_cvt_pk_bf16_f32 v148, v148, v149
    v_cvt_pk_bf16_f32 v149, v150, v151
    ds_write_b64 v6, v[148:149] offset:8480
    s_waitcnt lgkmcnt(3)
    buffer_store_dwordx4 v[192:195], v8, s[16:19], s88 offen offset:0 sc1
    s_waitcnt lgkmcnt(2)
    buffer_store_dwordx4 v[196:199], v8, s[16:19], s89 offen offset:0 sc1
    v_mfma_f32_16x16x32_bf16 a[76:79], v[48:51], v[120:123], a[76:79]
    v_accvgpr_read_b32 v152, a36
    v_accvgpr_read_b32 v153, a37
    v_accvgpr_read_b32 v154, a38
    v_accvgpr_read_b32 v155, a39
    v_mul_f32 v152, v152, v13
    v_mul_f32 v153, v153, v13
    v_mul_f32 v154, v154, v13
    v_mul_f32 v155, v155, v13
    v_cvt_pk_bf16_f32 v152, v152, v153
    v_cvt_pk_bf16_f32 v153, v154, v155
    ds_write_b64 v6, v[152:153] offset:8512
    v_mfma_f32_16x16x32_bf16 a[92:95], v[52:55], v[120:123], a[92:95]
    s_nop 0
    ds_read_b64_tr_b16 v[40:41], v3 offset:320
    ds_read_b64_tr_b16 v[42:43], v3 offset:832
    s_nop 0
    ds_read_b64_tr_b16 v[44:45], v3 offset:352
    ds_read_b64_tr_b16 v[46:47], v3 offset:864
    v_accvgpr_read_b32 v156, a52
    v_accvgpr_read_b32 v157, a53
    v_accvgpr_read_b32 v158, a54
    v_accvgpr_read_b32 v159, a55
    v_mul_f32 v156, v156, v13
    v_mul_f32 v157, v157, v13
    v_mul_f32 v158, v158, v13
    v_mul_f32 v159, v159, v13
    v_cvt_pk_bf16_f32 v156, v156, v157
    v_cvt_pk_bf16_f32 v157, v158, v159
    s_waitcnt lgkmcnt(8)
    ds_write_b64 v6, v[156:157] offset:8544
    ds_read_b128 v[200:203], v7 offset:8448
    ds_read_b128 v[204:207], v7 offset:12672
    v_mfma_f32_16x16x32_bf16 a[96:99], v[56:59], v[96:99], a[96:99]
    v_accvgpr_read_b32 v160, a8
    v_accvgpr_read_b32 v161, a9
    v_accvgpr_read_b32 v162, a10
    v_accvgpr_read_b32 v163, a11
    v_mul_f32 v160, v160, v14
    v_mul_f32 v161, v161, v14
    v_mul_f32 v162, v162, v14
    v_mul_f32 v163, v163, v14
    v_cvt_pk_bf16_f32 v160, v160, v161
    v_cvt_pk_bf16_f32 v161, v162, v163
    ds_write_b64 v6, v[160:161] offset:16896
    v_mfma_f32_16x16x32_bf16 a[112:115], v[60:63], v[96:99], a[112:115]
    v_accvgpr_read_b32 v164, a24
    v_accvgpr_read_b32 v165, a25
    v_accvgpr_read_b32 v166, a26
    v_accvgpr_read_b32 v167, a27
    v_mul_f32 v164, v164, v14
    v_mul_f32 v165, v165, v14
    v_mul_f32 v166, v166, v14
    v_mul_f32 v167, v167, v14
    v_cvt_pk_bf16_f32 v164, v164, v165
    v_cvt_pk_bf16_f32 v165, v166, v167
    ds_write_b64 v6, v[164:165] offset:16928
    s_waitcnt lgkmcnt(3)
    buffer_store_dwordx4 v[200:203], v8, s[16:19], s90 offen offset:0 sc1
    s_waitcnt lgkmcnt(2)
    buffer_store_dwordx4 v[204:207], v8, s[16:19], s91 offen offset:0 sc1
    v_mfma_f32_16x16x32_bf16 a[100:103], v[56:59], v[104:107], a[100:103]
    v_accvgpr_read_b32 v168, a40
    v_accvgpr_read_b32 v169, a41
    v_accvgpr_read_b32 v170, a42
    v_accvgpr_read_b32 v171, a43
    v_mul_f32 v168, v168, v14
    v_mul_f32 v169, v169, v14
    v_mul_f32 v170, v170, v14
    v_mul_f32 v171, v171, v14
    v_cvt_pk_bf16_f32 v168, v168, v169
    v_cvt_pk_bf16_f32 v169, v170, v171
    ds_write_b64 v6, v[168:169] offset:16960
    v_mfma_f32_16x16x32_bf16 a[116:119], v[60:63], v[104:107], a[116:119]
    v_accvgpr_read_b32 v172, a56
    v_accvgpr_read_b32 v173, a57
    v_accvgpr_read_b32 v174, a58
    v_accvgpr_read_b32 v175, a59
    v_mul_f32 v172, v172, v14
    v_mul_f32 v173, v173, v14
    v_mul_f32 v174, v174, v14
    v_mul_f32 v175, v175, v14
    v_cvt_pk_bf16_f32 v172, v172, v173
    v_cvt_pk_bf16_f32 v173, v174, v175
    ds_write_b64 v6, v[172:173] offset:16992
    s_waitcnt lgkmcnt(8)
    ds_read_b128 v[208:211], v7 offset:16896
    ds_read_b128 v[212:215], v7 offset:21120
    v_mfma_f32_16x16x32_bf16 a[104:107], v[56:59], v[112:115], a[104:107]
    v_accvgpr_read_b32 v176, a12
    v_accvgpr_read_b32 v177, a13
    v_accvgpr_read_b32 v178, a14
    v_accvgpr_read_b32 v179, a15
    v_mul_f32 v176, v176, v15
    v_mul_f32 v177, v177, v15
    v_mul_f32 v178, v178, v15
    v_mul_f32 v179, v179, v15
    v_cvt_pk_bf16_f32 v176, v176, v177
    v_cvt_pk_bf16_f32 v177, v178, v179
    ds_write_b64 v6, v[176:177] offset:25344
    v_mfma_f32_16x16x32_bf16 a[120:123], v[60:63], v[112:115], a[120:123]
    v_accvgpr_read_b32 v180, a28
    v_accvgpr_read_b32 v181, a29
    v_accvgpr_read_b32 v182, a30
    v_accvgpr_read_b32 v183, a31
    v_mul_f32 v180, v180, v15
    v_mul_f32 v181, v181, v15
    v_mul_f32 v182, v182, v15
    v_mul_f32 v183, v183, v15
    v_cvt_pk_bf16_f32 v180, v180, v181
    v_cvt_pk_bf16_f32 v181, v182, v183
    ds_write_b64 v6, v[180:181] offset:25376
    s_waitcnt lgkmcnt(3)
    buffer_store_dwordx4 v[208:211], v8, s[16:19], s92 offen offset:0 sc1
    s_waitcnt lgkmcnt(2)
    buffer_store_dwordx4 v[212:215], v8, s[16:19], s93 offen offset:0 sc1
    v_mfma_f32_16x16x32_bf16 a[108:111], v[56:59], v[120:123], a[108:111]
    v_accvgpr_read_b32 v184, a44
    v_accvgpr_read_b32 v185, a45
    v_accvgpr_read_b32 v186, a46
    v_accvgpr_read_b32 v187, a47
    v_mul_f32 v184, v184, v15
    v_mul_f32 v185, v185, v15
    v_mul_f32 v186, v186, v15
    v_mul_f32 v187, v187, v15
    v_cvt_pk_bf16_f32 v184, v184, v185
    v_cvt_pk_bf16_f32 v185, v186, v187
    ds_write_b64 v6, v[184:185] offset:25408
    v_mfma_f32_16x16x32_bf16 a[124:127], v[60:63], v[120:123], a[124:127]
    s_nop 0
    ds_read_b64_tr_b16 v[48:49], v3 offset:384
    ds_read_b64_tr_b16 v[50:51], v3 offset:896
    s_nop 0
    s_waitcnt lgkmcnt(8)
    ds_read_b64_tr_b16 v[52:53], v3 offset:416
    ds_read_b64_tr_b16 v[54:55], v3 offset:928
    v_accvgpr_read_b32 v188, a60
    v_accvgpr_read_b32 v189, a61
    v_accvgpr_read_b32 v190, a62
    v_accvgpr_read_b32 v191, a63
    v_mul_f32 v188, v188, v15
    v_mul_f32 v189, v189, v15
    v_mul_f32 v190, v190, v15
    v_mul_f32 v191, v191, v15
    v_cvt_pk_bf16_f32 v188, v188, v189
    v_cvt_pk_bf16_f32 v189, v190, v191
    ds_write_b64 v6, v[188:189] offset:25440
    ds_read_b128 v[216:219], v7 offset:25344
    ds_read_b128 v[220:223], v7 offset:29568
    v_mfma_f32_16x16x32_bf16 a[128:131], v[32:35], v[96:99], a[128:131]
    v_accvgpr_read_b32 v128, a64
    v_accvgpr_read_b32 v129, a65
    v_accvgpr_read_b32 v130, a66
    v_accvgpr_read_b32 v131, a67
    v_mul_f32 v128, v128, v12
    v_mul_f32 v129, v129, v12
    v_mul_f32 v130, v130, v12
    v_mul_f32 v131, v131, v12
    v_cvt_pk_bf16_f32 v128, v128, v129
    v_cvt_pk_bf16_f32 v129, v130, v131
    ds_write_b64 v6, v[128:129] offset:128
    v_mfma_f32_16x16x32_bf16 a[144:147], v[36:39], v[96:99], a[144:147]
    v_accvgpr_read_b32 v132, a80
    v_accvgpr_read_b32 v133, a81
    v_accvgpr_read_b32 v134, a82
    v_accvgpr_read_b32 v135, a83
    v_mul_f32 v132, v132, v12
    v_mul_f32 v133, v133, v12
    v_mul_f32 v134, v134, v12
    v_mul_f32 v135, v135, v12
    v_cvt_pk_bf16_f32 v132, v132, v133
    v_cvt_pk_bf16_f32 v133, v134, v135
    ds_write_b64 v6, v[132:133] offset:160
    s_waitcnt lgkmcnt(3)
    buffer_store_dwordx4 v[216:219], v8, s[16:19], s94 offen offset:0 sc1
    s_waitcnt lgkmcnt(2)
    buffer_store_dwordx4 v[220:223], v8, s[16:19], s95 offen offset:0 sc1
    v_mfma_f32_16x16x32_bf16 a[132:135], v[32:35], v[104:107], a[132:135]
    v_accvgpr_read_b32 v136, a96
    v_accvgpr_read_b32 v137, a97
    v_accvgpr_read_b32 v138, a98
    v_accvgpr_read_b32 v139, a99
    v_mul_f32 v136, v136, v12
    v_mul_f32 v137, v137, v12
    v_mul_f32 v138, v138, v12
    v_mul_f32 v139, v139, v12
    v_cvt_pk_bf16_f32 v136, v136, v137
    v_cvt_pk_bf16_f32 v137, v138, v139
    s_waitcnt lgkmcnt(8)
    ds_write_b64 v6, v[136:137] offset:192
    v_mfma_f32_16x16x32_bf16 a[148:151], v[36:39], v[104:107], a[148:151]
    v_accvgpr_read_b32 v140, a112
    v_accvgpr_read_b32 v141, a113
    v_accvgpr_read_b32 v142, a114
    v_accvgpr_read_b32 v143, a115
    v_mul_f32 v140, v140, v12
    v_mul_f32 v141, v141, v12
    v_mul_f32 v142, v142, v12
    v_mul_f32 v143, v143, v12
    v_cvt_pk_bf16_f32 v140, v140, v141
    v_cvt_pk_bf16_f32 v141, v142, v143
    ds_write_b64 v6, v[140:141] offset:224
    ds_read_b128 v[192:195], v7 offset:128
    ds_read_b128 v[196:199], v7 offset:4352
    v_mfma_f32_16x16x32_bf16 a[136:139], v[32:35], v[112:115], a[136:139]
    v_accvgpr_read_b32 v144, a68
    v_accvgpr_read_b32 v145, a69
    v_accvgpr_read_b32 v146, a70
    v_accvgpr_read_b32 v147, a71
    v_mul_f32 v144, v144, v13
    v_mul_f32 v145, v145, v13
    v_mul_f32 v146, v146, v13
    v_mul_f32 v147, v147, v13
    v_cvt_pk_bf16_f32 v144, v144, v145
    v_cvt_pk_bf16_f32 v145, v146, v147
    ds_write_b64 v6, v[144:145] offset:8576
    v_mfma_f32_16x16x32_bf16 a[152:155], v[36:39], v[112:115], a[152:155]
    v_accvgpr_read_b32 v148, a84
    v_accvgpr_read_b32 v149, a85
    v_accvgpr_read_b32 v150, a86
    v_accvgpr_read_b32 v151, a87
    v_mul_f32 v148, v148, v13
    v_mul_f32 v149, v149, v13
    v_mul_f32 v150, v150, v13
    v_mul_f32 v151, v151, v13
    v_cvt_pk_bf16_f32 v148, v148, v149
    v_cvt_pk_bf16_f32 v149, v150, v151
    ds_write_b64 v6, v[148:149] offset:8608
    s_waitcnt lgkmcnt(3)
    buffer_store_dwordx4 v[192:195], v8, s[16:19], s88 offen offset:128 sc1
    s_waitcnt lgkmcnt(2)
    buffer_store_dwordx4 v[196:199], v8, s[16:19], s89 offen offset:128 sc1
    v_mfma_f32_16x16x32_bf16 a[140:143], v[32:35], v[120:123], a[140:143]
    v_accvgpr_read_b32 v152, a100
    v_accvgpr_read_b32 v153, a101
    v_accvgpr_read_b32 v154, a102
    v_accvgpr_read_b32 v155, a103
    v_mul_f32 v152, v152, v13
    v_mul_f32 v153, v153, v13
    v_mul_f32 v154, v154, v13
    v_mul_f32 v155, v155, v13
    v_cvt_pk_bf16_f32 v152, v152, v153
    v_cvt_pk_bf16_f32 v153, v154, v155
    ds_write_b64 v6, v[152:153] offset:8640
    v_mfma_f32_16x16x32_bf16 a[156:159], v[36:39], v[120:123], a[156:159]
    s_nop 0
    s_waitcnt lgkmcnt(8)
    ds_read_b64_tr_b16 v[56:57], v3 offset:448
    ds_read_b64_tr_b16 v[58:59], v3 offset:960
    s_nop 0
    ds_read_b64_tr_b16 v[60:61], v3 offset:480
    ds_read_b64_tr_b16 v[62:63], v3 offset:992
    v_accvgpr_read_b32 v156, a116
    v_accvgpr_read_b32 v157, a117
    v_accvgpr_read_b32 v158, a118
    v_accvgpr_read_b32 v159, a119
    v_mul_f32 v156, v156, v13
    v_mul_f32 v157, v157, v13
    v_mul_f32 v158, v158, v13
    v_mul_f32 v159, v159, v13
    v_cvt_pk_bf16_f32 v156, v156, v157
    v_cvt_pk_bf16_f32 v157, v158, v159
    ds_write_b64 v6, v[156:157] offset:8672
    ds_read_b128 v[200:203], v7 offset:8576
    ds_read_b128 v[204:207], v7 offset:12800
    v_mfma_f32_16x16x32_bf16 a[160:163], v[40:43], v[96:99], a[160:163]
    v_accvgpr_read_b32 v160, a72
    v_accvgpr_read_b32 v161, a73
    v_accvgpr_read_b32 v162, a74
    v_accvgpr_read_b32 v163, a75
    v_mul_f32 v160, v160, v14
    v_mul_f32 v161, v161, v14
    v_mul_f32 v162, v162, v14
    v_mul_f32 v163, v163, v14
    v_cvt_pk_bf16_f32 v160, v160, v161
    v_cvt_pk_bf16_f32 v161, v162, v163
    s_waitcnt lgkmcnt(8)
    ds_write_b64 v6, v[160:161] offset:17024
    v_mfma_f32_16x16x32_bf16 a[176:179], v[44:47], v[96:99], a[176:179]
    v_accvgpr_read_b32 v164, a88
    v_accvgpr_read_b32 v165, a89
    v_accvgpr_read_b32 v166, a90
    v_accvgpr_read_b32 v167, a91
    v_mul_f32 v164, v164, v14
    v_mul_f32 v165, v165, v14
    v_mul_f32 v166, v166, v14
    v_mul_f32 v167, v167, v14
    v_cvt_pk_bf16_f32 v164, v164, v165
    v_cvt_pk_bf16_f32 v165, v166, v167
    ds_write_b64 v6, v[164:165] offset:17056
    s_waitcnt lgkmcnt(3)
    buffer_store_dwordx4 v[200:203], v8, s[16:19], s90 offen offset:128 sc1
    s_waitcnt lgkmcnt(2)
    buffer_store_dwordx4 v[204:207], v8, s[16:19], s91 offen offset:128 sc1
    v_mfma_f32_16x16x32_bf16 a[164:167], v[40:43], v[104:107], a[164:167]
    v_accvgpr_read_b32 v168, a104
    v_accvgpr_read_b32 v169, a105
    v_accvgpr_read_b32 v170, a106
    v_accvgpr_read_b32 v171, a107
    v_mul_f32 v168, v168, v14
    v_mul_f32 v169, v169, v14
    v_mul_f32 v170, v170, v14
    v_mul_f32 v171, v171, v14
    v_cvt_pk_bf16_f32 v168, v168, v169
    v_cvt_pk_bf16_f32 v169, v170, v171
    ds_write_b64 v6, v[168:169] offset:17088
    v_mfma_f32_16x16x32_bf16 a[180:183], v[44:47], v[104:107], a[180:183]
    v_accvgpr_read_b32 v172, a120
    v_accvgpr_read_b32 v173, a121
    v_accvgpr_read_b32 v174, a122
    v_accvgpr_read_b32 v175, a123
    v_mul_f32 v172, v172, v14
    v_mul_f32 v173, v173, v14
    v_mul_f32 v174, v174, v14
    v_mul_f32 v175, v175, v14
    v_cvt_pk_bf16_f32 v172, v172, v173
    v_cvt_pk_bf16_f32 v173, v174, v175
    ds_write_b64 v6, v[172:173] offset:17120
    ds_read_b128 v[208:211], v7 offset:17024
    ds_read_b128 v[212:215], v7 offset:21248
    v_mfma_f32_16x16x32_bf16 a[168:171], v[40:43], v[112:115], a[168:171]
    v_accvgpr_read_b32 v176, a76
    v_accvgpr_read_b32 v177, a77
    v_accvgpr_read_b32 v178, a78
    v_accvgpr_read_b32 v179, a79
    v_mul_f32 v176, v176, v15
    v_mul_f32 v177, v177, v15
    v_mul_f32 v178, v178, v15
    v_mul_f32 v179, v179, v15
    v_cvt_pk_bf16_f32 v176, v176, v177
    v_cvt_pk_bf16_f32 v177, v178, v179
    ds_write_b64 v6, v[176:177] offset:25472
    v_mfma_f32_16x16x32_bf16 a[184:187], v[44:47], v[112:115], a[184:187]
    v_accvgpr_read_b32 v180, a92
    v_accvgpr_read_b32 v181, a93
    v_accvgpr_read_b32 v182, a94
    v_accvgpr_read_b32 v183, a95
    v_mul_f32 v180, v180, v15
    v_mul_f32 v181, v181, v15
    v_mul_f32 v182, v182, v15
    v_mul_f32 v183, v183, v15
    v_cvt_pk_bf16_f32 v180, v180, v181
    v_cvt_pk_bf16_f32 v181, v182, v183
    s_waitcnt lgkmcnt(8)
    ds_write_b64 v6, v[180:181] offset:25504
    s_waitcnt lgkmcnt(3)
    buffer_store_dwordx4 v[208:211], v8, s[16:19], s92 offen offset:128 sc1
    s_waitcnt lgkmcnt(2)
    buffer_store_dwordx4 v[212:215], v8, s[16:19], s93 offen offset:128 sc1
    v_mfma_f32_16x16x32_bf16 a[172:175], v[40:43], v[120:123], a[172:175]
    v_accvgpr_read_b32 v184, a108
    v_accvgpr_read_b32 v185, a109
    v_accvgpr_read_b32 v186, a110
    v_accvgpr_read_b32 v187, a111
    v_mul_f32 v184, v184, v15
    v_mul_f32 v185, v185, v15
    v_mul_f32 v186, v186, v15
    v_mul_f32 v187, v187, v15
    v_cvt_pk_bf16_f32 v184, v184, v185
    v_cvt_pk_bf16_f32 v185, v186, v187
    ds_write_b64 v6, v[184:185] offset:25536
    v_mfma_f32_16x16x32_bf16 a[188:191], v[44:47], v[120:123], a[188:191]
    v_accvgpr_read_b32 v188, a124
    v_accvgpr_read_b32 v189, a125
    v_accvgpr_read_b32 v190, a126
    v_accvgpr_read_b32 v191, a127
    v_mul_f32 v188, v188, v15
    v_mul_f32 v189, v189, v15
    v_mul_f32 v190, v190, v15
    v_mul_f32 v191, v191, v15
    v_cvt_pk_bf16_f32 v188, v188, v189
    v_cvt_pk_bf16_f32 v189, v190, v191
    ds_write_b64 v6, v[188:189] offset:25568
    ds_read_b128 v[216:219], v7 offset:25472
    ds_read_b128 v[220:223], v7 offset:29696
    v_mfma_f32_16x16x32_bf16 a[192:195], v[48:51], v[96:99], a[192:195]
    v_accvgpr_read_b32 v128, a128
    v_accvgpr_read_b32 v129, a129
    v_accvgpr_read_b32 v130, a130
    v_accvgpr_read_b32 v131, a131
    v_mul_f32 v128, v128, v12
    v_mul_f32 v129, v129, v12
    v_mul_f32 v130, v130, v12
    v_mul_f32 v131, v131, v12
    v_cvt_pk_bf16_f32 v128, v128, v129
    v_cvt_pk_bf16_f32 v129, v130, v131
    ds_write_b64 v6, v[128:129] offset:256
    v_mfma_f32_16x16x32_bf16 a[208:211], v[52:55], v[96:99], a[208:211]
    v_accvgpr_read_b32 v132, a144
    v_accvgpr_read_b32 v133, a145
    v_accvgpr_read_b32 v134, a146
    v_accvgpr_read_b32 v135, a147
    v_mul_f32 v132, v132, v12
    v_mul_f32 v133, v133, v12
    v_mul_f32 v134, v134, v12
    v_mul_f32 v135, v135, v12
    v_cvt_pk_bf16_f32 v132, v132, v133
    v_cvt_pk_bf16_f32 v133, v134, v135
    ds_write_b64 v6, v[132:133] offset:288
    s_waitcnt lgkmcnt(3)
    buffer_store_dwordx4 v[216:219], v8, s[16:19], s94 offen offset:128 sc1
    s_waitcnt lgkmcnt(2)
    buffer_store_dwordx4 v[220:223], v8, s[16:19], s95 offen offset:128 sc1
    v_mfma_f32_16x16x32_bf16 a[196:199], v[48:51], v[104:107], a[196:199]
    v_accvgpr_read_b32 v136, a160
    v_accvgpr_read_b32 v137, a161
    v_accvgpr_read_b32 v138, a162
    v_accvgpr_read_b32 v139, a163
    v_mul_f32 v136, v136, v12
    v_mul_f32 v137, v137, v12
    v_mul_f32 v138, v138, v12
    v_mul_f32 v139, v139, v12
    v_cvt_pk_bf16_f32 v136, v136, v137
    v_cvt_pk_bf16_f32 v137, v138, v139
    s_waitcnt lgkmcnt(8)
    ds_write_b64 v6, v[136:137] offset:320
    v_mfma_f32_16x16x32_bf16 a[212:215], v[52:55], v[104:107], a[212:215]
    v_accvgpr_read_b32 v140, a176
    v_accvgpr_read_b32 v141, a177
    v_accvgpr_read_b32 v142, a178
    v_accvgpr_read_b32 v143, a179
    v_mul_f32 v140, v140, v12
    v_mul_f32 v141, v141, v12
    v_mul_f32 v142, v142, v12
    v_mul_f32 v143, v143, v12
    v_cvt_pk_bf16_f32 v140, v140, v141
    v_cvt_pk_bf16_f32 v141, v142, v143
    ds_write_b64 v6, v[140:141] offset:352
    ds_read_b128 v[192:195], v7 offset:256
    ds_read_b128 v[196:199], v7 offset:4480
    v_mfma_f32_16x16x32_bf16 a[200:203], v[48:51], v[112:115], a[200:203]
    v_accvgpr_read_b32 v144, a132
    v_accvgpr_read_b32 v145, a133
    v_accvgpr_read_b32 v146, a134
    v_accvgpr_read_b32 v147, a135
    v_mul_f32 v144, v144, v13
    v_mul_f32 v145, v145, v13
    v_mul_f32 v146, v146, v13
    v_mul_f32 v147, v147, v13
    v_cvt_pk_bf16_f32 v144, v144, v145
    v_cvt_pk_bf16_f32 v145, v146, v147
    ds_write_b64 v6, v[144:145] offset:8704
    v_mfma_f32_16x16x32_bf16 a[216:219], v[52:55], v[112:115], a[216:219]
    v_accvgpr_read_b32 v148, a148
    v_accvgpr_read_b32 v149, a149
    v_accvgpr_read_b32 v150, a150
    v_accvgpr_read_b32 v151, a151
    v_mul_f32 v148, v148, v13
    v_mul_f32 v149, v149, v13
    v_mul_f32 v150, v150, v13
    v_mul_f32 v151, v151, v13
    v_cvt_pk_bf16_f32 v148, v148, v149
    v_cvt_pk_bf16_f32 v149, v150, v151
    ds_write_b64 v6, v[148:149] offset:8736
    s_waitcnt lgkmcnt(3)
    buffer_store_dwordx4 v[192:195], v8, s[16:19], s88 offen offset:256 sc1
    s_waitcnt lgkmcnt(2)
    buffer_store_dwordx4 v[196:199], v8, s[16:19], s89 offen offset:256 sc1
    v_mfma_f32_16x16x32_bf16 a[204:207], v[48:51], v[120:123], a[204:207]
    v_accvgpr_read_b32 v152, a164
    v_accvgpr_read_b32 v153, a165
    v_accvgpr_read_b32 v154, a166
    v_accvgpr_read_b32 v155, a167
    v_mul_f32 v152, v152, v13
    v_mul_f32 v153, v153, v13
    v_mul_f32 v154, v154, v13
    v_mul_f32 v155, v155, v13
    v_cvt_pk_bf16_f32 v152, v152, v153
    v_cvt_pk_bf16_f32 v153, v154, v155
    ds_write_b64 v6, v[152:153] offset:8768
    v_mfma_f32_16x16x32_bf16 a[220:223], v[52:55], v[120:123], a[220:223]
    v_accvgpr_read_b32 v156, a180
    v_accvgpr_read_b32 v157, a181
    v_accvgpr_read_b32 v158, a182
    v_accvgpr_read_b32 v159, a183
    v_mul_f32 v156, v156, v13
    v_mul_f32 v157, v157, v13
    v_mul_f32 v158, v158, v13
    v_mul_f32 v159, v159, v13
    v_cvt_pk_bf16_f32 v156, v156, v157
    v_cvt_pk_bf16_f32 v157, v158, v159
    s_waitcnt lgkmcnt(8)
    ds_write_b64 v6, v[156:157] offset:8800
    ds_read_b128 v[200:203], v7 offset:8704
    ds_read_b128 v[204:207], v7 offset:12928
    v_mfma_f32_16x16x32_bf16 a[224:227], v[56:59], v[96:99], a[224:227]
    v_accvgpr_read_b32 v160, a136
    v_accvgpr_read_b32 v161, a137
    v_accvgpr_read_b32 v162, a138
    v_accvgpr_read_b32 v163, a139
    v_mul_f32 v160, v160, v14
    v_mul_f32 v161, v161, v14
    v_mul_f32 v162, v162, v14
    v_mul_f32 v163, v163, v14
    v_cvt_pk_bf16_f32 v160, v160, v161
    v_cvt_pk_bf16_f32 v161, v162, v163
    ds_write_b64 v6, v[160:161] offset:17152
    v_mfma_f32_16x16x32_bf16 a[240:243], v[60:63], v[96:99], a[240:243]
    v_accvgpr_read_b32 v164, a152
    v_accvgpr_read_b32 v165, a153
    v_accvgpr_read_b32 v166, a154
    v_accvgpr_read_b32 v167, a155
    v_mul_f32 v164, v164, v14
    v_mul_f32 v165, v165, v14
    v_mul_f32 v166, v166, v14
    v_mul_f32 v167, v167, v14
    v_cvt_pk_bf16_f32 v164, v164, v165
    v_cvt_pk_bf16_f32 v165, v166, v167
    ds_write_b64 v6, v[164:165] offset:17184
    s_waitcnt lgkmcnt(3)
    buffer_store_dwordx4 v[200:203], v8, s[16:19], s90 offen offset:256 sc1
    s_waitcnt lgkmcnt(2)
    buffer_store_dwordx4 v[204:207], v8, s[16:19], s91 offen offset:256 sc1
    v_mfma_f32_16x16x32_bf16 a[228:231], v[56:59], v[104:107], a[228:231]
    v_accvgpr_read_b32 v168, a168
    v_accvgpr_read_b32 v169, a169
    v_accvgpr_read_b32 v170, a170
    v_accvgpr_read_b32 v171, a171
    v_mul_f32 v168, v168, v14
    v_mul_f32 v169, v169, v14
    v_mul_f32 v170, v170, v14
    v_mul_f32 v171, v171, v14
    v_cvt_pk_bf16_f32 v168, v168, v169
    v_cvt_pk_bf16_f32 v169, v170, v171
    ds_write_b64 v6, v[168:169] offset:17216
    v_mfma_f32_16x16x32_bf16 a[244:247], v[60:63], v[104:107], a[244:247]
    v_accvgpr_read_b32 v172, a184
    v_accvgpr_read_b32 v173, a185
    v_accvgpr_read_b32 v174, a186
    v_accvgpr_read_b32 v175, a187
    v_mul_f32 v172, v172, v14
    v_mul_f32 v173, v173, v14
    v_mul_f32 v174, v174, v14
    v_mul_f32 v175, v175, v14
    v_cvt_pk_bf16_f32 v172, v172, v173
    v_cvt_pk_bf16_f32 v173, v174, v175
    ds_write_b64 v6, v[172:173] offset:17248
    s_waitcnt lgkmcnt(8)
    ds_read_b128 v[208:211], v7 offset:17152
    ds_read_b128 v[212:215], v7 offset:21376
    v_mfma_f32_16x16x32_bf16 a[232:235], v[56:59], v[112:115], a[232:235]
    v_accvgpr_read_b32 v176, a140
    v_accvgpr_read_b32 v177, a141
    v_accvgpr_read_b32 v178, a142
    v_accvgpr_read_b32 v179, a143
    v_mul_f32 v176, v176, v15
    v_mul_f32 v177, v177, v15
    v_mul_f32 v178, v178, v15
    v_mul_f32 v179, v179, v15
    v_cvt_pk_bf16_f32 v176, v176, v177
    v_cvt_pk_bf16_f32 v177, v178, v179
    ds_write_b64 v6, v[176:177] offset:25600
    v_mfma_f32_16x16x32_bf16 a[248:251], v[60:63], v[112:115], a[248:251]
    v_accvgpr_read_b32 v180, a156
    v_accvgpr_read_b32 v181, a157
    v_accvgpr_read_b32 v182, a158
    v_accvgpr_read_b32 v183, a159
    v_mul_f32 v180, v180, v15
    v_mul_f32 v181, v181, v15
    v_mul_f32 v182, v182, v15
    v_mul_f32 v183, v183, v15
    v_cvt_pk_bf16_f32 v180, v180, v181
    v_cvt_pk_bf16_f32 v181, v182, v183
    ds_write_b64 v6, v[180:181] offset:25632
    s_waitcnt lgkmcnt(3)
    buffer_store_dwordx4 v[208:211], v8, s[16:19], s92 offen offset:256 sc1
    s_waitcnt lgkmcnt(2)
    buffer_store_dwordx4 v[212:215], v8, s[16:19], s93 offen offset:256 sc1
    v_mfma_f32_16x16x32_bf16 a[236:239], v[56:59], v[120:123], a[236:239]
    v_accvgpr_read_b32 v184, a172
    v_accvgpr_read_b32 v185, a173
    v_accvgpr_read_b32 v186, a174
    v_accvgpr_read_b32 v187, a175
    v_mul_f32 v184, v184, v15
    v_mul_f32 v185, v185, v15
    v_mul_f32 v186, v186, v15
    v_mul_f32 v187, v187, v15
    v_cvt_pk_bf16_f32 v184, v184, v185
    v_cvt_pk_bf16_f32 v185, v186, v187
    ds_write_b64 v6, v[184:185] offset:25664
    v_mfma_f32_16x16x32_bf16 a[252:255], v[60:63], v[120:123], a[252:255]
    v_accvgpr_read_b32 v188, a188
    v_accvgpr_read_b32 v189, a189
    v_accvgpr_read_b32 v190, a190
    v_accvgpr_read_b32 v191, a191
    v_mul_f32 v188, v188, v15
    v_mul_f32 v189, v189, v15
    v_mul_f32 v190, v190, v15
    v_mul_f32 v191, v191, v15
    v_cvt_pk_bf16_f32 v188, v188, v189
    v_cvt_pk_bf16_f32 v189, v190, v191
    ds_write_b64 v6, v[188:189] offset:25696
    ds_read_b128 v[216:219], v7 offset:25600
    s_waitcnt lgkmcnt(8)
    ds_read_b128 v[220:223], v7 offset:29824
    v_accvgpr_read_b32 v128, a192
    v_accvgpr_read_b32 v129, a193
    v_accvgpr_read_b32 v130, a194
    v_accvgpr_read_b32 v131, a195
    v_mul_f32 v128, v128, v12
    v_mul_f32 v129, v129, v12
    v_mul_f32 v130, v130, v12
    v_mul_f32 v131, v131, v12
    v_cvt_pk_bf16_f32 v128, v128, v129
    v_cvt_pk_bf16_f32 v129, v130, v131
    ds_write_b64 v6, v[128:129] offset:384
    v_accvgpr_read_b32 v132, a208
    v_accvgpr_read_b32 v133, a209
    v_accvgpr_read_b32 v134, a210
    v_accvgpr_read_b32 v135, a211
    v_mul_f32 v132, v132, v12
    v_mul_f32 v133, v133, v12
    v_mul_f32 v134, v134, v12
    v_mul_f32 v135, v135, v12
    v_cvt_pk_bf16_f32 v132, v132, v133
    v_cvt_pk_bf16_f32 v133, v134, v135
    ds_write_b64 v6, v[132:133] offset:416
    s_waitcnt lgkmcnt(3)
    buffer_store_dwordx4 v[216:219], v8, s[16:19], s94 offen offset:256 sc1
    s_waitcnt lgkmcnt(2)
    buffer_store_dwordx4 v[220:223], v8, s[16:19], s95 offen offset:256 sc1
    v_accvgpr_read_b32 v136, a224
    v_accvgpr_read_b32 v137, a225
    v_accvgpr_read_b32 v138, a226
    v_accvgpr_read_b32 v139, a227
    v_mul_f32 v136, v136, v12
    v_mul_f32 v137, v137, v12
    v_mul_f32 v138, v138, v12
    v_mul_f32 v139, v139, v12
    v_cvt_pk_bf16_f32 v136, v136, v137
    v_cvt_pk_bf16_f32 v137, v138, v139
    ds_write_b64 v6, v[136:137] offset:448
    v_accvgpr_read_b32 v140, a240
    v_accvgpr_read_b32 v141, a241
    v_accvgpr_read_b32 v142, a242
    v_accvgpr_read_b32 v143, a243
    v_mul_f32 v140, v140, v12
    v_mul_f32 v141, v141, v12
    v_mul_f32 v142, v142, v12
    v_mul_f32 v143, v143, v12
    v_cvt_pk_bf16_f32 v140, v140, v141
    v_cvt_pk_bf16_f32 v141, v142, v143
    ds_write_b64 v6, v[140:141] offset:480
    ds_read_b128 v[192:195], v7 offset:384
    ds_read_b128 v[196:199], v7 offset:4608
    v_accvgpr_read_b32 v144, a196
    v_accvgpr_read_b32 v145, a197
    v_accvgpr_read_b32 v146, a198
    v_accvgpr_read_b32 v147, a199
    v_mul_f32 v144, v144, v13
    v_mul_f32 v145, v145, v13
    v_mul_f32 v146, v146, v13
    v_mul_f32 v147, v147, v13
    v_cvt_pk_bf16_f32 v144, v144, v145
    v_cvt_pk_bf16_f32 v145, v146, v147
    s_waitcnt lgkmcnt(8)
    ds_write_b64 v6, v[144:145] offset:8832
    v_accvgpr_read_b32 v148, a212
    v_accvgpr_read_b32 v149, a213
    v_accvgpr_read_b32 v150, a214
    v_accvgpr_read_b32 v151, a215
    v_mul_f32 v148, v148, v13
    v_mul_f32 v149, v149, v13
    v_mul_f32 v150, v150, v13
    v_mul_f32 v151, v151, v13
    v_cvt_pk_bf16_f32 v148, v148, v149
    v_cvt_pk_bf16_f32 v149, v150, v151
    ds_write_b64 v6, v[148:149] offset:8864
    s_waitcnt lgkmcnt(3)
    buffer_store_dwordx4 v[192:195], v8, s[16:19], s88 offen offset:384 sc1
    s_waitcnt lgkmcnt(2)
    buffer_store_dwordx4 v[196:199], v8, s[16:19], s89 offen offset:384 sc1
    v_accvgpr_read_b32 v152, a228
    v_accvgpr_read_b32 v153, a229
    v_accvgpr_read_b32 v154, a230
    v_accvgpr_read_b32 v155, a231
    v_mul_f32 v152, v152, v13
    v_mul_f32 v153, v153, v13
    v_mul_f32 v154, v154, v13
    v_mul_f32 v155, v155, v13
    v_cvt_pk_bf16_f32 v152, v152, v153
    v_cvt_pk_bf16_f32 v153, v154, v155
    ds_write_b64 v6, v[152:153] offset:8896
    v_accvgpr_read_b32 v156, a244
    v_accvgpr_read_b32 v157, a245
    v_accvgpr_read_b32 v158, a246
    v_accvgpr_read_b32 v159, a247
    v_mul_f32 v156, v156, v13
    v_mul_f32 v157, v157, v13
    v_mul_f32 v158, v158, v13
    v_mul_f32 v159, v159, v13
    v_cvt_pk_bf16_f32 v156, v156, v157
    v_cvt_pk_bf16_f32 v157, v158, v159
    ds_write_b64 v6, v[156:157] offset:8928
    ds_read_b128 v[200:203], v7 offset:8832
    ds_read_b128 v[204:207], v7 offset:13056
    v_accvgpr_read_b32 v160, a200
    v_accvgpr_read_b32 v161, a201
    v_accvgpr_read_b32 v162, a202
    v_accvgpr_read_b32 v163, a203
    v_mul_f32 v160, v160, v14
    v_mul_f32 v161, v161, v14
    v_mul_f32 v162, v162, v14
    v_mul_f32 v163, v163, v14
    v_cvt_pk_bf16_f32 v160, v160, v161
    v_cvt_pk_bf16_f32 v161, v162, v163
    ds_write_b64 v6, v[160:161] offset:17280
    v_accvgpr_read_b32 v164, a216
    v_accvgpr_read_b32 v165, a217
    v_accvgpr_read_b32 v166, a218
    v_accvgpr_read_b32 v167, a219
    v_mul_f32 v164, v164, v14
    v_mul_f32 v165, v165, v14
    v_mul_f32 v166, v166, v14
    v_mul_f32 v167, v167, v14
    v_cvt_pk_bf16_f32 v164, v164, v165
    v_cvt_pk_bf16_f32 v165, v166, v167
    s_waitcnt lgkmcnt(8)
    ds_write_b64 v6, v[164:165] offset:17312
    s_waitcnt lgkmcnt(3)
    buffer_store_dwordx4 v[200:203], v8, s[16:19], s90 offen offset:384 sc1
    s_waitcnt lgkmcnt(2)
    buffer_store_dwordx4 v[204:207], v8, s[16:19], s91 offen offset:384 sc1
    v_accvgpr_read_b32 v168, a232
    v_accvgpr_read_b32 v169, a233
    v_accvgpr_read_b32 v170, a234
    v_accvgpr_read_b32 v171, a235
    v_mul_f32 v168, v168, v14
    v_mul_f32 v169, v169, v14
    v_mul_f32 v170, v170, v14
    v_mul_f32 v171, v171, v14
    v_cvt_pk_bf16_f32 v168, v168, v169
    v_cvt_pk_bf16_f32 v169, v170, v171
    ds_write_b64 v6, v[168:169] offset:17344
    v_accvgpr_read_b32 v172, a248
    v_accvgpr_read_b32 v173, a249
    v_accvgpr_read_b32 v174, a250
    v_accvgpr_read_b32 v175, a251
    v_mul_f32 v172, v172, v14
    v_mul_f32 v173, v173, v14
    v_mul_f32 v174, v174, v14
    v_mul_f32 v175, v175, v14
    v_cvt_pk_bf16_f32 v172, v172, v173
    v_cvt_pk_bf16_f32 v173, v174, v175
    ds_write_b64 v6, v[172:173] offset:17376
    ds_read_b128 v[208:211], v7 offset:17280
    ds_read_b128 v[212:215], v7 offset:21504
    v_accvgpr_read_b32 v176, a204
    v_accvgpr_read_b32 v177, a205
    v_accvgpr_read_b32 v178, a206
    v_accvgpr_read_b32 v179, a207
    v_mul_f32 v176, v176, v15
    v_mul_f32 v177, v177, v15
    v_mul_f32 v178, v178, v15
    v_mul_f32 v179, v179, v15
    v_cvt_pk_bf16_f32 v176, v176, v177
    v_cvt_pk_bf16_f32 v177, v178, v179
    ds_write_b64 v6, v[176:177] offset:25728
    v_accvgpr_read_b32 v180, a220
    v_accvgpr_read_b32 v181, a221
    v_accvgpr_read_b32 v182, a222
    v_accvgpr_read_b32 v183, a223
    v_mul_f32 v180, v180, v15
    v_mul_f32 v181, v181, v15
    v_mul_f32 v182, v182, v15
    v_mul_f32 v183, v183, v15
    v_cvt_pk_bf16_f32 v180, v180, v181
    v_cvt_pk_bf16_f32 v181, v182, v183
    ds_write_b64 v6, v[180:181] offset:25760
    s_waitcnt lgkmcnt(3)
    buffer_store_dwordx4 v[208:211], v8, s[16:19], s92 offen offset:384 sc1
    s_waitcnt lgkmcnt(2)
    buffer_store_dwordx4 v[212:215], v8, s[16:19], s93 offen offset:384 sc1
    v_accvgpr_read_b32 v184, a236
    v_accvgpr_read_b32 v185, a237
    v_accvgpr_read_b32 v186, a238
    v_accvgpr_read_b32 v187, a239
    v_mul_f32 v184, v184, v15
    v_mul_f32 v185, v185, v15
    v_mul_f32 v186, v186, v15
    v_mul_f32 v187, v187, v15
    v_cvt_pk_bf16_f32 v184, v184, v185
    v_cvt_pk_bf16_f32 v185, v186, v187
    s_waitcnt lgkmcnt(8)
    ds_write_b64 v6, v[184:185] offset:25792
    v_accvgpr_read_b32 v188, a252
    v_accvgpr_read_b32 v189, a253
    v_accvgpr_read_b32 v190, a254
    v_accvgpr_read_b32 v191, a255
    v_mul_f32 v188, v188, v15
    v_mul_f32 v189, v189, v15
    v_mul_f32 v190, v190, v15
    v_mul_f32 v191, v191, v15
    v_cvt_pk_bf16_f32 v188, v188, v189
    v_cvt_pk_bf16_f32 v189, v190, v191
    ds_write_b64 v6, v[188:189] offset:25824
    ds_read_b128 v[216:219], v7 offset:25728
    ds_read_b128 v[220:223], v7 offset:29952
    s_waitcnt lgkmcnt(1)
    buffer_store_dwordx4 v[216:219], v8, s[16:19], s94 offen offset:384 sc1
    s_waitcnt lgkmcnt(0)
    buffer_store_dwordx4 v[220:223], v8, s[16:19], s95 offen offset:384 sc1
    s_endpgm
L_slow0:
    s_nop 15
    v_max3_f32 v21, v96, v97, v98
    v_max3_f32 v21, v21, v99, v100
    v_max3_f32 v21, v21, v101, v102
    v_max3_f32 v21, v21, v103, 0
    v_mov_b32 v22, v21
    s_nop 1
    v_permlane16_swap_b32 v21, v22
    v_max_f32 v21, v21, v22
    v_mov_b32 v22, v21
    s_nop 1
    v_permlane32_swap_b32 v21, v22
    v_max_f32 v21, v21, v22
    v_ceil_f32 v21, v21
    v_add_f32 v16, v16, v21
    v_sub_f32 v96, v96, v21
    v_sub_f32 v97, v97, v21
    v_sub_f32 v98, v98, v21
    v_sub_f32 v99, v99, v21
    v_sub_f32 v100, v100, v21
    v_sub_f32 v101, v101, v21
    v_sub_f32 v102, v102, v21
    v_sub_f32 v103, v103, v21
    v_min_f32 v22, 0x43800000, v21
    v_cvt_i32_f32 v22, v22
    v_sub_u32 v22, 0, v22
    v_ldexp_f32 v23, 1.0, v22
    v_mul_f32 v12, v12, v23
    v_lshlrev_b32 v24, 16, v64
    v_and_b32 v25, 0xffff0000, v64
    v_mul_f32 v24, v24, v23
    v_mul_f32 v25, v25, v23
    v_cvt_pk_bf16_f32 v64, v24, v25
    v_lshlrev_b32 v24, 16, v65
    v_and_b32 v25, 0xffff0000, v65
    v_mul_f32 v24, v24, v23
    v_mul_f32 v25, v25, v23
    v_cvt_pk_bf16_f32 v65, v24, v25
    v_lshlrev_b32 v24, 16, v66
    v_and_b32 v25, 0xffff0000, v66
    v_mul_f32 v24, v24, v23
    v_mul_f32 v25, v25, v23
    v_cvt_pk_bf16_f32 v66, v24, v25
    v_lshlrev_b32 v24, 16, v67
    v_and_b32 v25, 0xffff0000, v67
    v_mul_f32 v24, v24, v23
    v_mul_f32 v25, v25, v23
    v_cvt_pk_bf16_f32 v67, v24, v25
    v_accvgpr_read_b32 v25, a0
    v_accvgpr_read_b32 v26, a1
    v_accvgpr_read_b32 v27, a2
    v_accvgpr_read_b32 v28, a3
    v_mul_f32 v25, v25, v23
    v_mul_f32 v26, v26, v23
    v_mul_f32 v27, v27, v23
    v_mul_f32 v28, v28, v23
    v_accvgpr_write_b32 a0, v25
    v_accvgpr_write_b32 a1, v26
    v_accvgpr_write_b32 a2, v27
    v_accvgpr_write_b32 a3, v28
    v_accvgpr_read_b32 v25, a16
    v_accvgpr_read_b32 v26, a17
    v_accvgpr_read_b32 v27, a18
    v_accvgpr_read_b32 v28, a19
    v_mul_f32 v25, v25, v23
    v_mul_f32 v26, v26, v23
    v_mul_f32 v27, v27, v23
    v_mul_f32 v28, v28, v23
    v_accvgpr_write_b32 a16, v25
    v_accvgpr_write_b32 a17, v26
    v_accvgpr_write_b32 a18, v27
    v_accvgpr_write_b32 a19, v28
    v_accvgpr_read_b32 v25, a32
    v_accvgpr_read_b32 v26, a33
    v_accvgpr_read_b32 v27, a34
    v_accvgpr_read_b32 v28, a35
    v_mul_f32 v25, v25, v23
    v_mul_f32 v26, v26, v23
    v_mul_f32 v27, v27, v23
    v_mul_f32 v28, v28, v23
    v_accvgpr_write_b32 a32, v25
    v_accvgpr_write_b32 a33, v26
    v_accvgpr_write_b32 a34, v27
    v_accvgpr_write_b32 a35, v28
    v_accvgpr_read_b32 v25, a48
    v_accvgpr_read_b32 v26, a49
    v_accvgpr_read_b32 v27, a50
    v_accvgpr_read_b32 v28, a51
    v_mul_f32 v25, v25, v23
    v_mul_f32 v26, v26, v23
    v_mul_f32 v27, v27, v23
    v_mul_f32 v28, v28, v23
    v_accvgpr_write_b32 a48, v25
    v_accvgpr_write_b32 a49, v26
    v_accvgpr_write_b32 a50, v27
    v_accvgpr_write_b32 a51, v28
    v_accvgpr_read_b32 v25, a64
    v_accvgpr_read_b32 v26, a65
    v_accvgpr_read_b32 v27, a66
    v_accvgpr_read_b32 v28, a67
    v_mul_f32 v25, v25, v23
    v_mul_f32 v26, v26, v23
    v_mul_f32 v27, v27, v23
    v_mul_f32 v28, v28, v23
    v_accvgpr_write_b32 a64, v25
    v_accvgpr_write_b32 a65, v26
    v_accvgpr_write_b32 a66, v27
    v_accvgpr_write_b32 a67, v28
    v_accvgpr_read_b32 v25, a80
    v_accvgpr_read_b32 v26, a81
    v_accvgpr_read_b32 v27, a82
    v_accvgpr_read_b32 v28, a83
    v_mul_f32 v25, v25, v23
    v_mul_f32 v26, v26, v23
    v_mul_f32 v27, v27, v23
    v_mul_f32 v28, v28, v23
    v_accvgpr_write_b32 a80, v25
    v_accvgpr_write_b32 a81, v26
    v_accvgpr_write_b32 a82, v27
    v_accvgpr_write_b32 a83, v28
    v_accvgpr_read_b32 v25, a96
    v_accvgpr_read_b32 v26, a97
    v_accvgpr_read_b32 v27, a98
    v_accvgpr_read_b32 v28, a99
    v_mul_f32 v25, v25, v23
    v_mul_f32 v26, v26, v23
    v_mul_f32 v27, v27, v23
    v_mul_f32 v28, v28, v23
    v_accvgpr_write_b32 a96, v25
    v_accvgpr_write_b32 a97, v26
    v_accvgpr_write_b32 a98, v27
    v_accvgpr_write_b32 a99, v28
    v_accvgpr_read_b32 v25, a112
    v_accvgpr_read_b32 v26, a113
    v_accvgpr_read_b32 v27, a114
    v_accvgpr_read_b32 v28, a115
    v_mul_f32 v25, v25, v23
    v_mul_f32 v26, v26, v23
    v_mul_f32 v27, v27, v23
    v_mul_f32 v28, v28, v23
    v_accvgpr_write_b32 a112, v25
    v_accvgpr_write_b32 a113, v26
    v_accvgpr_write_b32 a114, v27
    v_accvgpr_write_b32 a115, v28
    v_accvgpr_read_b32 v25, a128
    v_accvgpr_read_b32 v26, a129
    v_accvgpr_read_b32 v27, a130
    v_accvgpr_read_b32 v28, a131
    v_mul_f32 v25, v25, v23
    v_mul_f32 v26, v26, v23
    v_mul_f32 v27, v27, v23
    v_mul_f32 v28, v28, v23
    v_accvgpr_write_b32 a128, v25
    v_accvgpr_write_b32 a129, v26
    v_accvgpr_write_b32 a130, v27
    v_accvgpr_write_b32 a131, v28
    v_accvgpr_read_b32 v25, a144
    v_accvgpr_read_b32 v26, a145
    v_accvgpr_read_b32 v27, a146
    v_accvgpr_read_b32 v28, a147
    v_mul_f32 v25, v25, v23
    v_mul_f32 v26, v26, v23
    v_mul_f32 v27, v27, v23
    v_mul_f32 v28, v28, v23
    v_accvgpr_write_b32 a144, v25
    v_accvgpr_write_b32 a145, v26
    v_accvgpr_write_b32 a146, v27
    v_accvgpr_write_b32 a147, v28
    v_accvgpr_read_b32 v25, a160
    v_accvgpr_read_b32 v26, a161
    v_accvgpr_read_b32 v27, a162
    v_accvgpr_read_b32 v28, a163
    v_mul_f32 v25, v25, v23
    v_mul_f32 v26, v26, v23
    v_mul_f32 v27, v27, v23
    v_mul_f32 v28, v28, v23
    v_accvgpr_write_b32 a160, v25
    v_accvgpr_write_b32 a161, v26
    v_accvgpr_write_b32 a162, v27
    v_accvgpr_write_b32 a163, v28
    v_accvgpr_read_b32 v25, a176
    v_accvgpr_read_b32 v26, a177
    v_accvgpr_read_b32 v27, a178
    v_accvgpr_read_b32 v28, a179
    v_mul_f32 v25, v25, v23
    v_mul_f32 v26, v26, v23
    v_mul_f32 v27, v27, v23
    v_mul_f32 v28, v28, v23
    v_accvgpr_write_b32 a176, v25
    v_accvgpr_write_b32 a177, v26
    v_accvgpr_write_b32 a178, v27
    v_accvgpr_write_b32 a179, v28
    v_accvgpr_read_b32 v25, a192
    v_accvgpr_read_b32 v26, a193
    v_accvgpr_read_b32 v27, a194
    v_accvgpr_read_b32 v28, a195
    v_mul_f32 v25, v25, v23
    v_mul_f32 v26, v26, v23
    v_mul_f32 v27, v27, v23
    v_mul_f32 v28, v28, v23
    v_accvgpr_write_b32 a192, v25
    v_accvgpr_write_b32 a193, v26
    v_accvgpr_write_b32 a194, v27
    v_accvgpr_write_b32 a195, v28
    v_accvgpr_read_b32 v25, a208
    v_accvgpr_read_b32 v26, a209
    v_accvgpr_read_b32 v27, a210
    v_accvgpr_read_b32 v28, a211
    v_mul_f32 v25, v25, v23
    v_mul_f32 v26, v26, v23
    v_mul_f32 v27, v27, v23
    v_mul_f32 v28, v28, v23
    v_accvgpr_write_b32 a208, v25
    v_accvgpr_write_b32 a209, v26
    v_accvgpr_write_b32 a210, v27
    v_accvgpr_write_b32 a211, v28
    v_accvgpr_read_b32 v25, a224
    v_accvgpr_read_b32 v26, a225
    v_accvgpr_read_b32 v27, a226
    v_accvgpr_read_b32 v28, a227
    v_mul_f32 v25, v25, v23
    v_mul_f32 v26, v26, v23
    v_mul_f32 v27, v27, v23
    v_mul_f32 v28, v28, v23
    v_accvgpr_write_b32 a224, v25
    v_accvgpr_write_b32 a225, v26
    v_accvgpr_write_b32 a226, v27
    v_accvgpr_write_b32 a227, v28
    v_accvgpr_read_b32 v25, a240
    v_accvgpr_read_b32 v26, a241
    v_accvgpr_read_b32 v27, a242
    v_accvgpr_read_b32 v28, a243
    v_mul_f32 v25, v25, v23
    v_mul_f32 v26, v26, v23
    v_mul_f32 v27, v27, v23
    v_mul_f32 v28, v28, v23
    v_accvgpr_write_b32 a240, v25
    v_accvgpr_write_b32 a241, v26
    v_accvgpr_write_b32 a242, v27
    v_accvgpr_write_b32 a243, v28
    v_max3_f32 v21, v104, v105, v106
    v_max3_f32 v21, v21, v107, v108
    v_max3_f32 v21, v21, v109, v110
    v_max3_f32 v21, v21, v111, 0
    v_mov_b32 v22, v21
    s_nop 1
    v_permlane16_swap_b32 v21, v22
    v_max_f32 v21, v21, v22
    v_mov_b32 v22, v21
    s_nop 1
    v_permlane32_swap_b32 v21, v22
    v_max_f32 v21, v21, v22
    v_ceil_f32 v21, v21
    v_add_f32 v17, v17, v21
    v_sub_f32 v104, v104, v21
    v_sub_f32 v105, v105, v21
    v_sub_f32 v106, v106, v21
    v_sub_f32 v107, v107, v21
    v_sub_f32 v108, v108, v21
    v_sub_f32 v109, v109, v21
    v_sub_f32 v110, v110, v21
    v_sub_f32 v111, v111, v21
    v_min_f32 v22, 0x43800000, v21
    v_cvt_i32_f32 v22, v22
    v_sub_u32 v22, 0, v22
    v_ldexp_f32 v23, 1.0, v22
    v_mul_f32 v13, v13, v23
    v_lshlrev_b32 v24, 16, v72
    v_and_b32 v25, 0xffff0000, v72
    v_mul_f32 v24, v24, v23
    v_mul_f32 v25, v25, v23
    v_cvt_pk_bf16_f32 v72, v24, v25
    v_lshlrev_b32 v24, 16, v73
    v_and_b32 v25, 0xffff0000, v73
    v_mul_f32 v24, v24, v23
    v_mul_f32 v25, v25, v23
    v_cvt_pk_bf16_f32 v73, v24, v25
    v_lshlrev_b32 v24, 16, v74
    v_and_b32 v25, 0xffff0000, v74
    v_mul_f32 v24, v24, v23
    v_mul_f32 v25, v25, v23
    v_cvt_pk_bf16_f32 v74, v24, v25
    v_lshlrev_b32 v24, 16, v75
    v_and_b32 v25, 0xffff0000, v75
    v_mul_f32 v24, v24, v23
    v_mul_f32 v25, v25, v23
    v_cvt_pk_bf16_f32 v75, v24, v25
    v_accvgpr_read_b32 v25, a4
    v_accvgpr_read_b32 v26, a5
    v_accvgpr_read_b32 v27, a6
    v_accvgpr_read_b32 v28, a7
    v_mul_f32 v25, v25, v23
    v_mul_f32 v26, v26, v23
    v_mul_f32 v27, v27, v23
    v_mul_f32 v28, v28, v23
    v_accvgpr_write_b32 a4, v25
    v_accvgpr_write_b32 a5, v26
    v_accvgpr_write_b32 a6, v27
    v_accvgpr_write_b32 a7, v28
    v_accvgpr_read_b32 v25, a20
    v_accvgpr_read_b32 v26, a21
    v_accvgpr_read_b32 v27, a22
    v_accvgpr_read_b32 v28, a23
    v_mul_f32 v25, v25, v23
    v_mul_f32 v26, v26, v23
    v_mul_f32 v27, v27, v23
    v_mul_f32 v28, v28, v23
    v_accvgpr_write_b32 a20, v25
    v_accvgpr_write_b32 a21, v26
    v_accvgpr_write_b32 a22, v27
    v_accvgpr_write_b32 a23, v28
    v_accvgpr_read_b32 v25, a36
    v_accvgpr_read_b32 v26, a37
    v_accvgpr_read_b32 v27, a38
    v_accvgpr_read_b32 v28, a39
    v_mul_f32 v25, v25, v23
    v_mul_f32 v26, v26, v23
    v_mul_f32 v27, v27, v23
    v_mul_f32 v28, v28, v23
    v_accvgpr_write_b32 a36, v25
    v_accvgpr_write_b32 a37, v26
    v_accvgpr_write_b32 a38, v27
    v_accvgpr_write_b32 a39, v28
    v_accvgpr_read_b32 v25, a52
    v_accvgpr_read_b32 v26, a53
    v_accvgpr_read_b32 v27, a54
    v_accvgpr_read_b32 v28, a55
    v_mul_f32 v25, v25, v23
    v_mul_f32 v26, v26, v23
    v_mul_f32 v27, v27, v23
    v_mul_f32 v28, v28, v23
    v_accvgpr_write_b32 a52, v25
    v_accvgpr_write_b32 a53, v26
    v_accvgpr_write_b32 a54, v27
    v_accvgpr_write_b32 a55, v28
    v_accvgpr_read_b32 v25, a68
    v_accvgpr_read_b32 v26, a69
    v_accvgpr_read_b32 v27, a70
    v_accvgpr_read_b32 v28, a71
    v_mul_f32 v25, v25, v23
    v_mul_f32 v26, v26, v23
    v_mul_f32 v27, v27, v23
    v_mul_f32 v28, v28, v23
    v_accvgpr_write_b32 a68, v25
    v_accvgpr_write_b32 a69, v26
    v_accvgpr_write_b32 a70, v27
    v_accvgpr_write_b32 a71, v28
    v_accvgpr_read_b32 v25, a84
    v_accvgpr_read_b32 v26, a85
    v_accvgpr_read_b32 v27, a86
    v_accvgpr_read_b32 v28, a87
    v_mul_f32 v25, v25, v23
    v_mul_f32 v26, v26, v23
    v_mul_f32 v27, v27, v23
    v_mul_f32 v28, v28, v23
    v_accvgpr_write_b32 a84, v25
    v_accvgpr_write_b32 a85, v26
    v_accvgpr_write_b32 a86, v27
    v_accvgpr_write_b32 a87, v28
    v_accvgpr_read_b32 v25, a100
    v_accvgpr_read_b32 v26, a101
    v_accvgpr_read_b32 v27, a102
    v_accvgpr_read_b32 v28, a103
    v_mul_f32 v25, v25, v23
    v_mul_f32 v26, v26, v23
    v_mul_f32 v27, v27, v23
    v_mul_f32 v28, v28, v23
    v_accvgpr_write_b32 a100, v25
    v_accvgpr_write_b32 a101, v26
    v_accvgpr_write_b32 a102, v27
    v_accvgpr_write_b32 a103, v28
    v_accvgpr_read_b32 v25, a116
    v_accvgpr_read_b32 v26, a117
    v_accvgpr_read_b32 v27, a118
    v_accvgpr_read_b32 v28, a119
    v_mul_f32 v25, v25, v23
    v_mul_f32 v26, v26, v23
    v_mul_f32 v27, v27, v23
    v_mul_f32 v28, v28, v23
    v_accvgpr_write_b32 a116, v25
    v_accvgpr_write_b32 a117, v26
    v_accvgpr_write_b32 a118, v27
    v_accvgpr_write_b32 a119, v28
    v_accvgpr_read_b32 v25, a132
    v_accvgpr_read_b32 v26, a133
    v_accvgpr_read_b32 v27, a134
    v_accvgpr_read_b32 v28, a135
    v_mul_f32 v25, v25, v23
    v_mul_f32 v26, v26, v23
    v_mul_f32 v27, v27, v23
    v_mul_f32 v28, v28, v23
    v_accvgpr_write_b32 a132, v25
    v_accvgpr_write_b32 a133, v26
    v_accvgpr_write_b32 a134, v27
    v_accvgpr_write_b32 a135, v28
    v_accvgpr_read_b32 v25, a148
    v_accvgpr_read_b32 v26, a149
    v_accvgpr_read_b32 v27, a150
    v_accvgpr_read_b32 v28, a151
    v_mul_f32 v25, v25, v23
    v_mul_f32 v26, v26, v23
    v_mul_f32 v27, v27, v23
    v_mul_f32 v28, v28, v23
    v_accvgpr_write_b32 a148, v25
    v_accvgpr_write_b32 a149, v26
    v_accvgpr_write_b32 a150, v27
    v_accvgpr_write_b32 a151, v28
    v_accvgpr_read_b32 v25, a164
    v_accvgpr_read_b32 v26, a165
    v_accvgpr_read_b32 v27, a166
    v_accvgpr_read_b32 v28, a167
    v_mul_f32 v25, v25, v23
    v_mul_f32 v26, v26, v23
    v_mul_f32 v27, v27, v23
    v_mul_f32 v28, v28, v23
    v_accvgpr_write_b32 a164, v25
    v_accvgpr_write_b32 a165, v26
    v_accvgpr_write_b32 a166, v27
    v_accvgpr_write_b32 a167, v28
    v_accvgpr_read_b32 v25, a180
    v_accvgpr_read_b32 v26, a181
    v_accvgpr_read_b32 v27, a182
    v_accvgpr_read_b32 v28, a183
    v_mul_f32 v25, v25, v23
    v_mul_f32 v26, v26, v23
    v_mul_f32 v27, v27, v23
    v_mul_f32 v28, v28, v23
    v_accvgpr_write_b32 a180, v25
    v_accvgpr_write_b32 a181, v26
    v_accvgpr_write_b32 a182, v27
    v_accvgpr_write_b32 a183, v28
    v_accvgpr_read_b32 v25, a196
    v_accvgpr_read_b32 v26, a197
    v_accvgpr_read_b32 v27, a198
    v_accvgpr_read_b32 v28, a199
    v_mul_f32 v25, v25, v23
    v_mul_f32 v26, v26, v23
    v_mul_f32 v27, v27, v23
    v_mul_f32 v28, v28, v23
    v_accvgpr_write_b32 a196, v25
    v_accvgpr_write_b32 a197, v26
    v_accvgpr_write_b32 a198, v27
    v_accvgpr_write_b32 a199, v28
    v_accvgpr_read_b32 v25, a212
    v_accvgpr_read_b32 v26, a213
    v_accvgpr_read_b32 v27, a214
    v_accvgpr_read_b32 v28, a215
    v_mul_f32 v25, v25, v23
    v_mul_f32 v26, v26, v23
    v_mul_f32 v27, v27, v23
    v_mul_f32 v28, v28, v23
    v_accvgpr_write_b32 a212, v25
    v_accvgpr_write_b32 a213, v26
    v_accvgpr_write_b32 a214, v27
    v_accvgpr_write_b32 a215, v28
    v_accvgpr_read_b32 v25, a228
    v_accvgpr_read_b32 v26, a229
    v_accvgpr_read_b32 v27, a230
    v_accvgpr_read_b32 v28, a231
    v_mul_f32 v25, v25, v23
    v_mul_f32 v26, v26, v23
    v_mul_f32 v27, v27, v23
    v_mul_f32 v28, v28, v23
    v_accvgpr_write_b32 a228, v25
    v_accvgpr_write_b32 a229, v26
    v_accvgpr_write_b32 a230, v27
    v_accvgpr_write_b32 a231, v28
    v_accvgpr_read_b32 v25, a244
    v_accvgpr_read_b32 v26, a245
    v_accvgpr_read_b32 v27, a246
    v_accvgpr_read_b32 v28, a247
    v_mul_f32 v25, v25, v23
    v_mul_f32 v26, v26, v23
    v_mul_f32 v27, v27, v23
    v_mul_f32 v28, v28, v23
    v_accvgpr_write_b32 a244, v25
    v_accvgpr_write_b32 a245, v26
    v_accvgpr_write_b32 a246, v27
    v_accvgpr_write_b32 a247, v28
    v_max3_f32 v21, v112, v113, v114
    v_max3_f32 v21, v21, v115, v116
    v_max3_f32 v21, v21, v117, v118
    v_max3_f32 v21, v21, v119, 0
    v_mov_b32 v22, v21
    s_nop 1
    v_permlane16_swap_b32 v21, v22
    v_max_f32 v21, v21, v22
    v_mov_b32 v22, v21
    s_nop 1
    v_permlane32_swap_b32 v21, v22
    v_max_f32 v21, v21, v22
    v_ceil_f32 v21, v21
    v_add_f32 v18, v18, v21
    v_sub_f32 v112, v112, v21
    v_sub_f32 v113, v113, v21
    v_sub_f32 v114, v114, v21
    v_sub_f32 v115, v115, v21
    v_sub_f32 v116, v116, v21
    v_sub_f32 v117, v117, v21
    v_sub_f32 v118, v118, v21
    v_sub_f32 v119, v119, v21
    v_min_f32 v22, 0x43800000, v21
    v_cvt_i32_f32 v22, v22
    v_sub_u32 v22, 0, v22
    v_ldexp_f32 v23, 1.0, v22
    v_mul_f32 v14, v14, v23
    v_lshlrev_b32 v24, 16, v80
    v_and_b32 v25, 0xffff0000, v80
    v_mul_f32 v24, v24, v23
    v_mul_f32 v25, v25, v23
    v_cvt_pk_bf16_f32 v80, v24, v25
    v_lshlrev_b32 v24, 16, v81
    v_and_b32 v25, 0xffff0000, v81
    v_mul_f32 v24, v24, v23
    v_mul_f32 v25, v25, v23
    v_cvt_pk_bf16_f32 v81, v24, v25
    v_lshlrev_b32 v24, 16, v82
    v_and_b32 v25, 0xffff0000, v82
    v_mul_f32 v24, v24, v23
    v_mul_f32 v25, v25, v23
    v_cvt_pk_bf16_f32 v82, v24, v25
    v_lshlrev_b32 v24, 16, v83
    v_and_b32 v25, 0xffff0000, v83
    v_mul_f32 v24, v24, v23
    v_mul_f32 v25, v25, v23
    v_cvt_pk_bf16_f32 v83, v24, v25
    v_accvgpr_read_b32 v25, a8
    v_accvgpr_read_b32 v26, a9
    v_accvgpr_read_b32 v27, a10
    v_accvgpr_read_b32 v28, a11
    v_mul_f32 v25, v25, v23
    v_mul_f32 v26, v26, v23
    v_mul_f32 v27, v27, v23
    v_mul_f32 v28, v28, v23
    v_accvgpr_write_b32 a8, v25
    v_accvgpr_write_b32 a9, v26
    v_accvgpr_write_b32 a10, v27
    v_accvgpr_write_b32 a11, v28
    v_accvgpr_read_b32 v25, a24
    v_accvgpr_read_b32 v26, a25
    v_accvgpr_read_b32 v27, a26
    v_accvgpr_read_b32 v28, a27
    v_mul_f32 v25, v25, v23
    v_mul_f32 v26, v26, v23
    v_mul_f32 v27, v27, v23
    v_mul_f32 v28, v28, v23
    v_accvgpr_write_b32 a24, v25
    v_accvgpr_write_b32 a25, v26
    v_accvgpr_write_b32 a26, v27
    v_accvgpr_write_b32 a27, v28
    v_accvgpr_read_b32 v25, a40
    v_accvgpr_read_b32 v26, a41
    v_accvgpr_read_b32 v27, a42
    v_accvgpr_read_b32 v28, a43
    v_mul_f32 v25, v25, v23
    v_mul_f32 v26, v26, v23
    v_mul_f32 v27, v27, v23
    v_mul_f32 v28, v28, v23
    v_accvgpr_write_b32 a40, v25
    v_accvgpr_write_b32 a41, v26
    v_accvgpr_write_b32 a42, v27
    v_accvgpr_write_b32 a43, v28
    v_accvgpr_read_b32 v25, a56
    v_accvgpr_read_b32 v26, a57
    v_accvgpr_read_b32 v27, a58
    v_accvgpr_read_b32 v28, a59
    v_mul_f32 v25, v25, v23
    v_mul_f32 v26, v26, v23
    v_mul_f32 v27, v27, v23
    v_mul_f32 v28, v28, v23
    v_accvgpr_write_b32 a56, v25
    v_accvgpr_write_b32 a57, v26
    v_accvgpr_write_b32 a58, v27
    v_accvgpr_write_b32 a59, v28
    v_accvgpr_read_b32 v25, a72
    v_accvgpr_read_b32 v26, a73
    v_accvgpr_read_b32 v27, a74
    v_accvgpr_read_b32 v28, a75
    v_mul_f32 v25, v25, v23
    v_mul_f32 v26, v26, v23
    v_mul_f32 v27, v27, v23
    v_mul_f32 v28, v28, v23
    v_accvgpr_write_b32 a72, v25
    v_accvgpr_write_b32 a73, v26
    v_accvgpr_write_b32 a74, v27
    v_accvgpr_write_b32 a75, v28
    v_accvgpr_read_b32 v25, a88
    v_accvgpr_read_b32 v26, a89
    v_accvgpr_read_b32 v27, a90
    v_accvgpr_read_b32 v28, a91
    v_mul_f32 v25, v25, v23
    v_mul_f32 v26, v26, v23
    v_mul_f32 v27, v27, v23
    v_mul_f32 v28, v28, v23
    v_accvgpr_write_b32 a88, v25
    v_accvgpr_write_b32 a89, v26
    v_accvgpr_write_b32 a90, v27
    v_accvgpr_write_b32 a91, v28
    v_accvgpr_read_b32 v25, a104
    v_accvgpr_read_b32 v26, a105
    v_accvgpr_read_b32 v27, a106
    v_accvgpr_read_b32 v28, a107
    v_mul_f32 v25, v25, v23
    v_mul_f32 v26, v26, v23
    v_mul_f32 v27, v27, v23
    v_mul_f32 v28, v28, v23
    v_accvgpr_write_b32 a104, v25
    v_accvgpr_write_b32 a105, v26
    v_accvgpr_write_b32 a106, v27
    v_accvgpr_write_b32 a107, v28
    v_accvgpr_read_b32 v25, a120
    v_accvgpr_read_b32 v26, a121
    v_accvgpr_read_b32 v27, a122
    v_accvgpr_read_b32 v28, a123
    v_mul_f32 v25, v25, v23
    v_mul_f32 v26, v26, v23
    v_mul_f32 v27, v27, v23
    v_mul_f32 v28, v28, v23
    v_accvgpr_write_b32 a120, v25
    v_accvgpr_write_b32 a121, v26
    v_accvgpr_write_b32 a122, v27
    v_accvgpr_write_b32 a123, v28
    v_accvgpr_read_b32 v25, a136
    v_accvgpr_read_b32 v26, a137
    v_accvgpr_read_b32 v27, a138
    v_accvgpr_read_b32 v28, a139
    v_mul_f32 v25, v25, v23
    v_mul_f32 v26, v26, v23
    v_mul_f32 v27, v27, v23
    v_mul_f32 v28, v28, v23
    v_accvgpr_write_b32 a136, v25
    v_accvgpr_write_b32 a137, v26
    v_accvgpr_write_b32 a138, v27
    v_accvgpr_write_b32 a139, v28
    v_accvgpr_read_b32 v25, a152
    v_accvgpr_read_b32 v26, a153
    v_accvgpr_read_b32 v27, a154
    v_accvgpr_read_b32 v28, a155
    v_mul_f32 v25, v25, v23
    v_mul_f32 v26, v26, v23
    v_mul_f32 v27, v27, v23
    v_mul_f32 v28, v28, v23
    v_accvgpr_write_b32 a152, v25
    v_accvgpr_write_b32 a153, v26
    v_accvgpr_write_b32 a154, v27
    v_accvgpr_write_b32 a155, v28
    v_accvgpr_read_b32 v25, a168
    v_accvgpr_read_b32 v26, a169
    v_accvgpr_read_b32 v27, a170
    v_accvgpr_read_b32 v28, a171
    v_mul_f32 v25, v25, v23
    v_mul_f32 v26, v26, v23
    v_mul_f32 v27, v27, v23
    v_mul_f32 v28, v28, v23
    v_accvgpr_write_b32 a168, v25
    v_accvgpr_write_b32 a169, v26
    v_accvgpr_write_b32 a170, v27
    v_accvgpr_write_b32 a171, v28
    v_accvgpr_read_b32 v25, a184
    v_accvgpr_read_b32 v26, a185
    v_accvgpr_read_b32 v27, a186
    v_accvgpr_read_b32 v28, a187
    v_mul_f32 v25, v25, v23
    v_mul_f32 v26, v26, v23
    v_mul_f32 v27, v27, v23
    v_mul_f32 v28, v28, v23
    v_accvgpr_write_b32 a184, v25
    v_accvgpr_write_b32 a185, v26
    v_accvgpr_write_b32 a186, v27
    v_accvgpr_write_b32 a187, v28
    v_accvgpr_read_b32 v25, a200
    v_accvgpr_read_b32 v26, a201
    v_accvgpr_read_b32 v27, a202
    v_accvgpr_read_b32 v28, a203
    v_mul_f32 v25, v25, v23
    v_mul_f32 v26, v26, v23
    v_mul_f32 v27, v27, v23
    v_mul_f32 v28, v28, v23
    v_accvgpr_write_b32 a200, v25
    v_accvgpr_write_b32 a201, v26
    v_accvgpr_write_b32 a202, v27
    v_accvgpr_write_b32 a203, v28
    v_accvgpr_read_b32 v25, a216
    v_accvgpr_read_b32 v26, a217
    v_accvgpr_read_b32 v27, a218
    v_accvgpr_read_b32 v28, a219
    v_mul_f32 v25, v25, v23
    v_mul_f32 v26, v26, v23
    v_mul_f32 v27, v27, v23
    v_mul_f32 v28, v28, v23
    v_accvgpr_write_b32 a216, v25
    v_accvgpr_write_b32 a217, v26
    v_accvgpr_write_b32 a218, v27
    v_accvgpr_write_b32 a219, v28
    v_accvgpr_read_b32 v25, a232
    v_accvgpr_read_b32 v26, a233
    v_accvgpr_read_b32 v27, a234
    v_accvgpr_read_b32 v28, a235
    v_mul_f32 v25, v25, v23
    v_mul_f32 v26, v26, v23
    v_mul_f32 v27, v27, v23
    v_mul_f32 v28, v28, v23
    v_accvgpr_write_b32 a232, v25
    v_accvgpr_write_b32 a233, v26
    v_accvgpr_write_b32 a234, v27
    v_accvgpr_write_b32 a235, v28
    v_accvgpr_read_b32 v25, a248
    v_accvgpr_read_b32 v26, a249
    v_accvgpr_read_b32 v27, a250
    v_accvgpr_read_b32 v28, a251
    v_mul_f32 v25, v25, v23
    v_mul_f32 v26, v26, v23
    v_mul_f32 v27, v27, v23
    v_mul_f32 v28, v28, v23
    v_accvgpr_write_b32 a248, v25
    v_accvgpr_write_b32 a249, v26
    v_accvgpr_write_b32 a250, v27
    v_accvgpr_write_b32 a251, v28
    v_max3_f32 v21, v120, v121, v122
    v_max3_f32 v21, v21, v123, v124
    v_max3_f32 v21, v21, v125, v126
    v_max3_f32 v21, v21, v127, 0
    v_mov_b32 v22, v21
    s_nop 1
    v_permlane16_swap_b32 v21, v22
    v_max_f32 v21, v21, v22
    v_mov_b32 v22, v21
    s_nop 1
    v_permlane32_swap_b32 v21, v22
    v_max_f32 v21, v21, v22
    v_ceil_f32 v21, v21
    v_add_f32 v19, v19, v21
    v_sub_f32 v120, v120, v21
    v_sub_f32 v121, v121, v21
    v_sub_f32 v122, v122, v21
    v_sub_f32 v123, v123, v21
    v_sub_f32 v124, v124, v21
    v_sub_f32 v125, v125, v21
    v_sub_f32 v126, v126, v21
    v_sub_f32 v127, v127, v21
    v_min_f32 v22, 0x43800000, v21
    v_cvt_i32_f32 v22, v22
    v_sub_u32 v22, 0, v22
    v_ldexp_f32 v23, 1.0, v22
    v_mul_f32 v15, v15, v23
    v_lshlrev_b32 v24, 16, v88
    v_and_b32 v25, 0xffff0000, v88
    v_mul_f32 v24, v24, v23
    v_mul_f32 v25, v25, v23
    v_cvt_pk_bf16_f32 v88, v24, v25
    v_lshlrev_b32 v24, 16, v89
    v_and_b32 v25, 0xffff0000, v89
    v_mul_f32 v24, v24, v23
    v_mul_f32 v25, v25, v23
    v_cvt_pk_bf16_f32 v89, v24, v25
    v_lshlrev_b32 v24, 16, v90
    v_and_b32 v25, 0xffff0000, v90
    v_mul_f32 v24, v24, v23
    v_mul_f32 v25, v25, v23
    v_cvt_pk_bf16_f32 v90, v24, v25
    v_lshlrev_b32 v24, 16, v91
    v_and_b32 v25, 0xffff0000, v91
    v_mul_f32 v24, v24, v23
    v_mul_f32 v25, v25, v23
    v_cvt_pk_bf16_f32 v91, v24, v25
    v_accvgpr_read_b32 v25, a12
    v_accvgpr_read_b32 v26, a13
    v_accvgpr_read_b32 v27, a14
    v_accvgpr_read_b32 v28, a15
    v_mul_f32 v25, v25, v23
    v_mul_f32 v26, v26, v23
    v_mul_f32 v27, v27, v23
    v_mul_f32 v28, v28, v23
    v_accvgpr_write_b32 a12, v25
    v_accvgpr_write_b32 a13, v26
    v_accvgpr_write_b32 a14, v27
    v_accvgpr_write_b32 a15, v28
    v_accvgpr_read_b32 v25, a28
    v_accvgpr_read_b32 v26, a29
    v_accvgpr_read_b32 v27, a30
    v_accvgpr_read_b32 v28, a31
    v_mul_f32 v25, v25, v23
    v_mul_f32 v26, v26, v23
    v_mul_f32 v27, v27, v23
    v_mul_f32 v28, v28, v23
    v_accvgpr_write_b32 a28, v25
    v_accvgpr_write_b32 a29, v26
    v_accvgpr_write_b32 a30, v27
    v_accvgpr_write_b32 a31, v28
    v_accvgpr_read_b32 v25, a44
    v_accvgpr_read_b32 v26, a45
    v_accvgpr_read_b32 v27, a46
    v_accvgpr_read_b32 v28, a47
    v_mul_f32 v25, v25, v23
    v_mul_f32 v26, v26, v23
    v_mul_f32 v27, v27, v23
    v_mul_f32 v28, v28, v23
    v_accvgpr_write_b32 a44, v25
    v_accvgpr_write_b32 a45, v26
    v_accvgpr_write_b32 a46, v27
    v_accvgpr_write_b32 a47, v28
    v_accvgpr_read_b32 v25, a60
    v_accvgpr_read_b32 v26, a61
    v_accvgpr_read_b32 v27, a62
    v_accvgpr_read_b32 v28, a63
    v_mul_f32 v25, v25, v23
    v_mul_f32 v26, v26, v23
    v_mul_f32 v27, v27, v23
    v_mul_f32 v28, v28, v23
    v_accvgpr_write_b32 a60, v25
    v_accvgpr_write_b32 a61, v26
    v_accvgpr_write_b32 a62, v27
    v_accvgpr_write_b32 a63, v28
    v_accvgpr_read_b32 v25, a76
    v_accvgpr_read_b32 v26, a77
    v_accvgpr_read_b32 v27, a78
    v_accvgpr_read_b32 v28, a79
    v_mul_f32 v25, v25, v23
    v_mul_f32 v26, v26, v23
    v_mul_f32 v27, v27, v23
    v_mul_f32 v28, v28, v23
    v_accvgpr_write_b32 a76, v25
    v_accvgpr_write_b32 a77, v26
    v_accvgpr_write_b32 a78, v27
    v_accvgpr_write_b32 a79, v28
    v_accvgpr_read_b32 v25, a92
    v_accvgpr_read_b32 v26, a93
    v_accvgpr_read_b32 v27, a94
    v_accvgpr_read_b32 v28, a95
    v_mul_f32 v25, v25, v23
    v_mul_f32 v26, v26, v23
    v_mul_f32 v27, v27, v23
    v_mul_f32 v28, v28, v23
    v_accvgpr_write_b32 a92, v25
    v_accvgpr_write_b32 a93, v26
    v_accvgpr_write_b32 a94, v27
    v_accvgpr_write_b32 a95, v28
    v_accvgpr_read_b32 v25, a108
    v_accvgpr_read_b32 v26, a109
    v_accvgpr_read_b32 v27, a110
    v_accvgpr_read_b32 v28, a111
    v_mul_f32 v25, v25, v23
    v_mul_f32 v26, v26, v23
    v_mul_f32 v27, v27, v23
    v_mul_f32 v28, v28, v23
    v_accvgpr_write_b32 a108, v25
    v_accvgpr_write_b32 a109, v26
    v_accvgpr_write_b32 a110, v27
    v_accvgpr_write_b32 a111, v28
    v_accvgpr_read_b32 v25, a124
    v_accvgpr_read_b32 v26, a125
    v_accvgpr_read_b32 v27, a126
    v_accvgpr_read_b32 v28, a127
    v_mul_f32 v25, v25, v23
    v_mul_f32 v26, v26, v23
    v_mul_f32 v27, v27, v23
    v_mul_f32 v28, v28, v23
    v_accvgpr_write_b32 a124, v25
    v_accvgpr_write_b32 a125, v26
    v_accvgpr_write_b32 a126, v27
    v_accvgpr_write_b32 a127, v28
    v_accvgpr_read_b32 v25, a140
    v_accvgpr_read_b32 v26, a141
    v_accvgpr_read_b32 v27, a142
    v_accvgpr_read_b32 v28, a143
    v_mul_f32 v25, v25, v23
    v_mul_f32 v26, v26, v23
    v_mul_f32 v27, v27, v23
    v_mul_f32 v28, v28, v23
    v_accvgpr_write_b32 a140, v25
    v_accvgpr_write_b32 a141, v26
    v_accvgpr_write_b32 a142, v27
    v_accvgpr_write_b32 a143, v28
    v_accvgpr_read_b32 v25, a156
    v_accvgpr_read_b32 v26, a157
    v_accvgpr_read_b32 v27, a158
    v_accvgpr_read_b32 v28, a159
    v_mul_f32 v25, v25, v23
    v_mul_f32 v26, v26, v23
    v_mul_f32 v27, v27, v23
    v_mul_f32 v28, v28, v23
    v_accvgpr_write_b32 a156, v25
    v_accvgpr_write_b32 a157, v26
    v_accvgpr_write_b32 a158, v27
    v_accvgpr_write_b32 a159, v28
    v_accvgpr_read_b32 v25, a172
    v_accvgpr_read_b32 v26, a173
    v_accvgpr_read_b32 v27, a174
    v_accvgpr_read_b32 v28, a175
    v_mul_f32 v25, v25, v23
    v_mul_f32 v26, v26, v23
    v_mul_f32 v27, v27, v23
    v_mul_f32 v28, v28, v23
    v_accvgpr_write_b32 a172, v25
    v_accvgpr_write_b32 a173, v26
    v_accvgpr_write_b32 a174, v27
    v_accvgpr_write_b32 a175, v28
    v_accvgpr_read_b32 v25, a188
    v_accvgpr_read_b32 v26, a189
    v_accvgpr_read_b32 v27, a190
    v_accvgpr_read_b32 v28, a191
    v_mul_f32 v25, v25, v23
    v_mul_f32 v26, v26, v23
    v_mul_f32 v27, v27, v23
    v_mul_f32 v28, v28, v23
    v_accvgpr_write_b32 a188, v25
    v_accvgpr_write_b32 a189, v26
    v_accvgpr_write_b32 a190, v27
    v_accvgpr_write_b32 a191, v28
    v_accvgpr_read_b32 v25, a204
    v_accvgpr_read_b32 v26, a205
    v_accvgpr_read_b32 v27, a206
    v_accvgpr_read_b32 v28, a207
    v_mul_f32 v25, v25, v23
    v_mul_f32 v26, v26, v23
    v_mul_f32 v27, v27, v23
    v_mul_f32 v28, v28, v23
    v_accvgpr_write_b32 a204, v25
    v_accvgpr_write_b32 a205, v26
    v_accvgpr_write_b32 a206, v27
    v_accvgpr_write_b32 a207, v28
    v_accvgpr_read_b32 v25, a220
    v_accvgpr_read_b32 v26, a221
    v_accvgpr_read_b32 v27, a222
    v_accvgpr_read_b32 v28, a223
    v_mul_f32 v25, v25, v23
    v_mul_f32 v26, v26, v23
    v_mul_f32 v27, v27, v23
    v_mul_f32 v28, v28, v23
    v_accvgpr_write_b32 a220, v25
    v_accvgpr_write_b32 a221, v26
    v_accvgpr_write_b32 a222, v27
    v_accvgpr_write_b32 a223, v28
    v_accvgpr_read_b32 v25, a236
    v_accvgpr_read_b32 v26, a237
    v_accvgpr_read_b32 v27, a238
    v_accvgpr_read_b32 v28, a239
    v_mul_f32 v25, v25, v23
    v_mul_f32 v26, v26, v23
    v_mul_f32 v27, v27, v23
    v_mul_f32 v28, v28, v23
    v_accvgpr_write_b32 a236, v25
    v_accvgpr_write_b32 a237, v26
    v_accvgpr_write_b32 a238, v27
    v_accvgpr_write_b32 a239, v28
    v_accvgpr_read_b32 v25, a252
    v_accvgpr_read_b32 v26, a253
    v_accvgpr_read_b32 v27, a254
    v_accvgpr_read_b32 v28, a255
    v_mul_f32 v25, v25, v23
    v_mul_f32 v26, v26, v23
    v_mul_f32 v27, v27, v23
    v_mul_f32 v28, v28, v23
    v_accvgpr_write_b32 a252, v25
    v_accvgpr_write_b32 a253, v26
    v_accvgpr_write_b32 a254, v27
    v_accvgpr_write_b32 a255, v28
    s_nop 3
    s_branch L_back0
L_slow1:
    s_nop 15
    v_max3_f32 v21, v64, v65, v66
    v_max3_f32 v21, v21, v67, v68
    v_max3_f32 v21, v21, v69, v70
    v_max3_f32 v21, v21, v71, 0
    v_mov_b32 v22, v21
    s_nop 1
    v_permlane16_swap_b32 v21, v22
    v_max_f32 v21, v21, v22
    v_mov_b32 v22, v21
    s_nop 1
    v_permlane32_swap_b32 v21, v22
    v_max_f32 v21, v21, v22
    v_ceil_f32 v21, v21
    v_add_f32 v16, v16, v21
    v_sub_f32 v64, v64, v21
    v_sub_f32 v65, v65, v21
    v_sub_f32 v66, v66, v21
    v_sub_f32 v67, v67, v21
    v_sub_f32 v68, v68, v21
    v_sub_f32 v69, v69, v21
    v_sub_f32 v70, v70, v21
    v_sub_f32 v71, v71, v21
    v_min_f32 v22, 0x43800000, v21
    v_cvt_i32_f32 v22, v22
    v_sub_u32 v22, 0, v22
    v_ldexp_f32 v23, 1.0, v22
    v_mul_f32 v12, v12, v23
    v_lshlrev_b32 v24, 16, v96
    v_and_b32 v25, 0xffff0000, v96
    v_mul_f32 v24, v24, v23
    v_mul_f32 v25, v25, v23
    v_cvt_pk_bf16_f32 v96, v24, v25
    v_lshlrev_b32 v24, 16, v97
    v_and_b32 v25, 0xffff0000, v97
    v_mul_f32 v24, v24, v23
    v_mul_f32 v25, v25, v23
    v_cvt_pk_bf16_f32 v97, v24, v25
    v_lshlrev_b32 v24, 16, v98
    v_and_b32 v25, 0xffff0000, v98
    v_mul_f32 v24, v24, v23
    v_mul_f32 v25, v25, v23
    v_cvt_pk_bf16_f32 v98, v24, v25
    v_lshlrev_b32 v24, 16, v99
    v_and_b32 v25, 0xffff0000, v99
    v_mul_f32 v24, v24, v23
    v_mul_f32 v25, v25, v23
    v_cvt_pk_bf16_f32 v99, v24, v25
    v_accvgpr_read_b32 v25, a0
    v_accvgpr_read_b32 v26, a1
    v_accvgpr_read_b32 v27, a2
    v_accvgpr_read_b32 v28, a3
    v_mul_f32 v25, v25, v23
    v_mul_f32 v26, v26, v23
    v_mul_f32 v27, v27, v23
    v_mul_f32 v28, v28, v23
    v_accvgpr_write_b32 a0, v25
    v_accvgpr_write_b32 a1, v26
    v_accvgpr_write_b32 a2, v27
    v_accvgpr_write_b32 a3, v28
    v_accvgpr_read_b32 v25, a16
    v_accvgpr_read_b32 v26, a17
    v_accvgpr_read_b32 v27, a18
    v_accvgpr_read_b32 v28, a19
    v_mul_f32 v25, v25, v23
    v_mul_f32 v26, v26, v23
    v_mul_f32 v27, v27, v23
    v_mul_f32 v28, v28, v23
    v_accvgpr_write_b32 a16, v25
    v_accvgpr_write_b32 a17, v26
    v_accvgpr_write_b32 a18, v27
    v_accvgpr_write_b32 a19, v28
    v_accvgpr_read_b32 v25, a32
    v_accvgpr_read_b32 v26, a33
    v_accvgpr_read_b32 v27, a34
    v_accvgpr_read_b32 v28, a35
    v_mul_f32 v25, v25, v23
    v_mul_f32 v26, v26, v23
    v_mul_f32 v27, v27, v23
    v_mul_f32 v28, v28, v23
    v_accvgpr_write_b32 a32, v25
    v_accvgpr_write_b32 a33, v26
    v_accvgpr_write_b32 a34, v27
    v_accvgpr_write_b32 a35, v28
    v_accvgpr_read_b32 v25, a48
    v_accvgpr_read_b32 v26, a49
    v_accvgpr_read_b32 v27, a50
    v_accvgpr_read_b32 v28, a51
    v_mul_f32 v25, v25, v23
    v_mul_f32 v26, v26, v23
    v_mul_f32 v27, v27, v23
    v_mul_f32 v28, v28, v23
    v_accvgpr_write_b32 a48, v25
    v_accvgpr_write_b32 a49, v26
    v_accvgpr_write_b32 a50, v27
    v_accvgpr_write_b32 a51, v28
    v_accvgpr_read_b32 v25, a64
    v_accvgpr_read_b32 v26, a65
    v_accvgpr_read_b32 v27, a66
    v_accvgpr_read_b32 v28, a67
    v_mul_f32 v25, v25, v23
    v_mul_f32 v26, v26, v23
    v_mul_f32 v27, v27, v23
    v_mul_f32 v28, v28, v23
    v_accvgpr_write_b32 a64, v25
    v_accvgpr_write_b32 a65, v26
    v_accvgpr_write_b32 a66, v27
    v_accvgpr_write_b32 a67, v28
    v_accvgpr_read_b32 v25, a80
    v_accvgpr_read_b32 v26, a81
    v_accvgpr_read_b32 v27, a82
    v_accvgpr_read_b32 v28, a83
    v_mul_f32 v25, v25, v23
    v_mul_f32 v26, v26, v23
    v_mul_f32 v27, v27, v23
    v_mul_f32 v28, v28, v23
    v_accvgpr_write_b32 a80, v25
    v_accvgpr_write_b32 a81, v26
    v_accvgpr_write_b32 a82, v27
    v_accvgpr_write_b32 a83, v28
    v_accvgpr_read_b32 v25, a96
    v_accvgpr_read_b32 v26, a97
    v_accvgpr_read_b32 v27, a98
    v_accvgpr_read_b32 v28, a99
    v_mul_f32 v25, v25, v23
    v_mul_f32 v26, v26, v23
    v_mul_f32 v27, v27, v23
    v_mul_f32 v28, v28, v23
    v_accvgpr_write_b32 a96, v25
    v_accvgpr_write_b32 a97, v26
    v_accvgpr_write_b32 a98, v27
    v_accvgpr_write_b32 a99, v28
    v_accvgpr_read_b32 v25, a112
    v_accvgpr_read_b32 v26, a113
    v_accvgpr_read_b32 v27, a114
    v_accvgpr_read_b32 v28, a115
    v_mul_f32 v25, v25, v23
    v_mul_f32 v26, v26, v23
    v_mul_f32 v27, v27, v23
    v_mul_f32 v28, v28, v23
    v_accvgpr_write_b32 a112, v25
    v_accvgpr_write_b32 a113, v26
    v_accvgpr_write_b32 a114, v27
    v_accvgpr_write_b32 a115, v28
    v_accvgpr_read_b32 v25, a128
    v_accvgpr_read_b32 v26, a129
    v_accvgpr_read_b32 v27, a130
    v_accvgpr_read_b32 v28, a131
    v_mul_f32 v25, v25, v23
    v_mul_f32 v26, v26, v23
    v_mul_f32 v27, v27, v23
    v_mul_f32 v28, v28, v23
    v_accvgpr_write_b32 a128, v25
    v_accvgpr_write_b32 a129, v26
    v_accvgpr_write_b32 a130, v27
    v_accvgpr_write_b32 a131, v28
    v_accvgpr_read_b32 v25, a144
    v_accvgpr_read_b32 v26, a145
    v_accvgpr_read_b32 v27, a146
    v_accvgpr_read_b32 v28, a147
    v_mul_f32 v25, v25, v23
    v_mul_f32 v26, v26, v23
    v_mul_f32 v27, v27, v23
    v_mul_f32 v28, v28, v23
    v_accvgpr_write_b32 a144, v25
    v_accvgpr_write_b32 a145, v26
    v_accvgpr_write_b32 a146, v27
    v_accvgpr_write_b32 a147, v28
    v_accvgpr_read_b32 v25, a160
    v_accvgpr_read_b32 v26, a161
    v_accvgpr_read_b32 v27, a162
    v_accvgpr_read_b32 v28, a163
    v_mul_f32 v25, v25, v23
    v_mul_f32 v26, v26, v23
    v_mul_f32 v27, v27, v23
    v_mul_f32 v28, v28, v23
    v_accvgpr_write_b32 a160, v25
    v_accvgpr_write_b32 a161, v26
    v_accvgpr_write_b32 a162, v27
    v_accvgpr_write_b32 a163, v28
    v_accvgpr_read_b32 v25, a176
    v_accvgpr_read_b32 v26, a177
    v_accvgpr_read_b32 v27, a178
    v_accvgpr_read_b32 v28, a179
    v_mul_f32 v25, v25, v23
    v_mul_f32 v26, v26, v23
    v_mul_f32 v27, v27, v23
    v_mul_f32 v28, v28, v23
    v_accvgpr_write_b32 a176, v25
    v_accvgpr_write_b32 a177, v26
    v_accvgpr_write_b32 a178, v27
    v_accvgpr_write_b32 a179, v28
    v_accvgpr_read_b32 v25, a192
    v_accvgpr_read_b32 v26, a193
    v_accvgpr_read_b32 v27, a194
    v_accvgpr_read_b32 v28, a195
    v_mul_f32 v25, v25, v23
    v_mul_f32 v26, v26, v23
    v_mul_f32 v27, v27, v23
    v_mul_f32 v28, v28, v23
    v_accvgpr_write_b32 a192, v25
    v_accvgpr_write_b32 a193, v26
    v_accvgpr_write_b32 a194, v27
    v_accvgpr_write_b32 a195, v28
    v_accvgpr_read_b32 v25, a208
    v_accvgpr_read_b32 v26, a209
    v_accvgpr_read_b32 v27, a210
    v_accvgpr_read_b32 v28, a211
    v_mul_f32 v25, v25, v23
    v_mul_f32 v26, v26, v23
    v_mul_f32 v27, v27, v23
    v_mul_f32 v28, v28, v23
    v_accvgpr_write_b32 a208, v25
    v_accvgpr_write_b32 a209, v26
    v_accvgpr_write_b32 a210, v27
    v_accvgpr_write_b32 a211, v28
    v_accvgpr_read_b32 v25, a224
    v_accvgpr_read_b32 v26, a225
    v_accvgpr_read_b32 v27, a226
    v_accvgpr_read_b32 v28, a227
    v_mul_f32 v25, v25, v23
    v_mul_f32 v26, v26, v23
    v_mul_f32 v27, v27, v23
    v_mul_f32 v28, v28, v23
    v_accvgpr_write_b32 a224, v25
    v_accvgpr_write_b32 a225, v26
    v_accvgpr_write_b32 a226, v27
    v_accvgpr_write_b32 a227, v28
    v_accvgpr_read_b32 v25, a240
    v_accvgpr_read_b32 v26, a241
    v_accvgpr_read_b32 v27, a242
    v_accvgpr_read_b32 v28, a243
    v_mul_f32 v25, v25, v23
    v_mul_f32 v26, v26, v23
    v_mul_f32 v27, v27, v23
    v_mul_f32 v28, v28, v23
    v_accvgpr_write_b32 a240, v25
    v_accvgpr_write_b32 a241, v26
    v_accvgpr_write_b32 a242, v27
    v_accvgpr_write_b32 a243, v28
    v_max3_f32 v21, v72, v73, v74
    v_max3_f32 v21, v21, v75, v76
    v_max3_f32 v21, v21, v77, v78
    v_max3_f32 v21, v21, v79, 0
    v_mov_b32 v22, v21
    s_nop 1
    v_permlane16_swap_b32 v21, v22
    v_max_f32 v21, v21, v22
    v_mov_b32 v22, v21
    s_nop 1
    v_permlane32_swap_b32 v21, v22
    v_max_f32 v21, v21, v22
    v_ceil_f32 v21, v21
    v_add_f32 v17, v17, v21
    v_sub_f32 v72, v72, v21
    v_sub_f32 v73, v73, v21
    v_sub_f32 v74, v74, v21
    v_sub_f32 v75, v75, v21
    v_sub_f32 v76, v76, v21
    v_sub_f32 v77, v77, v21
    v_sub_f32 v78, v78, v21
    v_sub_f32 v79, v79, v21
    v_min_f32 v22, 0x43800000, v21
    v_cvt_i32_f32 v22, v22
    v_sub_u32 v22, 0, v22
    v_ldexp_f32 v23, 1.0, v22
    v_mul_f32 v13, v13, v23
    v_lshlrev_b32 v24, 16, v104
    v_and_b32 v25, 0xffff0000, v104
    v_mul_f32 v24, v24, v23
    v_mul_f32 v25, v25, v23
    v_cvt_pk_bf16_f32 v104, v24, v25
    v_lshlrev_b32 v24, 16, v105
    v_and_b32 v25, 0xffff0000, v105
    v_mul_f32 v24, v24, v23
    v_mul_f32 v25, v25, v23
    v_cvt_pk_bf16_f32 v105, v24, v25
    v_lshlrev_b32 v24, 16, v106
    v_and_b32 v25, 0xffff0000, v106
    v_mul_f32 v24, v24, v23
    v_mul_f32 v25, v25, v23
    v_cvt_pk_bf16_f32 v106, v24, v25
    v_lshlrev_b32 v24, 16, v107
    v_and_b32 v25, 0xffff0000, v107
    v_mul_f32 v24, v24, v23
    v_mul_f32 v25, v25, v23
    v_cvt_pk_bf16_f32 v107, v24, v25
    v_accvgpr_read_b32 v25, a4
    v_accvgpr_read_b32 v26, a5
    v_accvgpr_read_b32 v27, a6
    v_accvgpr_read_b32 v28, a7
    v_mul_f32 v25, v25, v23
    v_mul_f32 v26, v26, v23
    v_mul_f32 v27, v27, v23
    v_mul_f32 v28, v28, v23
    v_accvgpr_write_b32 a4, v25
    v_accvgpr_write_b32 a5, v26
    v_accvgpr_write_b32 a6, v27
    v_accvgpr_write_b32 a7, v28
    v_accvgpr_read_b32 v25, a20
    v_accvgpr_read_b32 v26, a21
    v_accvgpr_read_b32 v27, a22
    v_accvgpr_read_b32 v28, a23
    v_mul_f32 v25, v25, v23
    v_mul_f32 v26, v26, v23
    v_mul_f32 v27, v27, v23
    v_mul_f32 v28, v28, v23
    v_accvgpr_write_b32 a20, v25
    v_accvgpr_write_b32 a21, v26
    v_accvgpr_write_b32 a22, v27
    v_accvgpr_write_b32 a23, v28
    v_accvgpr_read_b32 v25, a36
    v_accvgpr_read_b32 v26, a37
    v_accvgpr_read_b32 v27, a38
    v_accvgpr_read_b32 v28, a39
    v_mul_f32 v25, v25, v23
    v_mul_f32 v26, v26, v23
    v_mul_f32 v27, v27, v23
    v_mul_f32 v28, v28, v23
    v_accvgpr_write_b32 a36, v25
    v_accvgpr_write_b32 a37, v26
    v_accvgpr_write_b32 a38, v27
    v_accvgpr_write_b32 a39, v28
    v_accvgpr_read_b32 v25, a52
    v_accvgpr_read_b32 v26, a53
    v_accvgpr_read_b32 v27, a54
    v_accvgpr_read_b32 v28, a55
    v_mul_f32 v25, v25, v23
    v_mul_f32 v26, v26, v23
    v_mul_f32 v27, v27, v23
    v_mul_f32 v28, v28, v23
    v_accvgpr_write_b32 a52, v25
    v_accvgpr_write_b32 a53, v26
    v_accvgpr_write_b32 a54, v27
    v_accvgpr_write_b32 a55, v28
    v_accvgpr_read_b32 v25, a68
    v_accvgpr_read_b32 v26, a69
    v_accvgpr_read_b32 v27, a70
    v_accvgpr_read_b32 v28, a71
    v_mul_f32 v25, v25, v23
    v_mul_f32 v26, v26, v23
    v_mul_f32 v27, v27, v23
    v_mul_f32 v28, v28, v23
    v_accvgpr_write_b32 a68, v25
    v_accvgpr_write_b32 a69, v26
    v_accvgpr_write_b32 a70, v27
    v_accvgpr_write_b32 a71, v28
    v_accvgpr_read_b32 v25, a84
    v_accvgpr_read_b32 v26, a85
    v_accvgpr_read_b32 v27, a86
    v_accvgpr_read_b32 v28, a87
    v_mul_f32 v25, v25, v23
    v_mul_f32 v26, v26, v23
    v_mul_f32 v27, v27, v23
    v_mul_f32 v28, v28, v23
    v_accvgpr_write_b32 a84, v25
    v_accvgpr_write_b32 a85, v26
    v_accvgpr_write_b32 a86, v27
    v_accvgpr_write_b32 a87, v28
    v_accvgpr_read_b32 v25, a100
    v_accvgpr_read_b32 v26, a101
    v_accvgpr_read_b32 v27, a102
    v_accvgpr_read_b32 v28, a103
    v_mul_f32 v25, v25, v23
    v_mul_f32 v26, v26, v23
    v_mul_f32 v27, v27, v23
    v_mul_f32 v28, v28, v23
    v_accvgpr_write_b32 a100, v25
    v_accvgpr_write_b32 a101, v26
    v_accvgpr_write_b32 a102, v27
    v_accvgpr_write_b32 a103, v28
    v_accvgpr_read_b32 v25, a116
    v_accvgpr_read_b32 v26, a117
    v_accvgpr_read_b32 v27, a118
    v_accvgpr_read_b32 v28, a119
    v_mul_f32 v25, v25, v23
    v_mul_f32 v26, v26, v23
    v_mul_f32 v27, v27, v23
    v_mul_f32 v28, v28, v23
    v_accvgpr_write_b32 a116, v25
    v_accvgpr_write_b32 a117, v26
    v_accvgpr_write_b32 a118, v27
    v_accvgpr_write_b32 a119, v28
    v_accvgpr_read_b32 v25, a132
    v_accvgpr_read_b32 v26, a133
    v_accvgpr_read_b32 v27, a134
    v_accvgpr_read_b32 v28, a135
    v_mul_f32 v25, v25, v23
    v_mul_f32 v26, v26, v23
    v_mul_f32 v27, v27, v23
    v_mul_f32 v28, v28, v23
    v_accvgpr_write_b32 a132, v25
    v_accvgpr_write_b32 a133, v26
    v_accvgpr_write_b32 a134, v27
    v_accvgpr_write_b32 a135, v28
    v_accvgpr_read_b32 v25, a148
    v_accvgpr_read_b32 v26, a149
    v_accvgpr_read_b32 v27, a150
    v_accvgpr_read_b32 v28, a151
    v_mul_f32 v25, v25, v23
    v_mul_f32 v26, v26, v23
    v_mul_f32 v27, v27, v23
    v_mul_f32 v28, v28, v23
    v_accvgpr_write_b32 a148, v25
    v_accvgpr_write_b32 a149, v26
    v_accvgpr_write_b32 a150, v27
    v_accvgpr_write_b32 a151, v28
    v_accvgpr_read_b32 v25, a164
    v_accvgpr_read_b32 v26, a165
    v_accvgpr_read_b32 v27, a166
    v_accvgpr_read_b32 v28, a167
    v_mul_f32 v25, v25, v23
    v_mul_f32 v26, v26, v23
    v_mul_f32 v27, v27, v23
    v_mul_f32 v28, v28, v23
    v_accvgpr_write_b32 a164, v25
    v_accvgpr_write_b32 a165, v26
    v_accvgpr_write_b32 a166, v27
    v_accvgpr_write_b32 a167, v28
    v_accvgpr_read_b32 v25, a180
    v_accvgpr_read_b32 v26, a181
    v_accvgpr_read_b32 v27, a182
    v_accvgpr_read_b32 v28, a183
    v_mul_f32 v25, v25, v23
    v_mul_f32 v26, v26, v23
    v_mul_f32 v27, v27, v23
    v_mul_f32 v28, v28, v23
    v_accvgpr_write_b32 a180, v25
    v_accvgpr_write_b32 a181, v26
    v_accvgpr_write_b32 a182, v27
    v_accvgpr_write_b32 a183, v28
    v_accvgpr_read_b32 v25, a196
    v_accvgpr_read_b32 v26, a197
    v_accvgpr_read_b32 v27, a198
    v_accvgpr_read_b32 v28, a199
    v_mul_f32 v25, v25, v23
    v_mul_f32 v26, v26, v23
    v_mul_f32 v27, v27, v23
    v_mul_f32 v28, v28, v23
    v_accvgpr_write_b32 a196, v25
    v_accvgpr_write_b32 a197, v26
    v_accvgpr_write_b32 a198, v27
    v_accvgpr_write_b32 a199, v28
    v_accvgpr_read_b32 v25, a212
    v_accvgpr_read_b32 v26, a213
    v_accvgpr_read_b32 v27, a214
    v_accvgpr_read_b32 v28, a215
    v_mul_f32 v25, v25, v23
    v_mul_f32 v26, v26, v23
    v_mul_f32 v27, v27, v23
    v_mul_f32 v28, v28, v23
    v_accvgpr_write_b32 a212, v25
    v_accvgpr_write_b32 a213, v26
    v_accvgpr_write_b32 a214, v27
    v_accvgpr_write_b32 a215, v28
    v_accvgpr_read_b32 v25, a228
    v_accvgpr_read_b32 v26, a229
    v_accvgpr_read_b32 v27, a230
    v_accvgpr_read_b32 v28, a231
    v_mul_f32 v25, v25, v23
    v_mul_f32 v26, v26, v23
    v_mul_f32 v27, v27, v23
    v_mul_f32 v28, v28, v23
    v_accvgpr_write_b32 a228, v25
    v_accvgpr_write_b32 a229, v26
    v_accvgpr_write_b32 a230, v27
    v_accvgpr_write_b32 a231, v28
    v_accvgpr_read_b32 v25, a244
    v_accvgpr_read_b32 v26, a245
    v_accvgpr_read_b32 v27, a246
    v_accvgpr_read_b32 v28, a247
    v_mul_f32 v25, v25, v23
    v_mul_f32 v26, v26, v23
    v_mul_f32 v27, v27, v23
    v_mul_f32 v28, v28, v23
    v_accvgpr_write_b32 a244, v25
    v_accvgpr_write_b32 a245, v26
    v_accvgpr_write_b32 a246, v27
    v_accvgpr_write_b32 a247, v28
    v_max3_f32 v21, v80, v81, v82
    v_max3_f32 v21, v21, v83, v84
    v_max3_f32 v21, v21, v85, v86
    v_max3_f32 v21, v21, v87, 0
    v_mov_b32 v22, v21
    s_nop 1
    v_permlane16_swap_b32 v21, v22
    v_max_f32 v21, v21, v22
    v_mov_b32 v22, v21
    s_nop 1
    v_permlane32_swap_b32 v21, v22
    v_max_f32 v21, v21, v22
    v_ceil_f32 v21, v21
    v_add_f32 v18, v18, v21
    v_sub_f32 v80, v80, v21
    v_sub_f32 v81, v81, v21
    v_sub_f32 v82, v82, v21
    v_sub_f32 v83, v83, v21
    v_sub_f32 v84, v84, v21
    v_sub_f32 v85, v85, v21
    v_sub_f32 v86, v86, v21
    v_sub_f32 v87, v87, v21
    v_min_f32 v22, 0x43800000, v21
    v_cvt_i32_f32 v22, v22
    v_sub_u32 v22, 0, v22
    v_ldexp_f32 v23, 1.0, v22
    v_mul_f32 v14, v14, v23
    v_lshlrev_b32 v24, 16, v112
    v_and_b32 v25, 0xffff0000, v112
    v_mul_f32 v24, v24, v23
    v_mul_f32 v25, v25, v23
    v_cvt_pk_bf16_f32 v112, v24, v25
    v_lshlrev_b32 v24, 16, v113
    v_and_b32 v25, 0xffff0000, v113
    v_mul_f32 v24, v24, v23
    v_mul_f32 v25, v25, v23
    v_cvt_pk_bf16_f32 v113, v24, v25
    v_lshlrev_b32 v24, 16, v114
    v_and_b32 v25, 0xffff0000, v114
    v_mul_f32 v24, v24, v23
    v_mul_f32 v25, v25, v23
    v_cvt_pk_bf16_f32 v114, v24, v25
    v_lshlrev_b32 v24, 16, v115
    v_and_b32 v25, 0xffff0000, v115
    v_mul_f32 v24, v24, v23
    v_mul_f32 v25, v25, v23
    v_cvt_pk_bf16_f32 v115, v24, v25
    v_accvgpr_read_b32 v25, a8
    v_accvgpr_read_b32 v26, a9
    v_accvgpr_read_b32 v27, a10
    v_accvgpr_read_b32 v28, a11
    v_mul_f32 v25, v25, v23
    v_mul_f32 v26, v26, v23
    v_mul_f32 v27, v27, v23
    v_mul_f32 v28, v28, v23
    v_accvgpr_write_b32 a8, v25
    v_accvgpr_write_b32 a9, v26
    v_accvgpr_write_b32 a10, v27
    v_accvgpr_write_b32 a11, v28
    v_accvgpr_read_b32 v25, a24
    v_accvgpr_read_b32 v26, a25
    v_accvgpr_read_b32 v27, a26
    v_accvgpr_read_b32 v28, a27
    v_mul_f32 v25, v25, v23
    v_mul_f32 v26, v26, v23
    v_mul_f32 v27, v27, v23
    v_mul_f32 v28, v28, v23
    v_accvgpr_write_b32 a24, v25
    v_accvgpr_write_b32 a25, v26
    v_accvgpr_write_b32 a26, v27
    v_accvgpr_write_b32 a27, v28
    v_accvgpr_read_b32 v25, a40
    v_accvgpr_read_b32 v26, a41
    v_accvgpr_read_b32 v27, a42
    v_accvgpr_read_b32 v28, a43
    v_mul_f32 v25, v25, v23
    v_mul_f32 v26, v26, v23
    v_mul_f32 v27, v27, v23
    v_mul_f32 v28, v28, v23
    v_accvgpr_write_b32 a40, v25
    v_accvgpr_write_b32 a41, v26
    v_accvgpr_write_b32 a42, v27
    v_accvgpr_write_b32 a43, v28
    v_accvgpr_read_b32 v25, a56
    v_accvgpr_read_b32 v26, a57
    v_accvgpr_read_b32 v27, a58
    v_accvgpr_read_b32 v28, a59
    v_mul_f32 v25, v25, v23
    v_mul_f32 v26, v26, v23
    v_mul_f32 v27, v27, v23
    v_mul_f32 v28, v28, v23
    v_accvgpr_write_b32 a56, v25
    v_accvgpr_write_b32 a57, v26
    v_accvgpr_write_b32 a58, v27
    v_accvgpr_write_b32 a59, v28
    v_accvgpr_read_b32 v25, a72
    v_accvgpr_read_b32 v26, a73
    v_accvgpr_read_b32 v27, a74
    v_accvgpr_read_b32 v28, a75
    v_mul_f32 v25, v25, v23
    v_mul_f32 v26, v26, v23
    v_mul_f32 v27, v27, v23
    v_mul_f32 v28, v28, v23
    v_accvgpr_write_b32 a72, v25
    v_accvgpr_write_b32 a73, v26
    v_accvgpr_write_b32 a74, v27
    v_accvgpr_write_b32 a75, v28
    v_accvgpr_read_b32 v25, a88
    v_accvgpr_read_b32 v26, a89
    v_accvgpr_read_b32 v27, a90
    v_accvgpr_read_b32 v28, a91
    v_mul_f32 v25, v25, v23
    v_mul_f32 v26, v26, v23
    v_mul_f32 v27, v27, v23
    v_mul_f32 v28, v28, v23
    v_accvgpr_write_b32 a88, v25
    v_accvgpr_write_b32 a89, v26
    v_accvgpr_write_b32 a90, v27
    v_accvgpr_write_b32 a91, v28
    v_accvgpr_read_b32 v25, a104
    v_accvgpr_read_b32 v26, a105
    v_accvgpr_read_b32 v27, a106
    v_accvgpr_read_b32 v28, a107
    v_mul_f32 v25, v25, v23
    v_mul_f32 v26, v26, v23
    v_mul_f32 v27, v27, v23
    v_mul_f32 v28, v28, v23
    v_accvgpr_write_b32 a104, v25
    v_accvgpr_write_b32 a105, v26
    v_accvgpr_write_b32 a106, v27
    v_accvgpr_write_b32 a107, v28
    v_accvgpr_read_b32 v25, a120
    v_accvgpr_read_b32 v26, a121
    v_accvgpr_read_b32 v27, a122
    v_accvgpr_read_b32 v28, a123
    v_mul_f32 v25, v25, v23
    v_mul_f32 v26, v26, v23
    v_mul_f32 v27, v27, v23
    v_mul_f32 v28, v28, v23
    v_accvgpr_write_b32 a120, v25
    v_accvgpr_write_b32 a121, v26
    v_accvgpr_write_b32 a122, v27
    v_accvgpr_write_b32 a123, v28
    v_accvgpr_read_b32 v25, a136
    v_accvgpr_read_b32 v26, a137
    v_accvgpr_read_b32 v27, a138
    v_accvgpr_read_b32 v28, a139
    v_mul_f32 v25, v25, v23
    v_mul_f32 v26, v26, v23
    v_mul_f32 v27, v27, v23
    v_mul_f32 v28, v28, v23
    v_accvgpr_write_b32 a136, v25
    v_accvgpr_write_b32 a137, v26
    v_accvgpr_write_b32 a138, v27
    v_accvgpr_write_b32 a139, v28
    v_accvgpr_read_b32 v25, a152
    v_accvgpr_read_b32 v26, a153
    v_accvgpr_read_b32 v27, a154
    v_accvgpr_read_b32 v28, a155
    v_mul_f32 v25, v25, v23
    v_mul_f32 v26, v26, v23
    v_mul_f32 v27, v27, v23
    v_mul_f32 v28, v28, v23
    v_accvgpr_write_b32 a152, v25
    v_accvgpr_write_b32 a153, v26
    v_accvgpr_write_b32 a154, v27
    v_accvgpr_write_b32 a155, v28
    v_accvgpr_read_b32 v25, a168
    v_accvgpr_read_b32 v26, a169
    v_accvgpr_read_b32 v27, a170
    v_accvgpr_read_b32 v28, a171
    v_mul_f32 v25, v25, v23
    v_mul_f32 v26, v26, v23
    v_mul_f32 v27, v27, v23
    v_mul_f32 v28, v28, v23
    v_accvgpr_write_b32 a168, v25
    v_accvgpr_write_b32 a169, v26
    v_accvgpr_write_b32 a170, v27
    v_accvgpr_write_b32 a171, v28
    v_accvgpr_read_b32 v25, a184
    v_accvgpr_read_b32 v26, a185
    v_accvgpr_read_b32 v27, a186
    v_accvgpr_read_b32 v28, a187
    v_mul_f32 v25, v25, v23
    v_mul_f32 v26, v26, v23
    v_mul_f32 v27, v27, v23
    v_mul_f32 v28, v28, v23
    v_accvgpr_write_b32 a184, v25
    v_accvgpr_write_b32 a185, v26
    v_accvgpr_write_b32 a186, v27
    v_accvgpr_write_b32 a187, v28
    v_accvgpr_read_b32 v25, a200
    v_accvgpr_read_b32 v26, a201
    v_accvgpr_read_b32 v27, a202
    v_accvgpr_read_b32 v28, a203
    v_mul_f32 v25, v25, v23
    v_mul_f32 v26, v26, v23
    v_mul_f32 v27, v27, v23
    v_mul_f32 v28, v28, v23
    v_accvgpr_write_b32 a200, v25
    v_accvgpr_write_b32 a201, v26
    v_accvgpr_write_b32 a202, v27
    v_accvgpr_write_b32 a203, v28
    v_accvgpr_read_b32 v25, a216
    v_accvgpr_read_b32 v26, a217
    v_accvgpr_read_b32 v27, a218
    v_accvgpr_read_b32 v28, a219
    v_mul_f32 v25, v25, v23
    v_mul_f32 v26, v26, v23
    v_mul_f32 v27, v27, v23
    v_mul_f32 v28, v28, v23
    v_accvgpr_write_b32 a216, v25
    v_accvgpr_write_b32 a217, v26
    v_accvgpr_write_b32 a218, v27
    v_accvgpr_write_b32 a219, v28
    v_accvgpr_read_b32 v25, a232
    v_accvgpr_read_b32 v26, a233
    v_accvgpr_read_b32 v27, a234
    v_accvgpr_read_b32 v28, a235
    v_mul_f32 v25, v25, v23
    v_mul_f32 v26, v26, v23
    v_mul_f32 v27, v27, v23
    v_mul_f32 v28, v28, v23
    v_accvgpr_write_b32 a232, v25
    v_accvgpr_write_b32 a233, v26
    v_accvgpr_write_b32 a234, v27
    v_accvgpr_write_b32 a235, v28
    v_accvgpr_read_b32 v25, a248
    v_accvgpr_read_b32 v26, a249
    v_accvgpr_read_b32 v27, a250
    v_accvgpr_read_b32 v28, a251
    v_mul_f32 v25, v25, v23
    v_mul_f32 v26, v26, v23
    v_mul_f32 v27, v27, v23
    v_mul_f32 v28, v28, v23
    v_accvgpr_write_b32 a248, v25
    v_accvgpr_write_b32 a249, v26
    v_accvgpr_write_b32 a250, v27
    v_accvgpr_write_b32 a251, v28
    v_max3_f32 v21, v88, v89, v90
    v_max3_f32 v21, v21, v91, v92
    v_max3_f32 v21, v21, v93, v94
    v_max3_f32 v21, v21, v95, 0
    v_mov_b32 v22, v21
    s_nop 1
    v_permlane16_swap_b32 v21, v22
    v_max_f32 v21, v21, v22
    v_mov_b32 v22, v21
    s_nop 1
    v_permlane32_swap_b32 v21, v22
    v_max_f32 v21, v21, v22
    v_ceil_f32 v21, v21
    v_add_f32 v19, v19, v21
    v_sub_f32 v88, v88, v21
    v_sub_f32 v89, v89, v21
    v_sub_f32 v90, v90, v21
    v_sub_f32 v91, v91, v21
    v_sub_f32 v92, v92, v21
    v_sub_f32 v93, v93, v21
    v_sub_f32 v94, v94, v21
    v_sub_f32 v95, v95, v21
    v_min_f32 v22, 0x43800000, v21
    v_cvt_i32_f32 v22, v22
    v_sub_u32 v22, 0, v22
    v_ldexp_f32 v23, 1.0, v22
    v_mul_f32 v15, v15, v23
    v_lshlrev_b32 v24, 16, v120
    v_and_b32 v25, 0xffff0000, v120
    v_mul_f32 v24, v24, v23
    v_mul_f32 v25, v25, v23
    v_cvt_pk_bf16_f32 v120, v24, v25
    v_lshlrev_b32 v24, 16, v121
    v_and_b32 v25, 0xffff0000, v121
    v_mul_f32 v24, v24, v23
    v_mul_f32 v25, v25, v23
    v_cvt_pk_bf16_f32 v121, v24, v25
    v_lshlrev_b32 v24, 16, v122
    v_and_b32 v25, 0xffff0000, v122
    v_mul_f32 v24, v24, v23
    v_mul_f32 v25, v25, v23
    v_cvt_pk_bf16_f32 v122, v24, v25
    v_lshlrev_b32 v24, 16, v123
    v_and_b32 v25, 0xffff0000, v123
    v_mul_f32 v24, v24, v23
    v_mul_f32 v25, v25, v23
    v_cvt_pk_bf16_f32 v123, v24, v25
    v_accvgpr_read_b32 v25, a12
    v_accvgpr_read_b32 v26, a13
    v_accvgpr_read_b32 v27, a14
    v_accvgpr_read_b32 v28, a15
    v_mul_f32 v25, v25, v23
    v_mul_f32 v26, v26, v23
    v_mul_f32 v27, v27, v23
    v_mul_f32 v28, v28, v23
    v_accvgpr_write_b32 a12, v25
    v_accvgpr_write_b32 a13, v26
    v_accvgpr_write_b32 a14, v27
    v_accvgpr_write_b32 a15, v28
    v_accvgpr_read_b32 v25, a28
    v_accvgpr_read_b32 v26, a29
    v_accvgpr_read_b32 v27, a30
    v_accvgpr_read_b32 v28, a31
    v_mul_f32 v25, v25, v23
    v_mul_f32 v26, v26, v23
    v_mul_f32 v27, v27, v23
    v_mul_f32 v28, v28, v23
    v_accvgpr_write_b32 a28, v25
    v_accvgpr_write_b32 a29, v26
    v_accvgpr_write_b32 a30, v27
    v_accvgpr_write_b32 a31, v28
    v_accvgpr_read_b32 v25, a44
    v_accvgpr_read_b32 v26, a45
    v_accvgpr_read_b32 v27, a46
    v_accvgpr_read_b32 v28, a47
    v_mul_f32 v25, v25, v23
    v_mul_f32 v26, v26, v23
    v_mul_f32 v27, v27, v23
    v_mul_f32 v28, v28, v23
    v_accvgpr_write_b32 a44, v25
    v_accvgpr_write_b32 a45, v26
    v_accvgpr_write_b32 a46, v27
    v_accvgpr_write_b32 a47, v28
    v_accvgpr_read_b32 v25, a60
    v_accvgpr_read_b32 v26, a61
    v_accvgpr_read_b32 v27, a62
    v_accvgpr_read_b32 v28, a63
    v_mul_f32 v25, v25, v23
    v_mul_f32 v26, v26, v23
    v_mul_f32 v27, v27, v23
    v_mul_f32 v28, v28, v23
    v_accvgpr_write_b32 a60, v25
    v_accvgpr_write_b32 a61, v26
    v_accvgpr_write_b32 a62, v27
    v_accvgpr_write_b32 a63, v28
    v_accvgpr_read_b32 v25, a76
    v_accvgpr_read_b32 v26, a77
    v_accvgpr_read_b32 v27, a78
    v_accvgpr_read_b32 v28, a79
    v_mul_f32 v25, v25, v23
    v_mul_f32 v26, v26, v23
    v_mul_f32 v27, v27, v23
    v_mul_f32 v28, v28, v23
    v_accvgpr_write_b32 a76, v25
    v_accvgpr_write_b32 a77, v26
    v_accvgpr_write_b32 a78, v27
    v_accvgpr_write_b32 a79, v28
    v_accvgpr_read_b32 v25, a92
    v_accvgpr_read_b32 v26, a93
    v_accvgpr_read_b32 v27, a94
    v_accvgpr_read_b32 v28, a95
    v_mul_f32 v25, v25, v23
    v_mul_f32 v26, v26, v23
    v_mul_f32 v27, v27, v23
    v_mul_f32 v28, v28, v23
    v_accvgpr_write_b32 a92, v25
    v_accvgpr_write_b32 a93, v26
    v_accvgpr_write_b32 a94, v27
    v_accvgpr_write_b32 a95, v28
    v_accvgpr_read_b32 v25, a108
    v_accvgpr_read_b32 v26, a109
    v_accvgpr_read_b32 v27, a110
    v_accvgpr_read_b32 v28, a111
    v_mul_f32 v25, v25, v23
    v_mul_f32 v26, v26, v23
    v_mul_f32 v27, v27, v23
    v_mul_f32 v28, v28, v23
    v_accvgpr_write_b32 a108, v25
    v_accvgpr_write_b32 a109, v26
    v_accvgpr_write_b32 a110, v27
    v_accvgpr_write_b32 a111, v28
    v_accvgpr_read_b32 v25, a124
    v_accvgpr_read_b32 v26, a125
    v_accvgpr_read_b32 v27, a126
    v_accvgpr_read_b32 v28, a127
    v_mul_f32 v25, v25, v23
    v_mul_f32 v26, v26, v23
    v_mul_f32 v27, v27, v23
    v_mul_f32 v28, v28, v23
    v_accvgpr_write_b32 a124, v25
    v_accvgpr_write_b32 a125, v26
    v_accvgpr_write_b32 a126, v27
    v_accvgpr_write_b32 a127, v28
    v_accvgpr_read_b32 v25, a140
    v_accvgpr_read_b32 v26, a141
    v_accvgpr_read_b32 v27, a142
    v_accvgpr_read_b32 v28, a143
    v_mul_f32 v25, v25, v23
    v_mul_f32 v26, v26, v23
    v_mul_f32 v27, v27, v23
    v_mul_f32 v28, v28, v23
    v_accvgpr_write_b32 a140, v25
    v_accvgpr_write_b32 a141, v26
    v_accvgpr_write_b32 a142, v27
    v_accvgpr_write_b32 a143, v28
    v_accvgpr_read_b32 v25, a156
    v_accvgpr_read_b32 v26, a157
    v_accvgpr_read_b32 v27, a158
    v_accvgpr_read_b32 v28, a159
    v_mul_f32 v25, v25, v23
    v_mul_f32 v26, v26, v23
    v_mul_f32 v27, v27, v23
    v_mul_f32 v28, v28, v23
    v_accvgpr_write_b32 a156, v25
    v_accvgpr_write_b32 a157, v26
    v_accvgpr_write_b32 a158, v27
    v_accvgpr_write_b32 a159, v28
    v_accvgpr_read_b32 v25, a172
    v_accvgpr_read_b32 v26, a173
    v_accvgpr_read_b32 v27, a174
    v_accvgpr_read_b32 v28, a175
    v_mul_f32 v25, v25, v23
    v_mul_f32 v26, v26, v23
    v_mul_f32 v27, v27, v23
    v_mul_f32 v28, v28, v23
    v_accvgpr_write_b32 a172, v25
    v_accvgpr_write_b32 a173, v26
    v_accvgpr_write_b32 a174, v27
    v_accvgpr_write_b32 a175, v28
    v_accvgpr_read_b32 v25, a188
    v_accvgpr_read_b32 v26, a189
    v_accvgpr_read_b32 v27, a190
    v_accvgpr_read_b32 v28, a191
    v_mul_f32 v25, v25, v23
    v_mul_f32 v26, v26, v23
    v_mul_f32 v27, v27, v23
    v_mul_f32 v28, v28, v23
    v_accvgpr_write_b32 a188, v25
    v_accvgpr_write_b32 a189, v26
    v_accvgpr_write_b32 a190, v27
    v_accvgpr_write_b32 a191, v28
    v_accvgpr_read_b32 v25, a204
    v_accvgpr_read_b32 v26, a205
    v_accvgpr_read_b32 v27, a206
    v_accvgpr_read_b32 v28, a207
    v_mul_f32 v25, v25, v23
    v_mul_f32 v26, v26, v23
    v_mul_f32 v27, v27, v23
    v_mul_f32 v28, v28, v23
    v_accvgpr_write_b32 a204, v25
    v_accvgpr_write_b32 a205, v26
    v_accvgpr_write_b32 a206, v27
    v_accvgpr_write_b32 a207, v28
    v_accvgpr_read_b32 v25, a220
    v_accvgpr_read_b32 v26, a221
    v_accvgpr_read_b32 v27, a222
    v_accvgpr_read_b32 v28, a223
    v_mul_f32 v25, v25, v23
    v_mul_f32 v26, v26, v23
    v_mul_f32 v27, v27, v23
    v_mul_f32 v28, v28, v23
    v_accvgpr_write_b32 a220, v25
    v_accvgpr_write_b32 a221, v26
    v_accvgpr_write_b32 a222, v27
    v_accvgpr_write_b32 a223, v28
    v_accvgpr_read_b32 v25, a236
    v_accvgpr_read_b32 v26, a237
    v_accvgpr_read_b32 v27, a238
    v_accvgpr_read_b32 v28, a239
    v_mul_f32 v25, v25, v23
    v_mul_f32 v26, v26, v23
    v_mul_f32 v27, v27, v23
    v_mul_f32 v28, v28, v23
    v_accvgpr_write_b32 a236, v25
    v_accvgpr_write_b32 a237, v26
    v_accvgpr_write_b32 a238, v27
    v_accvgpr_write_b32 a239, v28
    v_accvgpr_read_b32 v25, a252
    v_accvgpr_read_b32 v26, a253
    v_accvgpr_read_b32 v27, a254
    v_accvgpr_read_b32 v28, a255
    v_mul_f32 v25, v25, v23
    v_mul_f32 v26, v26, v23
    v_mul_f32 v27, v27, v23
    v_mul_f32 v28, v28, v23
    v_accvgpr_write_b32 a252, v25
    v_accvgpr_write_b32 a253, v26
    v_accvgpr_write_b32 a254, v27
    v_accvgpr_write_b32 a255, v28
    s_nop 3
    s_branch L_back1
.section .rodata,"a"
.p2align 6
.amdhsa_kernel standalone__mha_softmax__near_ridge_kernel
  .amdhsa_next_free_vgpr 512
  .amdhsa_next_free_sgpr 102
  .amdhsa_accum_offset 256
  .amdhsa_group_segment_fixed_size 0
  .amdhsa_kernarg_size 48
  .amdhsa_user_sgpr_count 2
  .amdhsa_user_sgpr_kernarg_segment_ptr 1
  .amdhsa_system_sgpr_workgroup_id_x 1
.end_amdhsa_kernel
```
